```python
import torch

def _softmax(x, axis=-1):
    return torch.softmax(x, dim=axis)
def _gelu(x):
    return torch.nn.functional.gelu(x, approximate="tanh")
def _silu(x):
    return torch.nn.functional.silu(x)
def _sigmoid(x):
    return torch.sigmoid(x)
def _layernorm(x, axis=-1, eps=1e-5):
    m = x.mean(dim=axis, keepdim=True)
    v = x.var(dim=axis, keepdim=True, unbiased=False)
    return (x - m) / torch.sqrt(v + eps)
def _scatter_add(tgt, idx, src, axis=0):
    return tgt.clone().index_add_(axis, idx, src)
def _segment_sum(src, seg, n):
    out = torch.zeros((n,) + src.shape[1:], dtype=src.dtype)
    return out.index_add_(0, seg, src)
def _pad(x, pw):
    flat = tuple(v for pair in reversed(pw) for v in pair)
    return torch.nn.functional.pad(x, flat)

kernel_name = 'recurrent_scan__linear_kernel_hedgehog__glu_gated_geglu__prompt'

def setup_inputs():

    _w = (lambda a: (lambda t: t.to(torch.bfloat16) if t.is_floating_point() else t)(torch.as_tensor(a)))
    def _A_setup():
        B, S, D, H = 1, 2048, 512, 32
        Dh = D // H
        return {
            "x": _w((lambda *s: torch.randn(*s, dtype=torch.bfloat16) * 0.05)(B, S, D)),
            "wqkv": _w((lambda *s: torch.randn(*s, dtype=torch.bfloat16) * 0.8)(D, 3 * D)),
            "w_phi": _w((lambda *s: torch.randn(*s, dtype=torch.bfloat16) * 0.8)(H, Dh, Dh) * (Dh ** -0.5)),
            "wo": _w((lambda *s: torch.randn(*s, dtype=torch.bfloat16) * 0.8)(D, D)),
        }
    _A_in = _A_setup()

    def _B_setup():
        B, S, Dm, Df = 1, 2048, 512, 1792
        return {
            "x": _w((lambda *s: torch.randn(*s, dtype=torch.bfloat16) * 0.05)(B, S, Dm)),
            "w_gate": _w((lambda *s: torch.randn(*s, dtype=torch.bfloat16) * 0.2)(Dm, Df) * (Dm ** -0.5)),
            "w_up": _w((lambda *s: torch.randn(*s, dtype=torch.bfloat16) * 0.2)(Dm, Df) * (Dm ** -0.5)),
            "w_down": _w((lambda *s: torch.randn(*s, dtype=torch.bfloat16) * 0.2)(Df, Dm) * (Df ** -0.5)),
        }
    _B_in = _B_setup()

    return {
        "A_x": _A_in["x"],
        "A_wqkv": _A_in["wqkv"],
        "A_w_phi": _A_in["w_phi"],
        "A_wo": _A_in["wo"],
        "B_x": _B_in["x"],
        "B_w_gate": _B_in["w_gate"],
        "B_w_up": _B_in["w_up"],
        "B_w_down": _B_in["w_down"],
    }

def reference(A_x, A_wqkv, A_w_phi, A_wo, B_x, B_w_gate, B_w_up, B_w_down):
    def _A_ref(x, wqkv, w_phi, wo):
        B, S, D = x.shape
        H = 32; Dh = D // H
        qkv = (lambda x, *d: x.permute(*d))((x @ wqkv).reshape(B, S, 3, H, Dh), 2, 0, 3, 1, 4)
        q, k, v = qkv[0], qkv[1], qkv[2]
        pq = torch.einsum("bhsd,hdf->bhsf", q, w_phi)
        pk = torch.einsum("bhsd,hdf->bhsf", k, w_phi)
        phi_q = torch.concatenate([_softmax(pq, axis=-1), _softmax(-pq, axis=-1)], axis=-1)
        phi_k = torch.concatenate([_softmax(pk, axis=-1), _softmax(-pk, axis=-1)], axis=-1)
        kv = torch.einsum("bhsf,bhsd->bhfd", phi_k, v)
        z  = torch.einsum("bhsf->bhf", phi_k)
        num = torch.einsum("bhqf,bhfd->bhqd", phi_q, kv)
        den = torch.einsum("bhqf,bhf->bhq", phi_q, z)[..., None] + 1e-6
        o = num / den
        return (lambda x, *d: x.permute(*d))(o, 0, 2, 1, 3).reshape(B, S, D) @ wo

    def _B_ref(x, w_gate, w_up, w_down):
        g = torch.einsum("bsd,df->bsf", x, w_gate)
        u = torch.einsum("bsd,df->bsf", x, w_up)
        h = _gelu(g) * u
        return torch.einsum("bsf,fd->bsd", h, w_down)

    x = A_x
    xn = _layernorm(x, axis=-1)
    s = _A_ref(xn, A_wqkv, A_w_phi, A_wo)
    g = _silu(_B_ref(xn, B_w_gate, B_w_up, B_w_down))
    return x + s * g
```

```asm
; @launch grid=(256,1,1) block=(512,1,1) lds=163840
.amdgcn_target "amdgcn-amd-amdhsa--gfx950"
.text
.globl recurrent_scan__linear_kernel_hedgehog__glu_gated_geglu__prompt_kernel
.p2align 8
.type recurrent_scan__linear_kernel_hedgehog__glu_gated_geglu__prompt_kernel,@function
recurrent_scan__linear_kernel_hedgehog__glu_gated_geglu__prompt_kernel:
    s_cmp_lt_u32 s2, 256
    s_cbranch_scc1 K1_GO
    s_endpgm
K1_GO:
    s_load_dwordx2 s[4:5], s[0:1], 0
    s_load_dwordx2 s[8:9], s[0:1], 8
    s_load_dwordx2 s[12:13], s[0:1], 40
    s_load_dwordx2 s[16:17], s[0:1], 48
    s_load_dwordx2 s[20:21], s[0:1], 80
    s_load_dwordx2 s[24:25], s[0:1], 16
    s_load_dwordx2 s[28:29], s[0:1], 72
    s_load_dwordx2 s[40:41], s[0:1], 56
    s_load_dwordx2 s[44:45], s[0:1], 24
    s_load_dwordx2 s[48:49], s[0:1], 64
    v_lshrrev_b32 v37, 6, v0
    v_lshrrev_b32 v32, 3, v0
    v_readfirstlane_b32 s32, v37
    v_and_b32 v33, 7, v0
    v_bfe_u32 v34, v0, 4, 3
    s_and_b32 s70, s2, 3
    s_lshl_b32 s70, s70, 2
    s_bfe_u32 s71, s2, 0x20003
    s_add_u32 s35, s70, s71
    s_and_b32 s70, s2, 4
    s_lshr_b32 s71, s2, 6
    s_add_u32 s36, s70, s71
    s_bfe_u32 s37, s2, 0x10005
    s_lshl_b32 s72, s35, 17
    v_xor_b32 v35, v34, v33
    v_lshl_add_u32 v35, v35, 4, s72
    v_lshl_add_u32 v64, v32, 10, v35
    v_and_b32 v35, 4, v34
    v_and_b32 v34, 1, v34
    v_lshl_or_b32 v35, v34, 1, v35
    v_xor_b32 v35, v35, v33
    s_lshl_b32 s70, s36, 7
    s_lshl_b32 s71, s36, 8
    s_add_u32 s71, s71, 1024
    s_cmp_eq_u32 s37, 0
    s_cselect_b32 s71, s70, s71
    v_lshl_add_u32 v36, v35, 4, s70
    v_lshl_add_u32 v35, v35, 4, s71
    s_movk_i32 s70, 3072
    s_movk_i32 s71, 3584
    v_mad_u32_u24 v1, v32, s70, v36
    v_mad_u32_u24 v2, v32, s71, v35
    s_lshl_b32 s38, s32, 10
    s_mov_b32 s6, 2097152
    s_mov_b32 s7, 0x20000
    s_mov_b32 s10, 1572864
    s_mov_b32 s11, 0x20000
    s_mov_b32 s14, 1835008
    s_mov_b32 s15, 0x20000
    s_mov_b32 s18, 1835008
    s_mov_b32 s19, 0x20000
    s_cmp_eq_u32 s37, 1
    s_waitcnt lgkmcnt(0)
    s_cbranch_scc1 K1_TYPEB
    s_add_u32 m0, s38, 0
    s_nop 0
    buffer_load_dwordx4 v64, s[4:7], 0 offen lds
    s_add_u32 m0, s38, 16384
    s_mov_b32 s39, 1024
    buffer_load_dwordx4 v1, s[8:11], s39 offen lds
    s_add_u32 m0, s38, 8192
    s_mov_b32 s39, 65536
    buffer_load_dwordx4 v64, s[4:7], s39 offen lds
    s_add_u32 m0, s38, 24576
    s_mov_b32 s39, 2048
    buffer_load_dwordx4 v1, s[8:11], s39 offen lds
    s_mov_b32 s22, 9519104
    s_mov_b32 s23, 0x20000
    s_mov_b32 s26, 16384
    s_mov_b32 s27, 0x20000
    s_mov_b32 s30, 256
    s_mov_b32 s31, 0x20000
    s_mov_b32 s42, 1835008
    s_mov_b32 s43, 0x20000
    s_mov_b32 s46, 524288
    s_mov_b32 s47, 0x20000
    s_mov_b32 s50, 2097152
    s_mov_b32 s51, 0x20000
    v_and_b32 v0, 63, v0
    s_and_b32 s33, s32, 3
    s_lshr_b32 s34, s32, 2
    v_lshlrev_b32 v34, 2, v34
    v_xor_b32 v33, v33, v34
    s_lshr_b32 s70, s2, 5
    s_lshl_b32 s70, s70, 7
    v_lshl_add_u32 v33, v33, 4, s70
    v_lshl_add_u32 v30, v32, 10, v33
    s_mul_i32 s90, s36, 10240
    s_add_u32 s90, s90, 9437184
    v_lshrrev_b32 v32, 4, v0
    v_bfe_u32 v33, v0, 2, 2
    v_lshl_add_u32 v34, v32, 3, v33
    v_lshlrev_b32 v34, 7, v34
    v_bfe_u32 v35, v0, 3, 2
    s_lshl_b32 s70, s34, 1
    s_and_b32 s71, s33, 1
    s_or_b32 s70, s70, s71
    v_xor_b32 v35, s70, v35
    v_lshl_add_u32 v34, v35, 5, v34
    v_and_b32 v35, 3, v0
    v_lshl_add_u32 v34, v35, 3, v34
    s_lshr_b32 s71, s33, 1
    s_lshl_b32 s72, s71, 12
    v_add_u32 v4, s72, v34
    v_xor_b32 v5, 32, v4
    v_xor_b32 v6, 0x1000, v4
    v_xor_b32 v7, 0x1020, v4
    v_and_b32 v33, 15, v0
    s_lshl_b32 s72, s33, 5
    s_lshl_b32 s73, s34, 4
    s_add_u32 s72, s72, s73
    v_add_u32 v34, s72, v33
    s_lshl_b32 s71, s71, 2
    v_or_b32 v35, s71, v32
    v_lshrrev_b32 v36, 1, v33
    v_xor_b32 v35, v35, v36
    v_lshlrev_b32 v35, 4, v35
    v_lshl_add_u32 v66, v34, 7, v35
    v_xor_b32 v67, 64, v66
    v_xor_b32 v68, 0x800, v66
    v_xor_b32 v69, 0x840, v66
    v_xor_b32 v3, s73, v0
    v_lshlrev_b32 v3, 4, v3
    s_mov_b32 s76, 0x22222222
    s_mov_b32 s77, 0x22222222
    s_mov_b32 s78, 0x44444444
    s_mov_b32 s79, 0x44444444
    s_mov_b32 s80, 0x88888888
    s_mov_b32 s81, 0x88888888
    s_mov_b32 s82, 0x0
    s_mov_b32 s83, 0xffffffff
    s_mov_b32 s84, 0xffff0000
    s_mov_b32 s85, 0xffff0000
    s_mov_b32 s86, 0xf0f0f0f
    s_mov_b32 s87, 0xf0f0f0f
    s_mov_b32 s88, 0xf0f0f0f0
    s_mov_b32 s89, 0xf0f0f0f0
    s_mov_b32 vcc_lo, 0x00ff00ff
    s_mov_b32 vcc_hi, 0x00ff00ff
    v_mov_b32 v72, 0x3f803f80
    v_mov_b32 v73, v72
    v_mov_b32 v74, v72
    v_mov_b32 v75, v72
    v_cndmask_b32 v8, 0, v72, vcc
    v_xor_b32 v12, v8, v72
    v_mov_b32 v9, v8
    v_mov_b32 v13, v12
    v_mov_b32 v10, v8
    v_mov_b32 v14, v12
    v_mov_b32 v11, v8
    v_mov_b32 v15, v12
    s_lshl_b32 s70, s35, 2
    s_add_u32 s70, s70, s33
    s_mul_i32 s70, s70, 147456
    s_lshl_b32 s71, s34, 11
    s_add_u32 s70, s70, s71
    s_and_b32 s71, s33, 1
    s_lshl_b32 s72, s71, 10
    s_add_u32 s68, s70, s72
    s_xor_b32 s72, s72, 1024
    s_add_u32 s69, s70, s72
    s_lshl_b32 s70, s34, 9
    s_lshl_b32 s71, s71, 7
    s_add_u32 s70, s70, s71
    s_add_u32 s75, s70, 157696
    s_lshr_b32 s71, s33, 1
    s_lshl_b32 s71, s71, 6
    s_add_u32 s74, s75, s71
    s_lshr_b32 s70, s35, 1
    s_mul_i32 s70, s70, 10240
    s_and_b32 s71, s35, 1
    s_mul_i32 s71, s71, 384
    s_add_u32 s70, s70, s71
    s_add_u32 s97, s70, 9446144
    s_cmp_eq_u32 s32, 0
    s_cselect_b32 s97, s97, 2146435072
    s_and_b32 s70, s2, 3
    s_lshl_b32 s70, s70, 3
    s_and_b32 s71, s2, 4
    s_add_u32 s70, s70, s71
    s_bfe_u32 s71, s2, 0x20003
    s_add_u32 s70, s70, s71
    s_lshr_b32 s71, s70, 2
    s_mul_i32 s71, s71, 10240
    s_bfe_u32 s72, s70, 0x10001
    s_mul_i32 s72, s72, 384
    s_add_u32 s71, s71, s72
    s_add_u32 s96, s71, 9446144
    s_lshl_b32 s70, s70, 1
    s_add_u32 s70, s70, s34
    s_mul_i32 s71, s70, 147456
    s_lshl_b32 s72, s33, 12
    s_add_u32 s94, s71, s72
    s_add_u32 s95, s94, s72
    s_lshl_b32 s70, s70, 15
    s_lshr_b32 s71, s2, 5
    s_lshl_b32 s71, s71, 7
    s_add_u32 s70, s70, s71
    s_lshl_b32 s71, s33, 5
    s_add_u32 s98, s70, s71
    s_add_u32 m0, s38, 32768
    s_mov_b32 s39, 128
    buffer_load_dwordx4 v64, s[4:7], s39 offen lds
    s_add_u32 m0, s38, 49152
    s_mov_b32 s39, 197632
    buffer_load_dwordx4 v1, s[8:11], s39 offen lds
    s_add_u32 m0, s38, 40960
    s_mov_b32 s39, 65664
    buffer_load_dwordx4 v64, s[4:7], s39 offen lds
    s_add_u32 m0, s38, 57344
    s_mov_b32 s39, 198656
    buffer_load_dwordx4 v1, s[8:11], s39 offen lds
    v_lshlrev_b32 v32, 4, v0
    s_lshl_b32 s70, s36, 11
    s_and_b32 s71, s38, 1024
    s_add_u32 s70, s70, s71
    s_add_u32 m0, s71, 160768
    s_nop 0
    buffer_load_dwordx4 v32, s[24:27], s70 offen lds
    s_waitcnt vmcnt(5)
    s_barrier
    ds_read_b128 v[128:131], v66 offset:0
    ds_read_b128 v[136:139], v67 offset:0
    ds_read_b128 v[132:135], v68 offset:0
    ds_read_b128 v[140:143], v69 offset:0
    v_lshlrev_b32 v70, 7, v0
    s_lshl_b32 s92, s2, 3
    s_add_u32 s92, s92, s32
    s_mov_b32 m0, 156672
    s_mul_i32 s93, s92, 768
    s_mov_b64 exec, 63
    buffer_load_dword v70, s[8:11], s93 offen lds
    s_mov_b64 exec, -1
    ds_read_b64_tr_b16 v[40:41], v4 offset:16384
    ds_read_b64_tr_b16 v[42:43], v4 offset:16896
    ds_read_b64_tr_b16 v[44:45], v6 offset:16384
    ds_read_b64_tr_b16 v[46:47], v6 offset:16896
    ds_read_b64_tr_b16 v[48:49], v4 offset:24576
    ds_read_b64_tr_b16 v[50:51], v4 offset:25088
    ds_read_b64_tr_b16 v[52:53], v6 offset:24576
    ds_read_b64_tr_b16 v[54:55], v6 offset:25088
    s_waitcnt lgkmcnt(4)
    v_mfma_f32_16x16x32_bf16 v[96:99], v[40:43], v[128:131], 0
    ds_read_b64_tr_b16 v[56:57], v5 offset:16384
    v_mfma_f32_16x16x32_bf16 v[96:99], v[44:47], v[136:139], v[96:99]
    ds_read_b64_tr_b16 v[58:59], v5 offset:16896
    s_add_u32 m0, s38, 65536
    s_mov_b32 s39, 256
    buffer_load_dwordx4 v64, s[4:7], s39 offen lds
    v_mfma_f32_16x16x32_bf16 v[100:103], v[40:43], v[132:135], 0
    ds_read_b64_tr_b16 v[60:61], v7 offset:16384
    v_mfma_f32_16x16x32_bf16 v[100:103], v[44:47], v[140:143], v[100:103]
    ds_read_b64_tr_b16 v[62:63], v7 offset:16896
    s_add_u32 m0, s38, 81920
    s_mov_b32 s39, 394240
    buffer_load_dwordx4 v1, s[8:11], s39 offen lds
    v_mfma_f32_16x16x32_bf16 v[16:19], v[8:11], v[40:43], 0
    s_waitcnt lgkmcnt(4)
    v_mfma_f32_16x16x32_bf16 v[112:115], v[48:51], v[128:131], 0
    ds_read_b64_tr_b16 v[40:41], v5 offset:24576
    v_mfma_f32_16x16x32_bf16 v[112:115], v[52:55], v[136:139], v[112:115]
    ds_read_b64_tr_b16 v[42:43], v5 offset:25088
    s_add_u32 m0, s38, 73728
    s_mov_b32 s39, 65792
    buffer_load_dwordx4 v64, s[4:7], s39 offen lds
    v_mfma_f32_16x16x32_bf16 v[116:119], v[48:51], v[132:135], 0
    ds_read_b64_tr_b16 v[44:45], v7 offset:24576
    v_mfma_f32_16x16x32_bf16 v[116:119], v[52:55], v[140:143], v[116:119]
    ds_read_b64_tr_b16 v[46:47], v7 offset:25088
    s_add_u32 m0, s38, 90112
    s_mov_b32 s39, 395264
    buffer_load_dwordx4 v1, s[8:11], s39 offen lds
    v_mfma_f32_16x16x32_bf16 v[16:19], v[12:15], v[48:51], v[16:19]
    s_waitcnt lgkmcnt(4)
    v_mfma_f32_16x16x32_bf16 v[88:91], v[72:75], v[128:131], 0
    v_mfma_f32_16x16x32_bf16 v[88:91], v[72:75], v[136:139], v[88:91]
    s_waitcnt vmcnt(6)
    s_waitcnt lgkmcnt(0)
    s_barrier
    v_lshlrev_b32 v70, 7, v0
    s_lshl_b32 s92, s2, 3
    s_add_u32 s92, s92, s32
    s_mov_b32 m0, 156672
    s_mul_i32 s93, s92, 896
    s_mov_b64 exec, 127
    buffer_load_dword v70, s[12:15], s93 offen lds
    s_mov_b64 exec, -1
    ds_read_b64_tr_b16 v[48:49], v4 offset:49152
    v_mfma_f32_16x16x32_bf16 v[104:107], v[56:59], v[128:131], 0
    ds_read_b64_tr_b16 v[50:51], v4 offset:49664
    ds_read_b128 v[144:147], v66 offset:32768
    v_mfma_f32_16x16x32_bf16 v[104:107], v[60:63], v[136:139], v[104:107]
    ds_read_b64_tr_b16 v[52:53], v6 offset:49152
    s_add_u32 m0, s38, 98304
    s_mov_b32 s39, 384
    buffer_load_dwordx4 v64, s[4:7], s39 offen lds
    v_mfma_f32_16x16x32_bf16 v[108:111], v[56:59], v[132:135], 0
    ds_read_b64_tr_b16 v[54:55], v6 offset:49664
    ds_read_b128 v[152:155], v67 offset:32768
    v_mfma_f32_16x16x32_bf16 v[108:111], v[60:63], v[140:143], v[108:111]
    v_mfma_f32_16x16x32_bf16 v[92:95], v[128:131], v[128:131], 0
    ds_read_b64_tr_b16 v[56:57], v4 offset:57344
    v_mfma_f32_16x16x32_bf16 v[92:95], v[136:139], v[136:139], v[92:95]
    ds_read_b64_tr_b16 v[58:59], v4 offset:57856
    s_add_u32 m0, s38, 114688
    s_mov_b32 s39, 590848
    buffer_load_dwordx4 v1, s[8:11], s39 offen lds
    v_mfma_f32_16x16x32_bf16 v[120:123], v[40:43], v[128:131], 0
    ds_read_b64_tr_b16 v[60:61], v6 offset:57344
    ds_read_b128 v[148:151], v68 offset:32768
    v_mfma_f32_16x16x32_bf16 v[120:123], v[44:47], v[136:139], v[120:123]
    ds_read_b64_tr_b16 v[62:63], v6 offset:57856
    s_add_u32 m0, s38, 106496
    s_mov_b32 s39, 65920
    buffer_load_dwordx4 v64, s[4:7], s39 offen lds
    v_mfma_f32_16x16x32_bf16 v[124:127], v[40:43], v[132:135], 0
    ds_read_b128 v[156:159], v69 offset:32768
    v_mfma_f32_16x16x32_bf16 v[124:127], v[44:47], v[140:143], v[124:127]
    s_waitcnt lgkmcnt(7)
    v_mfma_f32_16x16x32_bf16 v[96:99], v[48:51], v[144:147], v[96:99]
    ds_read_b64_tr_b16 v[40:41], v5 offset:49152
    s_waitcnt lgkmcnt(7)
    v_mfma_f32_16x16x32_bf16 v[96:99], v[52:55], v[152:155], v[96:99]
    ds_read_b64_tr_b16 v[42:43], v5 offset:49664
    s_add_u32 m0, s38, 122880
    s_mov_b32 s39, 591872
    buffer_load_dwordx4 v1, s[8:11], s39 offen lds
    s_waitcnt lgkmcnt(4)
    v_mfma_f32_16x16x32_bf16 v[100:103], v[48:51], v[148:151], v[100:103]
    ds_read_b64_tr_b16 v[44:45], v7 offset:49152
    s_waitcnt lgkmcnt(3)
    v_mfma_f32_16x16x32_bf16 v[100:103], v[52:55], v[156:159], v[100:103]
    ds_read_b64_tr_b16 v[46:47], v7 offset:49664
    s_add_u32 m0, s38, 0
    s_mov_b32 s39, 512
    buffer_load_dwordx4 v64, s[4:7], s39 offen lds
    v_mfma_f32_16x16x32_bf16 v[16:19], v[8:11], v[48:51], v[16:19]
    v_mfma_f32_16x16x32_bf16 v[112:115], v[56:59], v[144:147], v[112:115]
    ds_read_b64_tr_b16 v[48:49], v5 offset:57344
    v_mfma_f32_16x16x32_bf16 v[112:115], v[60:63], v[152:155], v[112:115]
    ds_read_b64_tr_b16 v[50:51], v5 offset:57856
    s_add_u32 m0, s38, 16384
    s_mov_b32 s39, 787456
    buffer_load_dwordx4 v1, s[8:11], s39 offen lds
    v_mfma_f32_16x16x32_bf16 v[116:119], v[56:59], v[148:151], v[116:119]
    ds_read_b64_tr_b16 v[52:53], v7 offset:57344
    v_mfma_f32_16x16x32_bf16 v[116:119], v[60:63], v[156:159], v[116:119]
    ds_read_b64_tr_b16 v[54:55], v7 offset:57856
    v_mfma_f32_16x16x32_bf16 v[16:19], v[12:15], v[56:59], v[16:19]
    s_waitcnt lgkmcnt(4)
    v_mfma_f32_16x16x32_bf16 v[88:91], v[72:75], v[144:147], v[88:91]
    v_mfma_f32_16x16x32_bf16 v[88:91], v[72:75], v[152:155], v[88:91]
    s_waitcnt vmcnt(7)
    s_waitcnt lgkmcnt(0)
    s_barrier
    v_add_u32 v66, 0x10000, v66
    v_add_u32 v67, 0x10000, v67
    v_add_u32 v68, 0x10000, v68
    v_add_u32 v69, 0x10000, v69
    v_lshlrev_b32 v70, 7, v0
    s_lshl_b32 s92, s2, 3
    s_add_u32 s92, s92, s32
    s_mov_b32 m0, 156672
    s_mul_i32 s93, s92, 896
    s_mov_b64 exec, 127
    buffer_load_dword v70, s[16:19], s93 offen lds
    s_mov_b64 exec, -1
    v_add_u32 v4, 0x10000, v4
    v_add_u32 v5, 0x10000, v5
    v_add_u32 v6, 0x10000, v6
    v_add_u32 v7, 0x10000, v7
    ds_read_b64_tr_b16 v[56:57], v4 offset:16384
    v_mfma_f32_16x16x32_bf16 v[104:107], v[40:43], v[144:147], v[104:107]
    ds_read_b64_tr_b16 v[58:59], v4 offset:16896
    ds_read_b128 v[160:163], v66 offset:0
    v_mfma_f32_16x16x32_bf16 v[104:107], v[44:47], v[152:155], v[104:107]
    ds_read_b64_tr_b16 v[60:61], v6 offset:16384
    s_add_u32 m0, s38, 8192
    s_mov_b32 s39, 66048
    buffer_load_dwordx4 v64, s[4:7], s39 offen lds
    v_mfma_f32_16x16x32_bf16 v[108:111], v[40:43], v[148:151], v[108:111]
    ds_read_b64_tr_b16 v[62:63], v6 offset:16896
    ds_read_b128 v[168:171], v67 offset:0
    v_mfma_f32_16x16x32_bf16 v[108:111], v[44:47], v[156:159], v[108:111]
    v_mfma_f32_16x16x32_bf16 v[92:95], v[144:147], v[144:147], v[92:95]
    ds_read_b64_tr_b16 v[40:41], v4 offset:24576
    v_mfma_f32_16x16x32_bf16 v[92:95], v[152:155], v[152:155], v[92:95]
    ds_read_b64_tr_b16 v[42:43], v4 offset:25088
    s_add_u32 m0, s38, 24576
    s_mov_b32 s39, 788480
    buffer_load_dwordx4 v1, s[8:11], s39 offen lds
    v_mfma_f32_16x16x32_bf16 v[120:123], v[48:51], v[144:147], v[120:123]
    ds_read_b64_tr_b16 v[44:45], v6 offset:24576
    ds_read_b128 v[164:167], v68 offset:0
    v_mfma_f32_16x16x32_bf16 v[120:123], v[52:55], v[152:155], v[120:123]
    ds_read_b64_tr_b16 v[46:47], v6 offset:25088
    s_add_u32 m0, s38, 32768
    s_mov_b32 s39, 640
    buffer_load_dwordx4 v64, s[4:7], s39 offen lds
    v_mfma_f32_16x16x32_bf16 v[124:127], v[48:51], v[148:151], v[124:127]
    ds_read_b128 v[172:175], v69 offset:0
    v_mfma_f32_16x16x32_bf16 v[124:127], v[52:55], v[156:159], v[124:127]
    s_waitcnt lgkmcnt(7)
    v_mfma_f32_16x16x32_bf16 v[96:99], v[56:59], v[160:163], v[96:99]
    ds_read_b64_tr_b16 v[48:49], v5 offset:16384
    s_waitcnt lgkmcnt(7)
    v_mfma_f32_16x16x32_bf16 v[96:99], v[60:63], v[168:171], v[96:99]
    ds_read_b64_tr_b16 v[50:51], v5 offset:16896
    s_add_u32 m0, s38, 49152
    s_mov_b32 s39, 984064
    buffer_load_dwordx4 v1, s[8:11], s39 offen lds
    s_waitcnt lgkmcnt(4)
    v_mfma_f32_16x16x32_bf16 v[100:103], v[56:59], v[164:167], v[100:103]
    ds_read_b64_tr_b16 v[52:53], v7 offset:16384
    s_waitcnt lgkmcnt(3)
    v_mfma_f32_16x16x32_bf16 v[100:103], v[60:63], v[172:175], v[100:103]
    ds_read_b64_tr_b16 v[54:55], v7 offset:16896
    v_mfma_f32_16x16x32_bf16 v[16:19], v[8:11], v[56:59], v[16:19]
    v_mfma_f32_16x16x32_bf16 v[112:115], v[40:43], v[160:163], v[112:115]
    ds_read_b64_tr_b16 v[56:57], v5 offset:24576
    v_mfma_f32_16x16x32_bf16 v[112:115], v[44:47], v[168:171], v[112:115]
    ds_read_b64_tr_b16 v[58:59], v5 offset:25088
    s_add_u32 m0, s38, 40960
    s_mov_b32 s39, 66176
    buffer_load_dwordx4 v64, s[4:7], s39 offen lds
    v_mfma_f32_16x16x32_bf16 v[116:119], v[40:43], v[164:167], v[116:119]
    ds_read_b64_tr_b16 v[60:61], v7 offset:24576
    v_mfma_f32_16x16x32_bf16 v[116:119], v[44:47], v[172:175], v[116:119]
    ds_read_b64_tr_b16 v[62:63], v7 offset:25088
    v_mfma_f32_16x16x32_bf16 v[16:19], v[12:15], v[40:43], v[16:19]
    s_waitcnt lgkmcnt(4)
    v_mfma_f32_16x16x32_bf16 v[88:91], v[72:75], v[160:163], v[88:91]
    v_mfma_f32_16x16x32_bf16 v[88:91], v[72:75], v[168:171], v[88:91]
    s_waitcnt vmcnt(8)
    s_waitcnt lgkmcnt(0)
    s_barrier
    ds_read_b64_tr_b16 v[40:41], v4 offset:49152
    v_mfma_f32_16x16x32_bf16 v[104:107], v[48:51], v[160:163], v[104:107]
    ds_read_b64_tr_b16 v[42:43], v4 offset:49664
    ds_read_b128 v[176:179], v66 offset:32768
    v_mfma_f32_16x16x32_bf16 v[104:107], v[52:55], v[168:171], v[104:107]
    ds_read_b64_tr_b16 v[44:45], v6 offset:49152
    s_add_u32 m0, s38, 57344
    s_mov_b32 s39, 985088
    buffer_load_dwordx4 v1, s[8:11], s39 offen lds
    v_mfma_f32_16x16x32_bf16 v[108:111], v[48:51], v[164:167], v[108:111]
    ds_read_b64_tr_b16 v[46:47], v6 offset:49664
    ds_read_b128 v[184:187], v67 offset:32768
    v_mfma_f32_16x16x32_bf16 v[108:111], v[52:55], v[172:175], v[108:111]
    v_and_b32 v24, 15, v0
    v_lshrrev_b32 v25, 5, v0
    s_lshl_b32 s70, s33, 8
    v_mfma_f32_16x16x32_bf16 v[92:95], v[160:163], v[160:163], v[92:95]
    v_lshl_add_u32 v20, v24, 2, s74
    s_lshl_b32 s71, s34, 7
    v_lshl_add_u32 v20, v25, 8, v20
    ds_read_b64_tr_b16 v[48:49], v4 offset:57344
    v_mfma_f32_16x16x32_bf16 v[92:95], v[168:171], v[168:171], v[92:95]
    ds_read_b64_tr_b16 v[50:51], v4 offset:57856
    s_add_u32 m0, s38, 65536
    s_mov_b32 s39, 768
    buffer_load_dwordx4 v64, s[4:7], s39 offen lds
    v_mfma_f32_16x16x32_bf16 v[120:123], v[56:59], v[160:163], v[120:123]
    s_add_u32 s70, s70, s71
    s_add_u32 s70, s70, 155648
    ds_read_b64_tr_b16 v[52:53], v6 offset:57344
    ds_read_b128 v[180:183], v68 offset:32768
    v_mfma_f32_16x16x32_bf16 v[120:123], v[60:63], v[168:171], v[120:123]
    ds_read_b64_tr_b16 v[54:55], v6 offset:57856
    s_add_u32 m0, s38, 81920
    s_mov_b32 s39, 1180672
    buffer_load_dwordx4 v1, s[8:11], s39 offen lds
    v_mfma_f32_16x16x32_bf16 v[124:127], v[56:59], v[164:167], v[124:127]
    v_lshl_add_u32 v22, v24, 3, s70
    s_mov_b32 vcc_lo, 0x00f0000f
    s_mov_b32 vcc_hi, 0xf0000f00
    ds_read_b128 v[188:191], v69 offset:32768
    v_mfma_f32_16x16x32_bf16 v[124:127], v[60:63], v[172:175], v[124:127]
    v_mov_b32 v21, 156672
    v_xor_b32 v23, 128, v22
    s_lshl_b32 s70, s34, 10
    s_waitcnt lgkmcnt(7)
    v_mfma_f32_16x16x32_bf16 v[96:99], v[40:43], v[176:179], v[96:99]
    v_cndmask_b32 v21, v21, v22, vcc
    v_and_b32 v28, 31, v0
    s_add_u32 s70, s70, 160768
    ds_read_b64_tr_b16 v[56:57], v5 offset:49152
    s_waitcnt lgkmcnt(7)
    v_mfma_f32_16x16x32_bf16 v[96:99], v[44:47], v[184:187], v[96:99]
    ds_read_b64_tr_b16 v[58:59], v5 offset:49664
    s_add_u32 m0, s38, 73728
    s_mov_b32 s39, 66304
    buffer_load_dwordx4 v64, s[4:7], s39 offen lds
    s_waitcnt lgkmcnt(4)
    v_mfma_f32_16x16x32_bf16 v[100:103], v[40:43], v[180:183], v[100:103]
    v_lshl_add_u32 v26, v28, 2, s75
    v_lshrrev_b32 v33, 5, v0
    ds_read_b64_tr_b16 v[60:61], v7 offset:49152
    s_waitcnt lgkmcnt(3)
    v_mfma_f32_16x16x32_bf16 v[100:103], v[44:47], v[188:191], v[100:103]
    v_xor_b32 v27, 128, v26
    v_bfe_u32 v32, v0, 2, 2
    ds_read_b64_tr_b16 v[62:63], v7 offset:49664
    v_mfma_f32_16x16x32_bf16 v[16:19], v[8:11], v[40:43], v[16:19]
    v_lshl_add_u32 v33, v33, 3, v32
    v_bfe_u32 v32, v0, 4, 1
    v_mfma_f32_16x16x32_bf16 v[112:115], v[48:51], v[176:179], v[112:115]
    v_lshlrev_b32 v33, 5, v33
    v_lshrrev_b32 v29, 4, v0
    ds_read_b64_tr_b16 v[40:41], v5 offset:57344
    v_mfma_f32_16x16x32_bf16 v[112:115], v[52:55], v[184:187], v[112:115]
    ds_read_b64_tr_b16 v[42:43], v5 offset:57856
    s_add_u32 m0, s38, 90112
    s_mov_b32 s39, 1181696
    buffer_load_dwordx4 v1, s[8:11], s39 offen lds
    v_mfma_f32_16x16x32_bf16 v[116:119], v[48:51], v[180:183], v[116:119]
    v_lshl_add_u32 v33, v32, 4, v33
    v_bfe_u32 v32, v0, 1, 1
    ds_read_b64_tr_b16 v[44:45], v7 offset:57344
    v_mfma_f32_16x16x32_bf16 v[116:119], v[52:55], v[188:191], v[116:119]
    v_lshl_add_u32 v33, v32, 3, v33
    v_xor_b32 v32, s33, v0
    ds_read_b64_tr_b16 v[46:47], v7 offset:57856
    v_mfma_f32_16x16x32_bf16 v[16:19], v[12:15], v[48:51], v[16:19]
    v_and_b32 v32, 1, v32
    v_mul_u32_u24 v35, 112, v24
    s_waitcnt lgkmcnt(4)
    v_mfma_f32_16x16x32_bf16 v[88:91], v[72:75], v[176:179], v[88:91]
    v_lshl_add_u32 v33, v32, 9, v33
    v_lshl_add_u32 v35, v29, 3, v35
    v_mfma_f32_16x16x32_bf16 v[88:91], v[72:75], v[184:187], v[88:91]
    s_waitcnt vmcnt(8)
    s_waitcnt lgkmcnt(0)
    s_barrier
    v_add_u32 v66, 0xffff0000, v66
    v_add_u32 v67, 0xffff0000, v67
    v_add_u32 v68, 0xffff0000, v68
    v_add_u32 v69, 0xffff0000, v69
    v_add_u32 v4, 0xffff0000, v4
    v_add_u32 v5, 0xffff0000, v5
    v_add_u32 v6, 0xffff0000, v6
    v_add_u32 v7, 0xffff0000, v7
    ds_read_b64_tr_b16 v[48:49], v4 offset:16384
    v_mfma_f32_16x16x32_bf16 v[104:107], v[56:59], v[176:179], v[104:107]
    v_add_u32 v33, s70, v33
    v_xor_b32 v25, s33, v25
    ds_read_b64_tr_b16 v[50:51], v4 offset:16896
    ds_read_b128 v[192:195], v66 offset:0
    v_mfma_f32_16x16x32_bf16 v[104:107], v[60:63], v[184:187], v[104:107]
    ds_read_b64_tr_b16 v[52:53], v6 offset:16384
    s_add_u32 m0, s38, 98304
    s_mov_b32 s39, 896
    buffer_load_dwordx4 v64, s[4:7], s39 offen lds
    v_mfma_f32_16x16x32_bf16 v[108:111], v[56:59], v[180:183], v[108:111]
    v_and_b32 v25, 1, v25
    v_mul_u32_u24 v37, 112, v28
    ds_read_b64_tr_b16 v[54:55], v6 offset:16896
    ds_read_b128 v[200:203], v67 offset:0
    v_mfma_f32_16x16x32_bf16 v[108:111], v[60:63], v[188:191], v[108:111]
    v_mul_u32_u24 v25, 14336, v25
    v_lshrrev_b32 v39, 2, v0
    v_mfma_f32_16x16x32_bf16 v[92:95], v[176:179], v[176:179], v[92:95]
    v_add_u32 v37, v37, v25
    v_mul_u32_u24 v39, 224, v39
    ds_read_b64_tr_b16 v[56:57], v4 offset:24576
    v_mfma_f32_16x16x32_bf16 v[92:95], v[184:187], v[184:187], v[92:95]
    ds_read_b64_tr_b16 v[58:59], v4 offset:25088
    s_add_u32 m0, s38, 114688
    s_mov_b32 s39, 1377280
    buffer_load_dwordx4 v1, s[8:11], s39 offen lds
    v_mfma_f32_16x16x32_bf16 v[120:123], v[40:43], v[176:179], v[120:123]
    v_and_b32 v25, 3, v0
    v_lshlrev_b32 v29, 9, v29
    ds_read_b64_tr_b16 v[60:61], v6 offset:24576
    ds_read_b128 v[196:199], v68 offset:0
    v_mfma_f32_16x16x32_bf16 v[120:123], v[44:47], v[184:187], v[120:123]
    v_lshl_add_u32 v39, v25, 3, v39
    v_lshl_add_u32 v31, v24, 2, v29
    ds_read_b64_tr_b16 v[62:63], v6 offset:25088
    v_mfma_f32_16x16x32_bf16 v[124:127], v[40:43], v[180:183], v[124:127]
    ds_read_b128 v[204:207], v69 offset:0
    v_mfma_f32_16x16x32_bf16 v[124:127], v[44:47], v[188:191], v[124:127]
    s_waitcnt lgkmcnt(7)
    v_mfma_f32_16x16x32_bf16 v[96:99], v[48:51], v[192:195], v[96:99]
    ds_read_b64_tr_b16 v[40:41], v5 offset:16384
    s_waitcnt lgkmcnt(7)
    v_mfma_f32_16x16x32_bf16 v[96:99], v[52:55], v[200:203], v[96:99]
    ds_read_b64_tr_b16 v[42:43], v5 offset:16896
    s_add_u32 m0, s38, 106496
    s_mov_b32 s39, 66432
    buffer_load_dwordx4 v64, s[4:7], s39 offen lds
    s_waitcnt lgkmcnt(4)
    v_mfma_f32_16x16x32_bf16 v[100:103], v[48:51], v[196:199], v[100:103]
    ds_read_b64_tr_b16 v[44:45], v7 offset:16384
    s_waitcnt lgkmcnt(3)
    v_mfma_f32_16x16x32_bf16 v[100:103], v[52:55], v[204:207], v[100:103]
    ds_read_b64_tr_b16 v[46:47], v7 offset:16896
    v_mfma_f32_16x16x32_bf16 v[16:19], v[8:11], v[48:51], v[16:19]
    v_mfma_f32_16x16x32_bf16 v[112:115], v[56:59], v[192:195], v[112:115]
    ds_read_b64_tr_b16 v[48:49], v5 offset:24576
    v_mfma_f32_16x16x32_bf16 v[112:115], v[60:63], v[200:203], v[112:115]
    ds_read_b64_tr_b16 v[50:51], v5 offset:25088
    s_add_u32 m0, s38, 122880
    s_mov_b32 s39, 1378304
    buffer_load_dwordx4 v1, s[8:11], s39 offen lds
    v_mfma_f32_16x16x32_bf16 v[116:119], v[56:59], v[196:199], v[116:119]
    ds_read_b64_tr_b16 v[52:53], v7 offset:24576
    v_mfma_f32_16x16x32_bf16 v[116:119], v[60:63], v[204:207], v[116:119]
    ds_read_b64_tr_b16 v[54:55], v7 offset:25088
    v_mfma_f32_16x16x32_bf16 v[16:19], v[12:15], v[56:59], v[16:19]
    s_waitcnt lgkmcnt(4)
    v_mfma_f32_16x16x32_bf16 v[88:91], v[72:75], v[192:195], v[88:91]
    v_mfma_f32_16x16x32_bf16 v[88:91], v[72:75], v[200:203], v[88:91]
    s_waitcnt vmcnt(8)
    s_waitcnt lgkmcnt(0)
    s_barrier
    v_lshrrev_b32 v25, 2, v0
    s_lshl_b32 s70, s32, 4
    v_add_u32 v25, s70, v25
    v_lshrrev_b32 v28, 5, v0
    v_lshlrev_b32 v28, 1, v28
    v_and_b32 v29, 3, v0
    v_xor_b32 v28, v28, v29
    s_lshl_b32 s70, s36, 6
    s_add_u32 s70, s70, 3072
    v_lshl_add_u32 v28, v28, 4, s70
    s_movk_i32 s70, 3584
    v_mad_u32_u24 v1, v25, s70, v28
    ds_read_b64_tr_b16 v[56:57], v4 offset:49152
    v_mfma_f32_16x16x32_bf16 v[104:107], v[40:43], v[192:195], v[104:107]
    ds_read_b64_tr_b16 v[58:59], v4 offset:49664
    ds_read_b128 v[208:211], v66 offset:32768
    v_mfma_f32_16x16x32_bf16 v[104:107], v[44:47], v[200:203], v[104:107]
    ds_read_b64_tr_b16 v[60:61], v6 offset:49152
    s_add_u32 m0, s38, 0
    s_nop 0
    buffer_load_dwordx4 v2, s[12:15], 0 offen lds
    v_mfma_f32_16x16x32_bf16 v[108:111], v[40:43], v[196:199], v[108:111]
    ds_read_b64_tr_b16 v[62:63], v6 offset:49664
    ds_read_b128 v[216:219], v67 offset:32768
    v_mfma_f32_16x16x32_bf16 v[108:111], v[44:47], v[204:207], v[108:111]
    v_mfma_f32_16x16x32_bf16 v[92:95], v[192:195], v[192:195], v[92:95]
    ds_read_b64_tr_b16 v[40:41], v4 offset:57344
    v_mfma_f32_16x16x32_bf16 v[92:95], v[200:203], v[200:203], v[92:95]
    ds_read_b64_tr_b16 v[42:43], v4 offset:57856
    s_add_u32 m0, s38, 8192
    s_nop 0
    buffer_load_dwordx4 v2, s[16:19], 0 offen lds
    v_mfma_f32_16x16x32_bf16 v[120:123], v[48:51], v[192:195], v[120:123]
    ds_read_b64_tr_b16 v[44:45], v6 offset:57344
    ds_read_b128 v[212:215], v68 offset:32768
    v_mfma_f32_16x16x32_bf16 v[120:123], v[52:55], v[200:203], v[120:123]
    ds_read_b64_tr_b16 v[46:47], v6 offset:57856
    v_mfma_f32_16x16x32_bf16 v[124:127], v[48:51], v[196:199], v[124:127]
    ds_read_b128 v[220:223], v69 offset:32768
    v_mfma_f32_16x16x32_bf16 v[124:127], v[52:55], v[204:207], v[124:127]
    s_waitcnt lgkmcnt(7)
    v_mfma_f32_16x16x32_bf16 v[96:99], v[56:59], v[208:211], v[96:99]
    ds_read_b64_tr_b16 v[48:49], v5 offset:49152
    s_waitcnt lgkmcnt(7)
    v_mfma_f32_16x16x32_bf16 v[96:99], v[60:63], v[216:219], v[96:99]
    ds_read_b64_tr_b16 v[50:51], v5 offset:49664
    s_add_u32 m0, s38, 16384
    s_mov_b32 s39, 229376
    buffer_load_dwordx4 v2, s[12:15], s39 offen lds
    s_waitcnt lgkmcnt(4)
    v_mfma_f32_16x16x32_bf16 v[100:103], v[56:59], v[212:215], v[100:103]
    ds_read_b64_tr_b16 v[52:53], v7 offset:49152
    s_waitcnt lgkmcnt(3)
    v_mfma_f32_16x16x32_bf16 v[100:103], v[60:63], v[220:223], v[100:103]
    ds_read_b64_tr_b16 v[54:55], v7 offset:49664
    v_mfma_f32_16x16x32_bf16 v[16:19], v[8:11], v[56:59], v[16:19]
    v_mfma_f32_16x16x32_bf16 v[112:115], v[40:43], v[208:211], v[112:115]
    ds_read_b64_tr_b16 v[56:57], v5 offset:57344
    v_mfma_f32_16x16x32_bf16 v[112:115], v[44:47], v[216:219], v[112:115]
    ds_read_b64_tr_b16 v[58:59], v5 offset:57856
    s_add_u32 m0, s38, 24576
    s_mov_b32 s39, 229376
    buffer_load_dwordx4 v2, s[16:19], s39 offen lds
    v_mfma_f32_16x16x32_bf16 v[116:119], v[40:43], v[212:215], v[116:119]
    ds_read_b64_tr_b16 v[60:61], v7 offset:57344
    v_mfma_f32_16x16x32_bf16 v[116:119], v[44:47], v[220:223], v[116:119]
    ds_read_b64_tr_b16 v[62:63], v7 offset:57856
    v_mfma_f32_16x16x32_bf16 v[16:19], v[12:15], v[40:43], v[16:19]
    s_waitcnt lgkmcnt(4)
    v_mfma_f32_16x16x32_bf16 v[88:91], v[72:75], v[208:211], v[88:91]
    v_mfma_f32_16x16x32_bf16 v[88:91], v[72:75], v[216:219], v[88:91]
    s_waitcnt vmcnt(8)
    s_waitcnt lgkmcnt(0)
    s_barrier
    v_add_u32 v66, 0x10000, v66
    v_add_u32 v67, 0x10000, v67
    v_add_u32 v68, 0x10000, v68
    v_add_u32 v69, 0x10000, v69
    v_lshlrev_b32 v28, 5, v0
    buffer_load_dword v29, v28, s[28:31], 0 offen sc0 sc1
    v_add_u32 v4, 0x10000, v4
    v_add_u32 v5, 0x10000, v5
    v_add_u32 v6, 0x10000, v6
    v_add_u32 v7, 0x10000, v7
    ds_read_b64_tr_b16 v[40:41], v4 offset:16384
    v_mfma_f32_16x16x32_bf16 v[104:107], v[48:51], v[208:211], v[104:107]
    ds_read_b64_tr_b16 v[42:43], v4 offset:16896
    ds_read_b128 v[224:227], v66 offset:0
    v_mfma_f32_16x16x32_bf16 v[104:107], v[52:55], v[216:219], v[104:107]
    ds_read_b64_tr_b16 v[44:45], v6 offset:16384
    s_add_u32 m0, s38, 32768
    s_mov_b32 s39, 458752
    buffer_load_dwordx4 v2, s[12:15], s39 offen lds
    v_mfma_f32_16x16x32_bf16 v[108:111], v[48:51], v[212:215], v[108:111]
    ds_read_b64_tr_b16 v[46:47], v6 offset:16896
    ds_read_b128 v[232:235], v67 offset:0
    v_mfma_f32_16x16x32_bf16 v[108:111], v[52:55], v[220:223], v[108:111]
    v_mfma_f32_16x16x32_bf16 v[92:95], v[208:211], v[208:211], v[92:95]
    ds_read_b64_tr_b16 v[48:49], v4 offset:24576
    v_mfma_f32_16x16x32_bf16 v[92:95], v[216:219], v[216:219], v[92:95]
    ds_read_b64_tr_b16 v[50:51], v4 offset:25088
    s_add_u32 m0, s38, 40960
    s_mov_b32 s39, 458752
    buffer_load_dwordx4 v2, s[16:19], s39 offen lds
    v_mfma_f32_16x16x32_bf16 v[120:123], v[56:59], v[208:211], v[120:123]
    ds_read_b64_tr_b16 v[52:53], v6 offset:24576
    ds_read_b128 v[228:231], v68 offset:0
    v_mfma_f32_16x16x32_bf16 v[120:123], v[60:63], v[216:219], v[120:123]
    ds_read_b64_tr_b16 v[54:55], v6 offset:25088
    v_mfma_f32_16x16x32_bf16 v[124:127], v[56:59], v[212:215], v[124:127]
    ds_read_b128 v[236:239], v69 offset:0
    v_mfma_f32_16x16x32_bf16 v[124:127], v[60:63], v[220:223], v[124:127]
    s_waitcnt lgkmcnt(7)
    v_mfma_f32_16x16x32_bf16 v[96:99], v[40:43], v[224:227], v[96:99]
    ds_read_b64_tr_b16 v[56:57], v5 offset:16384
    s_waitcnt lgkmcnt(7)
    v_mfma_f32_16x16x32_bf16 v[96:99], v[44:47], v[232:235], v[96:99]
    ds_read_b64_tr_b16 v[58:59], v5 offset:16896
    s_add_u32 m0, s38, 49152
    s_mov_b32 s39, 688128
    buffer_load_dwordx4 v2, s[12:15], s39 offen lds
    s_waitcnt lgkmcnt(4)
    v_mfma_f32_16x16x32_bf16 v[100:103], v[40:43], v[228:231], v[100:103]
    ds_read_b64_tr_b16 v[60:61], v7 offset:16384
    s_waitcnt lgkmcnt(3)
    v_mfma_f32_16x16x32_bf16 v[100:103], v[44:47], v[236:239], v[100:103]
    ds_read_b64_tr_b16 v[62:63], v7 offset:16896
    v_mfma_f32_16x16x32_bf16 v[16:19], v[8:11], v[40:43], v[16:19]
    v_mfma_f32_16x16x32_bf16 v[112:115], v[48:51], v[224:227], v[112:115]
    ds_read_b64_tr_b16 v[40:41], v5 offset:24576
    v_mfma_f32_16x16x32_bf16 v[112:115], v[52:55], v[232:235], v[112:115]
    ds_read_b64_tr_b16 v[42:43], v5 offset:25088
    s_add_u32 m0, s38, 57344
    s_mov_b32 s39, 688128
    buffer_load_dwordx4 v2, s[16:19], s39 offen lds
    v_mfma_f32_16x16x32_bf16 v[116:119], v[48:51], v[228:231], v[116:119]
    ds_read_b64_tr_b16 v[44:45], v7 offset:24576
    v_mfma_f32_16x16x32_bf16 v[116:119], v[52:55], v[236:239], v[116:119]
    ds_read_b64_tr_b16 v[46:47], v7 offset:25088
    v_mfma_f32_16x16x32_bf16 v[16:19], v[12:15], v[48:51], v[16:19]
    s_waitcnt lgkmcnt(4)
    v_mfma_f32_16x16x32_bf16 v[88:91], v[72:75], v[224:227], v[88:91]
    v_mfma_f32_16x16x32_bf16 v[88:91], v[72:75], v[232:235], v[88:91]
    s_waitcnt vmcnt(9)
    s_waitcnt lgkmcnt(0)
    s_barrier
    ds_read_b64_tr_b16 v[48:49], v4 offset:49152
    v_mfma_f32_16x16x32_bf16 v[104:107], v[56:59], v[224:227], v[104:107]
    ds_read_b64_tr_b16 v[50:51], v4 offset:49664
    ds_read_b128 v[240:243], v66 offset:32768
    v_mfma_f32_16x16x32_bf16 v[104:107], v[60:63], v[232:235], v[104:107]
    ds_read_b64_tr_b16 v[52:53], v6 offset:49152
    s_add_u32 m0, s38, 65536
    s_mov_b32 s39, 917504
    buffer_load_dwordx4 v2, s[12:15], s39 offen lds
    v_mfma_f32_16x16x32_bf16 v[108:111], v[56:59], v[228:231], v[108:111]
    ds_read_b64_tr_b16 v[54:55], v6 offset:49664
    ds_read_b128 v[248:251], v67 offset:32768
    v_mfma_f32_16x16x32_bf16 v[108:111], v[60:63], v[236:239], v[108:111]
    v_mfma_f32_16x16x32_bf16 v[92:95], v[224:227], v[224:227], v[92:95]
    ds_read_b64_tr_b16 v[56:57], v4 offset:57344
    v_mfma_f32_16x16x32_bf16 v[92:95], v[232:235], v[232:235], v[92:95]
    ds_read_b64_tr_b16 v[58:59], v4 offset:57856
    s_add_u32 m0, s38, 73728
    s_mov_b32 s39, 917504
    buffer_load_dwordx4 v2, s[16:19], s39 offen lds
    v_mfma_f32_16x16x32_bf16 v[120:123], v[40:43], v[224:227], v[120:123]
    ds_read_b64_tr_b16 v[60:61], v6 offset:57344
    ds_read_b128 v[244:247], v68 offset:32768
    v_mfma_f32_16x16x32_bf16 v[120:123], v[44:47], v[232:235], v[120:123]
    ds_read_b64_tr_b16 v[62:63], v6 offset:57856
    v_mfma_f32_16x16x32_bf16 v[124:127], v[40:43], v[228:231], v[124:127]
    ds_read_b128 v[252:255], v69 offset:32768
    v_mfma_f32_16x16x32_bf16 v[124:127], v[44:47], v[236:239], v[124:127]
    s_waitcnt lgkmcnt(7)
    v_mfma_f32_16x16x32_bf16 v[96:99], v[48:51], v[240:243], v[96:99]
    ds_read_b64_tr_b16 v[40:41], v5 offset:49152
    s_waitcnt lgkmcnt(7)
    v_mfma_f32_16x16x32_bf16 v[96:99], v[52:55], v[248:251], v[96:99]
    ds_read_b64_tr_b16 v[42:43], v5 offset:49664
    s_add_u32 m0, s38, 81920
    s_mov_b32 s39, 1146880
    buffer_load_dwordx4 v2, s[12:15], s39 offen lds
    s_waitcnt lgkmcnt(4)
    v_mfma_f32_16x16x32_bf16 v[100:103], v[48:51], v[244:247], v[100:103]
    ds_read_b64_tr_b16 v[44:45], v7 offset:49152
    s_waitcnt lgkmcnt(3)
    v_mfma_f32_16x16x32_bf16 v[100:103], v[52:55], v[252:255], v[100:103]
    ds_read_b64_tr_b16 v[46:47], v7 offset:49664
    v_mfma_f32_16x16x32_bf16 v[16:19], v[8:11], v[48:51], v[16:19]
    v_mfma_f32_16x16x32_bf16 v[112:115], v[56:59], v[240:243], v[112:115]
    ds_read_b64_tr_b16 v[48:49], v5 offset:57344
    v_mfma_f32_16x16x32_bf16 v[112:115], v[60:63], v[248:251], v[112:115]
    ds_read_b64_tr_b16 v[50:51], v5 offset:57856
    s_add_u32 m0, s38, 90112
    s_mov_b32 s39, 1146880
    buffer_load_dwordx4 v2, s[16:19], s39 offen lds
    v_mfma_f32_16x16x32_bf16 v[116:119], v[56:59], v[244:247], v[116:119]
    ds_read_b64_tr_b16 v[52:53], v7 offset:57344
    v_mfma_f32_16x16x32_bf16 v[116:119], v[60:63], v[252:255], v[116:119]
    ds_read_b64_tr_b16 v[54:55], v7 offset:57856
    v_mfma_f32_16x16x32_bf16 v[16:19], v[12:15], v[56:59], v[16:19]
    s_waitcnt lgkmcnt(4)
    v_mfma_f32_16x16x32_bf16 v[88:91], v[72:75], v[240:243], v[88:91]
    v_mfma_f32_16x16x32_bf16 v[88:91], v[72:75], v[248:251], v[88:91]
    s_waitcnt vmcnt(9)
    s_waitcnt lgkmcnt(0)
    s_barrier
    s_waitcnt vmcnt(8)
    v_cmp_eq_u32 vcc, 1, v29
    s_nop 3
    s_cmp_eq_u32 vcc_lo, 0xff
    s_cbranch_scc1 K1_ok_2
    s_mov_b32 s72, 0
K1_poll_1:
    buffer_load_dword v29, v28, s[28:31], 0 offen sc0 sc1
    s_waitcnt vmcnt(0)
    v_cmp_eq_u32 vcc, 1, v29
    s_add_u32 s72, s72, 1
    s_cmp_ge_u32 s72, 0x20000
    s_cbranch_scc1 K1_ok_2
    s_nop 1
    s_cmp_lg_u32 vcc_lo, 0xff
    s_cbranch_scc1 K1_poll_1
K1_ok_2:
    v_lshlrev_b32 v70, 7, v0
    s_lshl_b32 s92, s2, 3
    s_add_u32 s92, s92, s32
    s_mov_b32 m0, 156672
    s_mul_i32 s93, s92, 896
    s_mov_b64 exec, 127
    buffer_load_dword v70, s[40:43], s93 offen lds
    s_mul_i32 s93, s92, 256
    s_mov_b64 exec, 3
    buffer_load_dword v70, s[44:47], s93 offen lds
    s_mov_b64 exec, -1
    v_add_u32 v4, 0xffff0000, v4
    v_add_u32 v5, 0xffff0000, v5
    v_add_u32 v6, 0xffff0000, v6
    v_add_u32 v7, 0xffff0000, v7
    ds_read_b64_tr_b16 v[56:57], v4 offset:0
    v_mfma_f32_16x16x32_bf16 v[104:107], v[40:43], v[240:243], v[104:107]
    ds_read_b64_tr_b16 v[58:59], v4 offset:512
    v_mfma_f32_16x16x32_bf16 v[104:107], v[44:47], v[248:251], v[104:107]
    ds_read_b64_tr_b16 v[60:61], v6 offset:0
    v_mfma_f32_16x16x32_bf16 v[108:111], v[40:43], v[244:247], v[108:111]
    ds_read_b64_tr_b16 v[62:63], v6 offset:512
    v_mfma_f32_16x16x32_bf16 v[108:111], v[44:47], v[252:255], v[108:111]
    v_mfma_f32_16x16x32_bf16 v[92:95], v[240:243], v[240:243], v[92:95]
    ds_read_b64_tr_b16 v[40:41], v4 offset:8192
    v_mfma_f32_16x16x32_bf16 v[92:95], v[248:251], v[248:251], v[92:95]
    ds_read_b64_tr_b16 v[42:43], v4 offset:8704
    v_mfma_f32_16x16x32_bf16 v[120:123], v[48:51], v[240:243], v[120:123]
    ds_read_b64_tr_b16 v[44:45], v6 offset:8192
    v_mfma_f32_16x16x32_bf16 v[120:123], v[52:55], v[248:251], v[120:123]
    ds_read_b64_tr_b16 v[46:47], v6 offset:8704
    v_mfma_f32_16x16x32_bf16 v[124:127], v[48:51], v[244:247], v[124:127]
    v_mfma_f32_16x16x32_bf16 v[124:127], v[52:55], v[252:255], v[124:127]
    v_cvt_pk_bf16_f32 v24, v16, v16
    v_lshlrev_b32 v24, 16, v24
    v_sub_f32 v24, v16, v24
    v_cvt_pk_bf16_f32 v24, v16, v24
    ds_write_b32 v20, v24 offset:0
    v_cndmask_b32 v89, v92, v93, s[76:77]
    v_cndmask_b32 v89, v89, v94, s[78:79]
    v_cndmask_b32 v89, v89, v95, s[80:81]
    ds_write_b64 v21, v[88:89]
    s_waitcnt lgkmcnt(6)
    v_mfma_f32_16x16x32_bf16 v[64:67], v[56:59], v[128:131], 0
    ds_read_b64_tr_b16 v[48:49], v5 offset:0
    v_mfma_f32_16x16x32_bf16 v[64:67], v[60:63], v[136:139], v[64:67]
    ds_read_b64_tr_b16 v[50:51], v5 offset:512
    v_mfma_f32_16x16x32_bf16 v[68:71], v[56:59], v[132:135], 0
    s_waitcnt lgkmcnt(2)
    s_barrier
    ds_read_b64 v[24:25], v22
    ds_read_b64 v[28:29], v23
    ds_read_b32 v32, v26 offset:0
    ds_read_b32 v34, v27 offset:0
    ds_read_b32 v36, v26 offset:256
    ds_read_b32 v38, v27 offset:256
    s_mul_i32 s70, s33, 3584
    ds_read_b64_tr_b16 v[52:53], v7 offset:0
    v_mfma_f32_16x16x32_bf16 v[68:71], v[60:63], v[140:143], v[68:71]
    s_mul_i32 s71, s34, 28672
    s_add_u32 s70, s70, s71
    s_add_u32 s91, s70, 98304
    s_and_b32 s71, s33, 1
    s_mul_i32 s71, s71, 14336
    s_add_u32 s72, s91, s71
    s_sub_u32 s73, s91, s71
    s_add_u32 s73, s73, 14336
    ds_read_b64_tr_b16 v[54:55], v7 offset:512
    v_mfma_f32_16x16x32_bf16 v[16:19], v[8:11], v[56:59], 0
    v_mfma_f32_16x16x32_bf16 v[80:83], v[40:43], v[128:131], 0
    ds_read_b64_tr_b16 v[56:57], v5 offset:8192
    v_mfma_f32_16x16x32_bf16 v[80:83], v[44:47], v[136:139], v[80:83]
    ds_read_b64_tr_b16 v[58:59], v5 offset:8704
    v_mfma_f32_16x16x32_bf16 v[84:87], v[40:43], v[132:135], 0
    s_waitcnt lgkmcnt(9)
    v_mul_f32 v24, 0xbb000000, v24
    v_mul_f32 v25, 0x3b000000, v25
    v_cvt_pk_bf16_f32 v20, v24, v24
    v_fma_f32 v25, -v24, v24, v25
    v_lshlrev_b32 v21, 16, v20
    v_max_f32 v25, 0, v25
    v_sub_f32 v21, v24, v21
    v_add_f32 v26, 0x3727c5ac, v25
    ds_read_b64_tr_b16 v[60:61], v7 offset:8192
    v_mfma_f32_16x16x32_bf16 v[84:87], v[44:47], v[140:143], v[84:87]
    v_rsq_f32 v25, v26
    v_cvt_pk_bf16_f32 v21, v21, v21
    v_mul_f32 v24, 0xc0135761, v25
    v_cndmask_b32 v20, v20, v21, s[82:83]
    v_mov_b32 v21, 0
    v_mul_f32 v25, v25, v25
    s_waitcnt lgkmcnt(9)
    v_mul_f32 v28, 0xbb000000, v28
    s_waitcnt lgkmcnt(8)
    v_mfma_f32_16x16x16_bf16 v[96:99], v[32:33], v[20:21], v[96:99]
    v_mul_f32 v25, 0x3d372713, v25
    v_mul_f32 v29, 0x3b000000, v29
    v_mul_f32 v25, v25, v24
    v_fma_f32 v29, -v28, v28, v29
    v_cvt_pk_bf16_f32 v22, v28, v28
    v_max_f32 v29, 0, v29
    v_lshlrev_b32 v23, 16, v22
    v_add_f32 v29, 0x3727c5ac, v29
    s_waitcnt lgkmcnt(7)
    v_mfma_f32_16x16x16_bf16 v[104:107], v[34:35], v[20:21], v[104:107]
    v_sub_f32 v23, v28, v23
    v_rsq_f32 v27, v29
    v_cvt_pk_bf16_f32 v23, v23, v23
    v_mul_f32 v28, v27, v27
    v_cndmask_b32 v22, v22, v23, s[82:83]
    v_mov_b32 v23, 0
    v_mul_f32 v27, 0xc0135761, v27
    s_nop 0
    v_mfma_f32_16x16x16_bf16 v[100:103], v[32:33], v[22:23], v[100:103]
    v_mul_f32 v28, 0x3d372713, v28
    v_mfma_f32_16x16x16_bf16 v[108:111], v[34:35], v[22:23], v[108:111]
    v_mul_f32 v28, v28, v27
    s_waitcnt lgkmcnt(6)
    v_mfma_f32_16x16x16_bf16 v[116:119], v[36:37], v[22:23], v[116:119]
    s_waitcnt lgkmcnt(5)
    v_mfma_f32_16x16x16_bf16 v[120:123], v[38:39], v[20:21], v[120:123]
    v_mfma_f32_16x16x16_bf16 v[124:127], v[38:39], v[22:23], v[124:127]
    v_cvt_pk_bf16_f32 v96, v96, v97
    v_cvt_pk_bf16_f32 v97, v98, v99
    v_cvt_pk_bf16_f32 v98, v100, v101
    v_cvt_pk_bf16_f32 v99, v102, v103
    ds_read_b64_tr_b16 v[100:101], v33
    ds_read_b64_tr_b16 v[102:103], v33 offset:128
    v_cvt_pk_bf16_f32 v104, v104, v105
    v_cvt_pk_bf16_f32 v105, v106, v107
    v_cvt_pk_bf16_f32 v106, v108, v109
    v_mfma_f32_16x16x16_bf16 v[112:115], v[36:37], v[20:21], v[112:115]
    v_cvt_pk_bf16_f32 v107, v110, v111
    v_permlane16_swap_b32 v96, v98
    v_permlane16_swap_b32 v97, v99
    v_permlane16_swap_b32 v104, v106
    v_permlane16_swap_b32 v105, v107
    v_add_u32 v38, s73, v35
    v_add_u32 v35, s72, v35
    v_mul_f32 v116, v116, v27
    s_mul_i32 s71, s33, 14336
    ds_read_b64_tr_b16 v[62:63], v7 offset:8704
    v_mfma_f32_16x16x32_bf16 v[16:19], v[12:15], v[40:43], v[16:19]
    v_mul_f32 v117, v117, v27
    v_mul_f32 v118, v118, v27
    v_mul_f32 v119, v119, v27
    v_cvt_pk_bf16_f32 v116, v116, v117
    v_cvt_pk_bf16_f32 v117, v118, v119
    v_mul_f32 v120, v120, v24
    ds_write_b64 v35, v[116:117] offset:1856
    v_mul_f32 v121, v121, v24
    v_mul_f32 v122, v122, v24
    s_waitcnt lgkmcnt(7)
    v_mfma_f32_16x16x32_bf16 v[72:75], v[48:51], v[128:131], 0
    v_mul_f32 v112, v112, v24
    v_mul_f32 v113, v113, v24
    v_mul_f32 v114, v114, v24
    v_mul_f32 v115, v115, v24
    v_cvt_pk_bf16_f32 v112, v112, v113
    v_cvt_pk_bf16_f32 v113, v114, v115
    v_mul_f32 v123, v123, v24
    ds_write_b64 v35, v[112:113] offset:64
    v_cvt_pk_bf16_f32 v120, v120, v121
    ds_read_b64_tr_b16 v[40:41], v4 offset:16384
    v_mfma_f32_16x16x32_bf16 v[72:75], v[52:55], v[136:139], v[72:75]
    v_cvt_pk_bf16_f32 v121, v122, v123
    v_mul_f32 v124, v124, v27
    ds_write_b64 v38, v[120:121] offset:64
    v_mul_f32 v125, v125, v27
    v_mul_f32 v126, v126, v27
    v_mul_f32 v127, v127, v27
    v_cvt_pk_bf16_f32 v124, v124, v125
    v_cvt_pk_bf16_f32 v125, v126, v127
    v_add_u32 v37, s91, v37
    ds_read_b64_tr_b16 v[42:43], v4 offset:16896
    v_mfma_f32_16x16x32_bf16 v[76:79], v[48:51], v[132:135], 0
    s_waitcnt lgkmcnt(7)
    v_cndmask_b32 v108, 0, v100, s[88:89]
    v_cndmask_b32 v109, 0, v101, s[88:89]
    s_waitcnt lgkmcnt(6)
    v_cndmask_b32 v110, 0, v102, s[88:89]
    v_cndmask_b32 v111, 0, v103, s[88:89]
    v_cndmask_b32 v100, 0, v100, s[86:87]
    v_cndmask_b32 v101, 0, v101, s[86:87]
    v_cndmask_b32 v102, 0, v102, s[86:87]
    ds_read_b64_tr_b16 v[44:45], v6 offset:16384
    v_mfma_f32_16x16x32_bf16 v[76:79], v[52:55], v[140:143], v[76:79]
    v_cndmask_b32 v103, 0, v103, s[86:87]
    ds_write_b64 v38, v[124:125] offset:1856
    s_add_u32 s71, s71, 98304
    v_add_u32 v39, s71, v39
    v_cndmask_b32 v36, v24, v27, s[84:85]
    v_lshl_add_u32 v33, s34, 5, v39
    v_mul_f32 v36, 0xbf206c99, v36
    s_lshl_b32 s70, s36, 12
    v_mfma_f32_32x32x16_bf16 v[112:127], v[108:111], v[104:107], 0
    s_add_u32 s70, s70, s68
    v_mfma_f32_32x32x16_bf16 v[112:127], v[100:103], v[96:99], v[112:127]
    v_mov_b32 v108, -1
    v_mov_b32 v109, -1
    v_mov_b32 v110, -1
    v_mov_b32 v111, -1
    s_lshl_b32 s71, s34, 10
    buffer_store_dwordx4 v[108:111], v3, s[20:23], s70 offen sc0 sc1
    s_lshl_b32 s70, s36, 12
    s_add_u32 s70, s70, s69
    ds_read_b64_tr_b16 v[46:47], v6 offset:16896
    s_waitcnt lgkmcnt(8)
    v_mfma_f32_16x16x32_bf16 v[88:91], v[56:59], v[128:131], 0
    ds_read_b64_tr_b16 v[48:49], v4 offset:24576
    v_mfma_f32_16x16x32_bf16 v[88:91], v[60:63], v[136:139], v[88:91]
    ds_read_b64_tr_b16 v[50:51], v4 offset:25088
    v_mfma_f32_16x16x32_bf16 v[92:95], v[56:59], v[132:135], 0
    v_max3_f32 v32, v112, v113, v114
    v_min3_f32 v34, v112, v113, v114
    v_max3_f32 v32, v32, v115, v116
    v_min3_f32 v34, v34, v115, v116
    v_max3_f32 v32, v32, v117, v118
    v_min3_f32 v34, v34, v117, v118
    v_max3_f32 v32, v32, v119, v120
    v_min3_f32 v34, v34, v119, v120
    ds_read_b64_tr_b16 v[52:53], v6 offset:24576
    v_mfma_f32_16x16x32_bf16 v[92:95], v[60:63], v[140:143], v[92:95]
    v_max3_f32 v32, v32, v121, v122
    v_min3_f32 v34, v34, v121, v122
    v_max3_f32 v32, v32, v123, v124
    v_min3_f32 v34, v34, v123, v124
    v_max3_f32 v32, v32, v125, v126
    v_min3_f32 v34, v34, v125, v126
    v_max_f32 v32, v32, v127
    v_min_f32 v34, v34, v127
    ds_read_b64_tr_b16 v[54:55], v6 offset:25088
    s_waitcnt lgkmcnt(4)
    v_mfma_f32_16x16x32_bf16 v[64:67], v[40:43], v[144:147], v[64:67]
    v_mul_f32 v32, v32, v36
    v_mul_f32 v34, v34, v36
    v_fma_f32 v96, v112, v36, -v32
    v_fma_f32 v112, -v112, v36, v34
    v_fma_f32 v97, v113, v36, -v32
    v_fma_f32 v113, -v113, v36, v34
    v_exp_f32 v96, v96
    buffer_store_dwordx4 v[108:111], v3, s[20:23], s70 offen sc0 sc1
    s_min_u32 s70, s68, s69
    ds_read_b64_tr_b16 v[56:57], v5 offset:16384
    v_mfma_f32_16x16x32_bf16 v[64:67], v[44:47], v[152:155], v[64:67]
    v_exp_f32 v112, v112
    v_exp_f32 v97, v97
    v_exp_f32 v113, v113
    v_fma_f32 v98, v114, v36, -v32
    v_fma_f32 v114, -v114, v36, v34
    s_sub_u32 s70, s70, s71
    s_lshl_b32 s71, s36, 11
    s_add_u32 s70, s70, s71
    s_add_u32 s70, s70, 98304
    ds_read_b64_tr_b16 v[58:59], v5 offset:16896
    v_mfma_f32_16x16x32_bf16 v[68:71], v[40:43], v[148:151], v[68:71]
    v_fma_f32 v99, v115, v36, -v32
    v_fma_f32 v115, -v115, v36, v34
    v_exp_f32 v98, v98
    v_exp_f32 v114, v114
    v_exp_f32 v99, v99
    ds_read_b64_tr_b16 v[60:61], v7 offset:16384
    v_mfma_f32_16x16x32_bf16 v[68:71], v[44:47], v[156:159], v[68:71]
    v_exp_f32 v115, v115
    v_fma_f32 v100, v116, v36, -v32
    v_fma_f32 v116, -v116, v36, v34
    v_fma_f32 v101, v117, v36, -v32
    v_fma_f32 v117, -v117, v36, v34
    v_exp_f32 v100, v100
    ds_read_b64_tr_b16 v[62:63], v7 offset:16896
    v_mfma_f32_16x16x32_bf16 v[16:19], v[8:11], v[40:43], v[16:19]
    v_exp_f32 v116, v116
    v_exp_f32 v101, v101
    v_exp_f32 v117, v117
    v_fma_f32 v102, v118, v36, -v32
    v_fma_f32 v118, -v118, v36, v34
    buffer_store_dwordx4 v[108:111], v3, s[20:23], s70 offen sc0 sc1
    s_waitcnt lgkmcnt(4)
    v_mfma_f32_16x16x32_bf16 v[80:83], v[48:51], v[144:147], v[80:83]
    v_fma_f32 v103, v119, v36, -v32
    v_fma_f32 v119, -v119, v36, v34
    v_exp_f32 v102, v102
    v_exp_f32 v118, v118
    v_exp_f32 v103, v103
    ds_read_b64_tr_b16 v[40:41], v5 offset:24576
    v_mfma_f32_16x16x32_bf16 v[80:83], v[52:55], v[152:155], v[80:83]
    v_exp_f32 v119, v119
    v_fma_f32 v104, v120, v36, -v32
    v_fma_f32 v120, -v120, v36, v34
    v_fma_f32 v105, v121, v36, -v32
    v_fma_f32 v121, -v121, v36, v34
    v_exp_f32 v104, v104
    ds_read_b64_tr_b16 v[42:43], v5 offset:25088
    v_mfma_f32_16x16x32_bf16 v[84:87], v[48:51], v[148:151], v[84:87]
    v_exp_f32 v120, v120
    v_exp_f32 v105, v105
    v_exp_f32 v121, v121
    v_fma_f32 v106, v122, v36, -v32
    v_fma_f32 v122, -v122, v36, v34
    ds_read_b64_tr_b16 v[44:45], v7 offset:24576
    v_mfma_f32_16x16x32_bf16 v[84:87], v[52:55], v[156:159], v[84:87]
    v_fma_f32 v107, v123, v36, -v32
    v_fma_f32 v123, -v123, v36, v34
    v_exp_f32 v106, v106
    v_exp_f32 v122, v122
    v_exp_f32 v107, v107
    ds_read_b64_tr_b16 v[46:47], v7 offset:25088
    v_mfma_f32_16x16x32_bf16 v[16:19], v[12:15], v[48:51], v[16:19]
    v_exp_f32 v123, v123
    v_fma_f32 v108, v124, v36, -v32
    v_fma_f32 v124, -v124, v36, v34
    v_fma_f32 v109, v125, v36, -v32
    v_fma_f32 v125, -v125, v36, v34
    v_exp_f32 v108, v108
    s_waitcnt lgkmcnt(4)
    v_mfma_f32_16x16x32_bf16 v[72:75], v[56:59], v[144:147], v[72:75]
    v_exp_f32 v124, v124
    v_exp_f32 v109, v109
    v_exp_f32 v125, v125
    v_fma_f32 v110, v126, v36, -v32
    v_fma_f32 v126, -v126, v36, v34
    v_mfma_f32_16x16x32_bf16 v[72:75], v[60:63], v[152:155], v[72:75]
    v_fma_f32 v111, v127, v36, -v32
    v_fma_f32 v127, -v127, v36, v34
    v_exp_f32 v110, v110
    v_exp_f32 v126, v126
    v_exp_f32 v111, v111
    s_waitcnt vmcnt(9)
    s_waitcnt lgkmcnt(0)
    s_barrier
    ds_read_b64_tr_b16 v[48:49], v4 offset:32768
    ds_read_b64_tr_b16 v[50:51], v4 offset:33280
    v_mfma_f32_16x16x32_bf16 v[76:79], v[56:59], v[148:151], v[76:79]
    v_exp_f32 v127, v127
    v_add_f32 v38, v96, v97
    v_add_f32 v35, v112, v113
    v_add_f32 v38, v38, v98
    v_add_f32 v35, v35, v114
    v_add_f32 v38, v38, v99
    v_add_f32 v35, v35, v115
    ds_read_b64_tr_b16 v[52:53], v6 offset:32768
    ds_read_b64_tr_b16 v[54:55], v6 offset:33280
    v_mfma_f32_16x16x32_bf16 v[76:79], v[60:63], v[156:159], v[76:79]
    v_add_f32 v38, v38, v100
    v_add_f32 v35, v35, v116
    v_add_f32 v38, v38, v101
    v_add_f32 v35, v35, v117
    v_add_f32 v38, v38, v102
    v_add_f32 v35, v35, v118
    v_add_f32 v38, v38, v103
    v_add_f32 v35, v35, v119
    v_mfma_f32_16x16x32_bf16 v[88:91], v[40:43], v[144:147], v[88:91]
    v_add_f32 v38, v38, v104
    v_add_f32 v35, v35, v120
    v_add_f32 v38, v38, v105
    v_add_f32 v35, v35, v121
    v_add_f32 v38, v38, v106
    v_add_f32 v35, v35, v122
    v_add_f32 v38, v38, v107
    v_add_f32 v35, v35, v123
    ds_read_b64_tr_b16 v[56:57], v4 offset:40960
    s_add_u32 m0, s38, 0
    v_mfma_f32_16x16x32_bf16 v[88:91], v[44:47], v[152:155], v[88:91]
    v_add_f32 v38, v38, v108
    v_add_f32 v35, v35, v124
    v_add_f32 v38, v38, v109
    v_add_f32 v35, v35, v125
    v_add_f32 v38, v38, v110
    v_add_f32 v35, v35, v126
    v_add_f32 v38, v38, v111
    v_add_f32 v35, v35, v127
    ds_read_b64_tr_b16 v[58:59], v4 offset:41472
    s_mov_b32 s39, 1376256
    v_mfma_f32_16x16x32_bf16 v[92:95], v[40:43], v[148:151], v[92:95]
    v_rcp_f32 v38, v38
    v_rcp_f32 v35, v35
    v_mul_f32 v96, v96, v38
    v_mul_f32 v97, v97, v38
    v_mul_f32 v98, v98, v38
    v_mul_f32 v99, v99, v38
    ds_read_b64_tr_b16 v[60:61], v6 offset:40960
    buffer_load_dwordx4 v2, s[12:15], s39 offen lds
    v_mfma_f32_16x16x32_bf16 v[92:95], v[44:47], v[156:159], v[92:95]
    v_mul_f32 v100, v100, v38
    v_mul_f32 v101, v101, v38
    v_mul_f32 v102, v102, v38
    v_mul_f32 v103, v103, v38
    v_cvt_pk_bf16_f32 v96, v96, v97
    v_cvt_pk_bf16_f32 v97, v98, v99
    v_cvt_pk_bf16_f32 v98, v100, v101
    v_cvt_pk_bf16_f32 v99, v102, v103
    ds_read_b64_tr_b16 v[62:63], v6 offset:41472
    s_waitcnt lgkmcnt(4)
    v_mfma_f32_16x16x32_bf16 v[64:67], v[48:51], v[160:163], v[64:67]
    ds_write_b128 v37, v[96:99] offset:0
    v_mul_f32 v104, v104, v38
    v_mul_f32 v105, v105, v38
    v_mul_f32 v106, v106, v38
    v_mul_f32 v107, v107, v38
    v_mul_f32 v108, v108, v38
    v_mul_f32 v109, v109, v38
    v_mul_f32 v110, v110, v38
    ds_read_b64_tr_b16 v[40:41], v5 offset:32768
    s_add_u32 m0, s38, 8192
    v_mfma_f32_16x16x32_bf16 v[64:67], v[52:55], v[168:171], v[64:67]
    v_mul_f32 v111, v111, v38
    v_cvt_pk_bf16_f32 v100, v104, v105
    v_cvt_pk_bf16_f32 v101, v106, v107
    v_cvt_pk_bf16_f32 v102, v108, v109
    v_cvt_pk_bf16_f32 v103, v110, v111
    v_mul_f32 v112, v112, v35
    ds_write_b128 v37, v[100:103] offset:16
    v_mul_f32 v113, v113, v35
    ds_read_b64_tr_b16 v[42:43], v5 offset:33280
    s_mov_b32 s39, 1376256
    v_mfma_f32_16x16x32_bf16 v[68:71], v[48:51], v[164:167], v[68:71]
    v_mul_f32 v114, v114, v35
    v_mul_f32 v115, v115, v35
    v_mul_f32 v116, v116, v35
    v_mul_f32 v117, v117, v35
    v_mul_f32 v118, v118, v35
    v_mul_f32 v119, v119, v35
    v_cvt_pk_bf16_f32 v112, v112, v113
    v_cvt_pk_bf16_f32 v113, v114, v115
    ds_read_b64_tr_b16 v[44:45], v7 offset:32768
    buffer_load_dwordx4 v2, s[16:19], s39 offen lds
    v_mfma_f32_16x16x32_bf16 v[68:71], v[52:55], v[172:175], v[68:71]
    v_cvt_pk_bf16_f32 v114, v116, v117
    v_cvt_pk_bf16_f32 v115, v118, v119
    v_mul_f32 v120, v120, v35
    ds_write_b128 v37, v[112:115] offset:32
    v_mul_f32 v121, v121, v35
    v_mul_f32 v122, v122, v35
    v_mul_f32 v123, v123, v35
    v_mul_f32 v124, v124, v35
    v_mul_f32 v125, v125, v35
    ds_read_b64_tr_b16 v[46:47], v7 offset:33280
    v_mfma_f32_16x16x32_bf16 v[16:19], v[8:11], v[48:51], v[16:19]
    v_mul_f32 v126, v126, v35
    v_mul_f32 v127, v127, v35
    v_cvt_pk_bf16_f32 v116, v120, v121
    v_cvt_pk_bf16_f32 v117, v122, v123
    v_cvt_pk_bf16_f32 v118, v124, v125
    v_cvt_pk_bf16_f32 v119, v126, v127
    s_lshl_b32 s71, s34, 6
    ds_write_b128 v37, v[116:119] offset:48
    s_add_u32 s71, s71, s90
    s_waitcnt lgkmcnt(8)
    v_mfma_f32_16x16x32_bf16 v[80:83], v[56:59], v[160:163], v[80:83]
    s_lshl_b32 s70, s33, 11
    s_add_u32 s91, s70, s71
    s_lshl_b32 s70, s33, 7
    s_add_u32 s73, s70, s71
    s_add_u32 s73, s73, 8192
    ds_read_b64_tr_b16 v[48:49], v5 offset:40960
    s_add_u32 m0, s38, 16384
    v_mfma_f32_16x16x32_bf16 v[80:83], v[60:63], v[168:171], v[80:83]
    ds_read_b64_tr_b16 v[50:51], v5 offset:41472
    s_mov_b32 s39, 1605632
    v_mfma_f32_16x16x32_bf16 v[84:87], v[56:59], v[164:167], v[84:87]
    s_waitcnt lgkmcnt(2)
    s_barrier
    ds_read_b64_tr_b16 v[96:97], v39 offset:64
    ds_read_b64_tr_b16 v[100:101], v33 offset:0
    ds_read_b64_tr_b16 v[98:99], v39 offset:176
    ds_read_b64_tr_b16 v[102:103], v33 offset:112
    ds_read_b64_tr_b16 v[104:105], v39 offset:3648
    ds_read_b64_tr_b16 v[108:109], v33 offset:3584
    ds_read_b64_tr_b16 v[52:53], v7 offset:40960
    buffer_load_dwordx4 v2, s[12:15], s39 offen lds
    v_mfma_f32_16x16x32_bf16 v[84:87], v[60:63], v[172:175], v[84:87]
    ds_read_b64_tr_b16 v[106:107], v39 offset:3760
    ds_read_b64_tr_b16 v[110:111], v33 offset:3696
    ds_read_b64_tr_b16 v[112:113], v39 offset:7232
    ds_read_b64_tr_b16 v[116:117], v33 offset:7168
    ds_read_b64_tr_b16 v[114:115], v39 offset:7344
    ds_read_b64_tr_b16 v[118:119], v33 offset:7280
    ds_read_b64_tr_b16 v[120:121], v39 offset:10816
    ds_read_b64_tr_b16 v[124:125], v33 offset:10752
    ds_read_b64_tr_b16 v[122:123], v39 offset:10928
    ds_read_b64_tr_b16 v[54:55], v7 offset:41472
    v_mfma_f32_16x16x32_bf16 v[16:19], v[12:15], v[56:59], v[16:19]
    ds_read_b64_tr_b16 v[126:127], v33 offset:10864
    v_mfma_f32_16x16x32_bf16 v[72:75], v[40:43], v[160:163], v[72:75]
    ds_read_b64_tr_b16 v[56:57], v4 offset:49152
    s_add_u32 m0, s38, 24576
    v_mfma_f32_16x16x32_bf16 v[72:75], v[44:47], v[168:171], v[72:75]
    ds_read_b64_tr_b16 v[58:59], v4 offset:49664
    s_mov_b32 s39, 1605632
    v_mfma_f32_16x16x32_bf16 v[76:79], v[40:43], v[164:167], v[76:79]
    s_waitcnt lgkmcnt(15)
    v_mfma_f32_16x16x32_bf16 v[36:39], v[8:11], v[100:103], 0
    s_waitcnt lgkmcnt(11)
    v_mfma_f32_16x16x32_bf16 v[36:39], v[8:11], v[108:111], v[36:39]
    s_waitcnt lgkmcnt(7)
    v_mfma_f32_16x16x32_bf16 v[36:39], v[8:11], v[116:119], v[36:39]
    s_waitcnt lgkmcnt(2)
    v_mfma_f32_16x16x32_bf16 v[36:39], v[8:11], v[124:127], v[36:39]
    v_mfma_f32_16x16x32_bf16 v[32:35], v[96:99], v[100:103], 0
    v_mfma_f32_16x16x32_bf16 v[32:35], v[104:107], v[108:111], v[32:35]
    s_nop 5
    v_mul_f32 v36, 0xc0135761, v36
    v_mfma_f32_16x16x32_bf16 v[32:35], v[112:115], v[116:119], v[32:35]
    v_mfma_f32_16x16x32_bf16 v[32:35], v[120:123], v[124:127], v[32:35]
    ds_read_b64_tr_b16 v[60:61], v6 offset:49152
    buffer_load_dwordx4 v2, s[16:19], s39 offen lds
    v_mfma_f32_16x16x32_bf16 v[76:79], v[44:47], v[172:175], v[76:79]
    ds_read_b64_tr_b16 v[62:63], v6 offset:49664
    v_mfma_f32_16x16x32_bf16 v[88:91], v[48:51], v[160:163], v[88:91]
    s_nop 2
    buffer_atomic_add_f32 v32, v31, s[20:23], s91 offen offset:0 sc1
    ds_read_b64_tr_b16 v[40:41], v4 offset:57344
    v_mfma_f32_16x16x32_bf16 v[88:91], v[52:55], v[168:171], v[88:91]
    ds_read_b64_tr_b16 v[42:43], v4 offset:57856
    v_mfma_f32_16x16x32_bf16 v[92:95], v[48:51], v[164:167], v[92:95]
    ds_read_b64_tr_b16 v[44:45], v6 offset:57344
    v_mfma_f32_16x16x32_bf16 v[92:95], v[52:55], v[172:175], v[92:95]
    ds_read_b64_tr_b16 v[46:47], v6 offset:57856
    s_waitcnt lgkmcnt(4)
    v_mfma_f32_16x16x32_bf16 v[64:67], v[56:59], v[176:179], v[64:67]
    buffer_atomic_add_f32 v33, v31, s[20:23], s91 offen offset:128 sc1
    ds_read_b64_tr_b16 v[48:49], v5 offset:49152
    v_mfma_f32_16x16x32_bf16 v[64:67], v[60:63], v[184:187], v[64:67]
    ds_read_b64_tr_b16 v[50:51], v5 offset:49664
    v_mfma_f32_16x16x32_bf16 v[68:71], v[56:59], v[180:183], v[68:71]
    ds_read_b64_tr_b16 v[52:53], v7 offset:49152
    v_mfma_f32_16x16x32_bf16 v[68:71], v[60:63], v[188:191], v[68:71]
    ds_read_b64_tr_b16 v[54:55], v7 offset:49664
    v_mfma_f32_16x16x32_bf16 v[16:19], v[8:11], v[56:59], v[16:19]
    buffer_atomic_add_f32 v34, v31, s[20:23], s91 offen offset:256 sc1
    s_waitcnt lgkmcnt(4)
    v_mfma_f32_16x16x32_bf16 v[80:83], v[40:43], v[176:179], v[80:83]
    ds_read_b64_tr_b16 v[56:57], v5 offset:57344
    v_mfma_f32_16x16x32_bf16 v[80:83], v[44:47], v[184:187], v[80:83]
    ds_read_b64_tr_b16 v[58:59], v5 offset:57856
    v_mfma_f32_16x16x32_bf16 v[84:87], v[40:43], v[180:183], v[84:87]
    ds_read_b64_tr_b16 v[60:61], v7 offset:57344
    v_mfma_f32_16x16x32_bf16 v[84:87], v[44:47], v[188:191], v[84:87]
    buffer_atomic_add_f32 v35, v31, s[20:23], s91 offen offset:384 sc1
    ds_read_b64_tr_b16 v[62:63], v7 offset:57856
    v_mfma_f32_16x16x32_bf16 v[16:19], v[12:15], v[40:43], v[16:19]
    s_waitcnt lgkmcnt(4)
    v_mfma_f32_16x16x32_bf16 v[72:75], v[48:51], v[176:179], v[72:75]
    v_mfma_f32_16x16x32_bf16 v[72:75], v[52:55], v[184:187], v[72:75]
    s_mov_b64 exec, 0xffff
    buffer_atomic_add_f32 v36, v31, s[20:23], s73 offen sc1
    s_mov_b64 exec, -1
    s_waitcnt vmcnt(14)
    s_waitcnt lgkmcnt(0)
    s_barrier
    v_add_u32 v4, 0x10000, v4
    v_add_u32 v5, 0x10000, v5
    v_add_u32 v6, 0x10000, v6
    v_add_u32 v7, 0x10000, v7
    ds_read_b64_tr_b16 v[40:41], v4 offset:0
    ds_read_b64_tr_b16 v[42:43], v4 offset:512
    v_mfma_f32_16x16x32_bf16 v[76:79], v[48:51], v[180:183], v[76:79]
    ds_read_b64_tr_b16 v[44:45], v6 offset:0
    ds_read_b64_tr_b16 v[46:47], v6 offset:512
    v_mfma_f32_16x16x32_bf16 v[76:79], v[52:55], v[188:191], v[76:79]
    v_mfma_f32_16x16x32_bf16 v[88:91], v[56:59], v[176:179], v[88:91]
    ds_read_b64_tr_b16 v[48:49], v4 offset:8192
    s_add_u32 m0, s38, 32768
    v_mfma_f32_16x16x32_bf16 v[88:91], v[60:63], v[184:187], v[88:91]
    ds_read_b64_tr_b16 v[50:51], v4 offset:8704
    buffer_load_dwordx4 v1, s[12:15], 0 offen lds
    v_mfma_f32_16x16x32_bf16 v[92:95], v[56:59], v[180:183], v[92:95]
    ds_read_b64_tr_b16 v[52:53], v6 offset:8192
    v_mfma_f32_16x16x32_bf16 v[92:95], v[60:63], v[188:191], v[92:95]
    ds_read_b64_tr_b16 v[54:55], v6 offset:8704
    s_waitcnt lgkmcnt(4)
    v_mfma_f32_16x16x32_bf16 v[64:67], v[40:43], v[192:195], v[64:67]
    ds_read_b64_tr_b16 v[56:57], v5 offset:0
    s_add_u32 m0, s38, 49152
    v_mfma_f32_16x16x32_bf16 v[64:67], v[44:47], v[200:203], v[64:67]
    ds_read_b64_tr_b16 v[58:59], v5 offset:512
    buffer_load_dwordx4 v1, s[16:19], 0 offen lds
    v_mfma_f32_16x16x32_bf16 v[68:71], v[40:43], v[196:199], v[68:71]
    ds_read_b64_tr_b16 v[60:61], v7 offset:0
    v_mfma_f32_16x16x32_bf16 v[68:71], v[44:47], v[204:207], v[68:71]
    ds_read_b64_tr_b16 v[62:63], v7 offset:512
    v_mfma_f32_16x16x32_bf16 v[16:19], v[8:11], v[40:43], v[16:19]
    s_waitcnt lgkmcnt(4)
    v_mfma_f32_16x16x32_bf16 v[80:83], v[48:51], v[192:195], v[80:83]
    ds_read_b64_tr_b16 v[40:41], v5 offset:8192
    s_add_u32 m0, s38, 40960
    v_mfma_f32_16x16x32_bf16 v[80:83], v[52:55], v[200:203], v[80:83]
    ds_read_b64_tr_b16 v[42:43], v5 offset:8704
    s_mov_b32 s39, 458752
    v_mfma_f32_16x16x32_bf16 v[84:87], v[48:51], v[196:199], v[84:87]
    ds_read_b64_tr_b16 v[44:45], v7 offset:8192
    buffer_load_dwordx4 v1, s[12:15], s39 offen lds
    v_mfma_f32_16x16x32_bf16 v[84:87], v[52:55], v[204:207], v[84:87]
    ds_read_b64_tr_b16 v[46:47], v7 offset:8704
    v_mfma_f32_16x16x32_bf16 v[16:19], v[12:15], v[48:51], v[16:19]
    s_waitcnt lgkmcnt(4)
    v_mfma_f32_16x16x32_bf16 v[72:75], v[56:59], v[192:195], v[72:75]
    ds_read_b64_tr_b16 v[48:49], v4 offset:16384
    s_add_u32 m0, s38, 57344
    v_mfma_f32_16x16x32_bf16 v[72:75], v[60:63], v[200:203], v[72:75]
    ds_read_b64_tr_b16 v[50:51], v4 offset:16896
    s_mov_b32 s39, 458752
    v_mfma_f32_16x16x32_bf16 v[76:79], v[56:59], v[196:199], v[76:79]
    ds_read_b64_tr_b16 v[52:53], v6 offset:16384
    buffer_load_dwordx4 v1, s[16:19], s39 offen lds
    v_mfma_f32_16x16x32_bf16 v[76:79], v[60:63], v[204:207], v[76:79]
    ds_read_b64_tr_b16 v[54:55], v6 offset:16896
    s_waitcnt lgkmcnt(4)
    v_mfma_f32_16x16x32_bf16 v[88:91], v[40:43], v[192:195], v[88:91]
    ds_read_b64_tr_b16 v[56:57], v4 offset:24576
    s_add_u32 m0, s38, 98304
    v_mfma_f32_16x16x32_bf16 v[88:91], v[44:47], v[200:203], v[88:91]
    ds_read_b64_tr_b16 v[58:59], v4 offset:25088
    s_mov_b32 s39, 524288
    v_mfma_f32_16x16x32_bf16 v[92:95], v[40:43], v[196:199], v[92:95]
    ds_read_b64_tr_b16 v[60:61], v6 offset:24576
    buffer_load_dwordx4 v30, s[40:43], s39 offen lds
    v_mfma_f32_16x16x32_bf16 v[92:95], v[44:47], v[204:207], v[92:95]
    ds_read_b64_tr_b16 v[62:63], v6 offset:25088
    s_waitcnt lgkmcnt(4)
    v_mfma_f32_16x16x32_bf16 v[64:67], v[48:51], v[208:211], v[64:67]
    ds_read_b64_tr_b16 v[40:41], v5 offset:16384
    s_add_u32 m0, s38, 106496
    v_mfma_f32_16x16x32_bf16 v[64:67], v[52:55], v[216:219], v[64:67]
    ds_read_b64_tr_b16 v[42:43], v5 offset:16896
    s_mov_b32 s39, 655360
    v_mfma_f32_16x16x32_bf16 v[68:71], v[48:51], v[212:215], v[68:71]
    ds_read_b64_tr_b16 v[44:45], v7 offset:16384
    buffer_load_dwordx4 v30, s[40:43], s39 offen lds
    v_mfma_f32_16x16x32_bf16 v[68:71], v[52:55], v[220:223], v[68:71]
    ds_read_b64_tr_b16 v[46:47], v7 offset:16896
    v_mfma_f32_16x16x32_bf16 v[16:19], v[8:11], v[48:51], v[16:19]
    s_waitcnt lgkmcnt(4)
    v_mfma_f32_16x16x32_bf16 v[80:83], v[56:59], v[208:211], v[80:83]
    ds_read_b64_tr_b16 v[48:49], v5 offset:24576
    v_mfma_f32_16x16x32_bf16 v[80:83], v[60:63], v[216:219], v[80:83]
    ds_read_b64_tr_b16 v[50:51], v5 offset:25088
    v_mfma_f32_16x16x32_bf16 v[84:87], v[56:59], v[212:215], v[84:87]
    ds_read_b64_tr_b16 v[52:53], v7 offset:24576
    v_mfma_f32_16x16x32_bf16 v[84:87], v[60:63], v[220:223], v[84:87]
    ds_read_b64_tr_b16 v[54:55], v7 offset:25088
    v_mfma_f32_16x16x32_bf16 v[16:19], v[12:15], v[56:59], v[16:19]
    s_waitcnt lgkmcnt(4)
    v_mfma_f32_16x16x32_bf16 v[72:75], v[40:43], v[208:211], v[72:75]
    v_mfma_f32_16x16x32_bf16 v[72:75], v[44:47], v[216:219], v[72:75]
    s_waitcnt vmcnt(11)
    s_waitcnt vmcnt(6)
    s_waitcnt lgkmcnt(0)
    s_barrier
    s_cmp_eq_u32 s32, 0
    s_cselect_b32 s92, s90, 2146435072
    s_add_u32 s92, s92, 8704
    s_mov_b64 exec, 1
    buffer_atomic_inc v8, off, s[20:23], s92 offset:0 sc1
    s_mov_b64 exec, -1
    s_mov_b64 exec, 1
    buffer_atomic_inc v8, off, s[20:23], s97 offset:128 sc1
    s_mov_b64 exec, -1
    v_add_u32 v4, 0xffff0000, v4
    v_add_u32 v5, 0xffff0000, v5
    v_add_u32 v6, 0xffff0000, v6
    v_add_u32 v7, 0xffff0000, v7
    ds_read_b64_tr_b16 v[56:57], v4 offset:0
    ds_read_b64_tr_b16 v[58:59], v4 offset:512
    v_mfma_f32_16x16x32_bf16 v[76:79], v[40:43], v[212:215], v[76:79]
    ds_read_b64_tr_b16 v[60:61], v6 offset:0
    ds_read_b64_tr_b16 v[62:63], v6 offset:512
    v_mfma_f32_16x16x32_bf16 v[76:79], v[44:47], v[220:223], v[76:79]
    v_mfma_f32_16x16x32_bf16 v[88:91], v[48:51], v[208:211], v[88:91]
    ds_read_b64_tr_b16 v[40:41], v4 offset:8192
    s_add_u32 m0, s38, 65536
    v_mfma_f32_16x16x32_bf16 v[88:91], v[52:55], v[216:219], v[88:91]
    ds_read_b64_tr_b16 v[42:43], v4 offset:8704
    s_mov_b32 s39, 917504
    v_mfma_f32_16x16x32_bf16 v[92:95], v[48:51], v[212:215], v[92:95]
    ds_read_b64_tr_b16 v[44:45], v6 offset:8192
    buffer_load_dwordx4 v1, s[12:15], s39 offen lds
    v_mfma_f32_16x16x32_bf16 v[92:95], v[52:55], v[220:223], v[92:95]
    ds_read_b64_tr_b16 v[46:47], v6 offset:8704
    s_waitcnt lgkmcnt(4)
    v_mfma_f32_16x16x32_bf16 v[64:67], v[56:59], v[224:227], v[64:67]
    ds_read_b64_tr_b16 v[48:49], v5 offset:0
    s_add_u32 m0, s38, 81920
    v_mfma_f32_16x16x32_bf16 v[64:67], v[60:63], v[232:235], v[64:67]
    ds_read_b64_tr_b16 v[50:51], v5 offset:512
    s_mov_b32 s39, 917504
    v_mfma_f32_16x16x32_bf16 v[68:71], v[56:59], v[228:231], v[68:71]
    ds_read_b64_tr_b16 v[52:53], v7 offset:0
    buffer_load_dwordx4 v1, s[16:19], s39 offen lds
    v_mfma_f32_16x16x32_bf16 v[68:71], v[60:63], v[236:239], v[68:71]
    ds_read_b64_tr_b16 v[54:55], v7 offset:512
    v_mfma_f32_16x16x32_bf16 v[16:19], v[8:11], v[56:59], v[16:19]
    s_waitcnt lgkmcnt(4)
    v_mfma_f32_16x16x32_bf16 v[80:83], v[40:43], v[224:227], v[80:83]
    ds_read_b64_tr_b16 v[56:57], v5 offset:8192
    s_add_u32 m0, s38, 73728
    v_mfma_f32_16x16x32_bf16 v[80:83], v[44:47], v[232:235], v[80:83]
    ds_read_b64_tr_b16 v[58:59], v5 offset:8704
    s_mov_b32 s39, 1376256
    v_mfma_f32_16x16x32_bf16 v[84:87], v[40:43], v[228:231], v[84:87]
    ds_read_b64_tr_b16 v[60:61], v7 offset:8192
    buffer_load_dwordx4 v1, s[12:15], s39 offen lds
    v_mfma_f32_16x16x32_bf16 v[84:87], v[44:47], v[236:239], v[84:87]
    ds_read_b64_tr_b16 v[62:63], v7 offset:8704
    v_mfma_f32_16x16x32_bf16 v[16:19], v[12:15], v[40:43], v[16:19]
    s_waitcnt lgkmcnt(4)
    v_mfma_f32_16x16x32_bf16 v[72:75], v[48:51], v[224:227], v[72:75]
    ds_read_b64_tr_b16 v[40:41], v4 offset:16384
    s_add_u32 m0, s38, 90112
    v_mfma_f32_16x16x32_bf16 v[72:75], v[52:55], v[232:235], v[72:75]
    ds_read_b64_tr_b16 v[42:43], v4 offset:16896
    s_mov_b32 s39, 1376256
    v_mfma_f32_16x16x32_bf16 v[76:79], v[48:51], v[228:231], v[76:79]
    ds_read_b64_tr_b16 v[44:45], v6 offset:16384
    buffer_load_dwordx4 v1, s[16:19], s39 offen lds
    v_mfma_f32_16x16x32_bf16 v[76:79], v[52:55], v[236:239], v[76:79]
    ds_read_b64_tr_b16 v[46:47], v6 offset:16896
    s_waitcnt lgkmcnt(4)
    v_mfma_f32_16x16x32_bf16 v[88:91], v[56:59], v[224:227], v[88:91]
    ds_read_b64_tr_b16 v[48:49], v4 offset:24576
    s_add_u32 m0, s38, 114688
    v_mfma_f32_16x16x32_bf16 v[88:91], v[60:63], v[232:235], v[88:91]
    ds_read_b64_tr_b16 v[50:51], v4 offset:25088
    s_mov_b32 s39, 786432
    v_mfma_f32_16x16x32_bf16 v[92:95], v[56:59], v[228:231], v[92:95]
    ds_read_b64_tr_b16 v[52:53], v6 offset:24576
    buffer_load_dwordx4 v30, s[40:43], s39 offen lds
    v_mfma_f32_16x16x32_bf16 v[92:95], v[60:63], v[236:239], v[92:95]
    ds_read_b64_tr_b16 v[54:55], v6 offset:25088
    s_waitcnt lgkmcnt(4)
    v_mfma_f32_16x16x32_bf16 v[64:67], v[40:43], v[240:243], v[64:67]
    ds_read_b64_tr_b16 v[56:57], v5 offset:16384
    s_add_u32 m0, s38, 122880
    v_mfma_f32_16x16x32_bf16 v[64:67], v[44:47], v[248:251], v[64:67]
    ds_read_b64_tr_b16 v[58:59], v5 offset:16896
    s_mov_b32 s39, 917504
    v_mfma_f32_16x16x32_bf16 v[68:71], v[40:43], v[244:247], v[68:71]
    ds_read_b64_tr_b16 v[60:61], v7 offset:16384
    buffer_load_dwordx4 v30, s[40:43], s39 offen lds
    v_mfma_f32_16x16x32_bf16 v[68:71], v[44:47], v[252:255], v[68:71]
    ds_read_b64_tr_b16 v[62:63], v7 offset:16896
    v_mfma_f32_16x16x32_bf16 v[16:19], v[8:11], v[40:43], v[16:19]
    s_waitcnt lgkmcnt(4)
    v_mfma_f32_16x16x32_bf16 v[80:83], v[48:51], v[240:243], v[80:83]
    ds_read_b64_tr_b16 v[40:41], v5 offset:24576
    v_mfma_f32_16x16x32_bf16 v[80:83], v[52:55], v[248:251], v[80:83]
    ds_read_b64_tr_b16 v[42:43], v5 offset:25088
    v_mfma_f32_16x16x32_bf16 v[84:87], v[48:51], v[244:247], v[84:87]
    ds_read_b64_tr_b16 v[44:45], v7 offset:24576
    v_mfma_f32_16x16x32_bf16 v[84:87], v[52:55], v[252:255], v[84:87]
    ds_read_b64_tr_b16 v[46:47], v7 offset:25088
    v_mfma_f32_16x16x32_bf16 v[16:19], v[12:15], v[48:51], v[16:19]
    s_waitcnt lgkmcnt(4)
    v_mfma_f32_16x16x32_bf16 v[72:75], v[56:59], v[240:243], v[72:75]
    v_mfma_f32_16x16x32_bf16 v[72:75], v[60:63], v[248:251], v[72:75]
    s_waitcnt vmcnt(10)
    s_waitcnt lgkmcnt(0)
    s_barrier
    v_lshlrev_b32 v2, 4, v0
    v_lshrrev_b32 v5, 4, v0
    v_bfe_u32 v7, v0, 2, 2
    v_lshl_add_u32 v4, v5, 3, v7
    v_lshlrev_b32 v4, 6, v4
    v_and_b32 v5, 1, v5
    v_xor_b32 v5, s34, v5
    v_lshl_add_u32 v4, v5, 5, v4
    v_and_b32 v5, 3, v0
    v_lshl_add_u32 v4, v5, 3, v4
    s_lshr_b32 s92, s33, 1
    s_lshl_b32 s92, s92, 11
    v_add_u32 v4, s92, v4
    v_xor_b32 v6, 0x800, v4
    ds_read_b64_tr_b16 v[48:49], v4 offset:32768
    ds_read_b64_tr_b16 v[50:51], v4 offset:33024
    v_mfma_f32_16x16x32_bf16 v[76:79], v[56:59], v[244:247], v[76:79]
    ds_read_b64_tr_b16 v[52:53], v6 offset:32768
    ds_read_b64_tr_b16 v[54:55], v6 offset:33024
    v_mfma_f32_16x16x32_bf16 v[76:79], v[60:63], v[252:255], v[76:79]
    v_mfma_f32_16x16x32_bf16 v[88:91], v[40:43], v[240:243], v[88:91]
    ds_read_b64_tr_b16 v[56:57], v4 offset:49152
    s_add_u32 m0, s38, 131072
    v_mfma_f32_16x16x32_bf16 v[88:91], v[44:47], v[248:251], v[88:91]
    ds_read_b64_tr_b16 v[58:59], v4 offset:49408
    buffer_load_dwordx4 v30, s[40:43], 0 offen lds
    v_mfma_f32_16x16x32_bf16 v[92:95], v[40:43], v[244:247], v[92:95]
    ds_read_b64_tr_b16 v[60:61], v6 offset:49152
    v_mfma_f32_16x16x32_bf16 v[92:95], v[44:47], v[252:255], v[92:95]
    ds_read_b64_tr_b16 v[62:63], v6 offset:49408
    v_and_b32 v32, 15, v0
    v_lshrrev_b32 v33, 5, v0
    v_lshl_add_u32 v32, v32, 2, s74
    v_lshl_add_u32 v32, v33, 8, v32
    v_cvt_pk_bf16_f32 v33, v16, v16
    v_lshlrev_b32 v33, 16, v33
    v_sub_f32 v33, v16, v33
    v_cvt_pk_bf16_f32 v33, v16, v33
    ds_write_b32 v32, v33 offset:1024
    s_waitcnt lgkmcnt(5)
    v_mfma_f32_16x16x32_bf16 v[96:99], v[48:51], v[128:131], 0
    ds_read_b64_tr_b16 v[40:41], v4 offset:36864
    s_add_u32 m0, s38, 139264
    v_mfma_f32_16x16x32_bf16 v[96:99], v[52:55], v[136:139], v[96:99]
    ds_read_b64_tr_b16 v[42:43], v4 offset:37120
    s_mov_b32 s39, 65536
    v_mfma_f32_16x16x32_bf16 v[100:103], v[48:51], v[132:135], 0
    ds_read_b64_tr_b16 v[44:45], v6 offset:36864
    buffer_load_dwordx4 v30, s[40:43], s39 offen lds
    v_mfma_f32_16x16x32_bf16 v[100:103], v[52:55], v[140:143], v[100:103]
    ds_read_b64_tr_b16 v[46:47], v6 offset:37120
    v_mfma_f32_16x16x32_bf16 v[16:19], v[8:11], v[48:51], 0
    s_waitcnt lgkmcnt(5)
    v_mfma_f32_16x16x32_bf16 v[112:115], v[56:59], v[128:131], 0
    ds_read_b64_tr_b16 v[48:49], v4 offset:53248
    s_add_u32 m0, s38, 0
    v_mfma_f32_16x16x32_bf16 v[112:115], v[60:63], v[136:139], v[112:115]
    ds_read_b64_tr_b16 v[50:51], v4 offset:53504
    s_mov_b32 s39, 1048576
    v_mfma_f32_16x16x32_bf16 v[116:119], v[56:59], v[132:135], 0
    ds_read_b64_tr_b16 v[52:53], v6 offset:53248
    buffer_load_dwordx4 v30, s[40:43], s39 offen lds
    v_mfma_f32_16x16x32_bf16 v[116:119], v[60:63], v[140:143], v[116:119]
    ds_read_b64_tr_b16 v[54:55], v6 offset:53504
    v_mfma_f32_16x16x32_bf16 v[16:19], v[12:15], v[56:59], v[16:19]
    s_waitcnt lgkmcnt(4)
    v_mfma_f32_16x16x32_bf16 v[96:99], v[40:43], v[144:147], v[96:99]
    ds_read_b64_tr_b16 v[56:57], v4 offset:40960
    s_add_u32 m0, s38, 8192
    v_mfma_f32_16x16x32_bf16 v[96:99], v[44:47], v[152:155], v[96:99]
    ds_read_b64_tr_b16 v[58:59], v4 offset:41216
    s_mov_b32 s39, 1179648
    v_mfma_f32_16x16x32_bf16 v[100:103], v[40:43], v[148:151], v[100:103]
    ds_read_b64_tr_b16 v[60:61], v6 offset:40960
    buffer_load_dwordx4 v30, s[40:43], s39 offen lds
    v_mfma_f32_16x16x32_bf16 v[100:103], v[44:47], v[156:159], v[100:103]
    ds_read_b64_tr_b16 v[62:63], v6 offset:41216
    v_mfma_f32_16x16x32_bf16 v[16:19], v[8:11], v[40:43], v[16:19]
    s_waitcnt lgkmcnt(4)
    v_mfma_f32_16x16x32_bf16 v[112:115], v[48:51], v[144:147], v[112:115]
    ds_read_b64_tr_b16 v[40:41], v4 offset:57344
    s_add_u32 m0, s38, 16384
    v_mfma_f32_16x16x32_bf16 v[112:115], v[52:55], v[152:155], v[112:115]
    ds_read_b64_tr_b16 v[42:43], v4 offset:57600
    s_mov_b32 s39, 1310720
    v_mfma_f32_16x16x32_bf16 v[116:119], v[48:51], v[148:151], v[116:119]
    ds_read_b64_tr_b16 v[44:45], v6 offset:57344
    buffer_load_dwordx4 v30, s[40:43], s39 offen lds
    v_mfma_f32_16x16x32_bf16 v[116:119], v[52:55], v[156:159], v[116:119]
    ds_read_b64_tr_b16 v[46:47], v6 offset:57600
    v_mfma_f32_16x16x32_bf16 v[16:19], v[12:15], v[48:51], v[16:19]
    buffer_load_dword v31, off, s[20:23], s96 sc0 sc1
    s_waitcnt lgkmcnt(4)
    v_mfma_f32_16x16x32_bf16 v[96:99], v[56:59], v[160:163], v[96:99]
    ds_read_b64_tr_b16 v[48:49], v4 offset:45056
    s_add_u32 m0, s38, 24576
    v_mfma_f32_16x16x32_bf16 v[96:99], v[60:63], v[168:171], v[96:99]
    ds_read_b64_tr_b16 v[50:51], v4 offset:45312
    s_mov_b32 s39, 1441792
    v_mfma_f32_16x16x32_bf16 v[100:103], v[56:59], v[164:167], v[100:103]
    ds_read_b64_tr_b16 v[52:53], v6 offset:45056
    buffer_load_dwordx4 v30, s[40:43], s39 offen lds
    v_mfma_f32_16x16x32_bf16 v[100:103], v[60:63], v[172:175], v[100:103]
    ds_read_b64_tr_b16 v[54:55], v6 offset:45312
    v_mfma_f32_16x16x32_bf16 v[16:19], v[8:11], v[56:59], v[16:19]
    s_waitcnt lgkmcnt(4)
    v_mfma_f32_16x16x32_bf16 v[112:115], v[40:43], v[160:163], v[112:115]
    ds_read_b64_tr_b16 v[56:57], v4 offset:61440
    v_mfma_f32_16x16x32_bf16 v[112:115], v[44:47], v[168:171], v[112:115]
    ds_read_b64_tr_b16 v[58:59], v4 offset:61696
    v_mfma_f32_16x16x32_bf16 v[116:119], v[40:43], v[164:167], v[116:119]
    ds_read_b64_tr_b16 v[60:61], v6 offset:61440
    v_mfma_f32_16x16x32_bf16 v[116:119], v[44:47], v[172:175], v[116:119]
    ds_read_b64_tr_b16 v[62:63], v6 offset:61696
    v_mfma_f32_16x16x32_bf16 v[16:19], v[12:15], v[40:43], v[16:19]
    s_waitcnt lgkmcnt(4)
    v_mfma_f32_16x16x32_bf16 v[96:99], v[48:51], v[176:179], v[96:99]
    v_mfma_f32_16x16x32_bf16 v[96:99], v[52:55], v[184:187], v[96:99]
    s_waitcnt vmcnt(9)
    s_waitcnt lgkmcnt(0)
    s_barrier
    v_add_u32 v4, 0x10000, v4
    v_add_u32 v5, 0x10000, v5
    v_add_u32 v6, 0x10000, v6
    v_add_u32 v7, 0x10000, v7
    ds_read_b64_tr_b16 v[40:41], v4 offset:0
    ds_read_b64_tr_b16 v[42:43], v4 offset:256
    v_mfma_f32_16x16x32_bf16 v[100:103], v[48:51], v[180:183], v[100:103]
    ds_read_b64_tr_b16 v[44:45], v6 offset:0
    ds_read_b64_tr_b16 v[46:47], v6 offset:256
    v_mfma_f32_16x16x32_bf16 v[100:103], v[52:55], v[188:191], v[100:103]
    v_mfma_f32_16x16x32_bf16 v[16:19], v[8:11], v[48:51], v[16:19]
    v_mfma_f32_16x16x32_bf16 v[112:115], v[56:59], v[176:179], v[112:115]
    ds_read_b64_tr_b16 v[48:49], v4 offset:16384
    s_add_u32 m0, s38, 147456
    s_mov_b32 s39, 131072
    v_mfma_f32_16x16x32_bf16 v[112:115], v[60:63], v[184:187], v[112:115]
    ds_read_b64_tr_b16 v[50:51], v4 offset:16640
    buffer_load_dwordx4 v30, s[40:43], s39 offen lds
    s_add_u32 m0, s38, 32768
    v_mfma_f32_16x16x32_bf16 v[116:119], v[56:59], v[180:183], v[116:119]
    ds_read_b64_tr_b16 v[52:53], v6 offset:16384
    s_mov_b32 s39, 589824
    buffer_load_dwordx4 v30, s[40:43], s39 offen lds
    v_mfma_f32_16x16x32_bf16 v[116:119], v[60:63], v[188:191], v[116:119]
    ds_read_b64_tr_b16 v[54:55], v6 offset:16640
    v_mfma_f32_16x16x32_bf16 v[16:19], v[12:15], v[56:59], v[16:19]
    s_waitcnt vmcnt(3)
    v_readfirstlane_b32 s71, v31
    s_cmp_ge_u32 s71, 8
    s_cbranch_scc1 K1_ok_4
    s_mov_b32 s72, 0
K1_poll_3:
    buffer_load_dword v31, off, s[20:23], s96 offset:0 sc0 sc1
    s_waitcnt vmcnt(0)
    v_readfirstlane_b32 s71, v31
    s_add_u32 s72, s72, 1
    s_cmp_ge_u32 s72, 0x20000
    s_cbranch_scc1 K1_ok_4
    s_cmp_lt_u32 s71, 8
    s_cbranch_scc1 K1_poll_3
K1_ok_4:
    s_add_u32 m0, s38, 40960
    s_mov_b32 s39, 720896
    buffer_load_dwordx4 v30, s[40:43], s39 offen lds
    v_and_b32 v33, 31, v0
    v_lshl_add_u32 v33, v33, 2, s75
    v_xor_b32 v35, 128, v33
    v_mov_b32 v37, 0
    v_mov_b32 v39, 0
    ds_read_b32 v32, v33 offset:1024
    ds_read_b32 v34, v33 offset:1280
    ds_read_b32 v36, v35 offset:1024
    ds_read_b32 v38, v35 offset:1280
    s_waitcnt lgkmcnt(3)
    v_mfma_f32_16x16x16_bf16 v[64:67], v[32:33], v[20:21], v[64:67]
    v_mfma_f32_16x16x16_bf16 v[68:71], v[32:33], v[22:23], v[68:71]
    s_waitcnt lgkmcnt(2)
    v_mfma_f32_16x16x16_bf16 v[80:83], v[34:35], v[20:21], v[80:83]
    v_mfma_f32_16x16x16_bf16 v[84:87], v[34:35], v[22:23], v[84:87]
    s_waitcnt lgkmcnt(1)
    v_mfma_f32_16x16x16_bf16 v[72:75], v[36:37], v[20:21], v[72:75]
    v_mfma_f32_16x16x16_bf16 v[76:79], v[36:37], v[22:23], v[76:79]
    s_waitcnt lgkmcnt(0)
    v_mfma_f32_16x16x16_bf16 v[88:91], v[38:39], v[20:21], v[88:91]
    v_mfma_f32_16x16x16_bf16 v[92:95], v[38:39], v[22:23], v[92:95]
    v_mul_f32 v32, v64, v64
    v_mul_f32 v33, v65, v65
    v_mul_f32 v34, v66, v66
    v_mul_f32 v35, v67, v67
    v_fma_f32 v32, v32, v25, v24
    v_fma_f32 v33, v33, v25, v24
    v_fma_f32 v34, v34, v25, v24
    v_fma_f32 v35, v35, v25, v24
    v_mul_f32 v80, v64, v80
    v_mul_f32 v64, v32, v64
    v_mul_f32 v81, v65, v81
    s_add_u32 m0, s38, 49152
    s_mov_b32 s39, 851968
    buffer_load_dwordx4 v30, s[40:43], s39 offen lds
    v_mul_f32 v65, v33, v65
    v_mul_f32 v82, v66, v82
    v_mul_f32 v66, v34, v66
    v_mul_f32 v83, v67, v83
    v_mul_f32 v67, v35, v67
    v_exp_f32 v64, v64
    v_exp_f32 v65, v65
    v_exp_f32 v66, v66
    v_exp_f32 v67, v67
    v_fma_f32 v64, v64, v26, v26
    v_fma_f32 v65, v65, v26, v26
    v_fma_f32 v66, v66, v26, v26
    s_add_u32 m0, s38, 57344
    s_mov_b32 s39, 983040
    buffer_load_dwordx4 v30, s[40:43], s39 offen lds
    v_fma_f32 v67, v67, v26, v26
    v_rcp_f32 v64, v64
    v_rcp_f32 v65, v65
    v_rcp_f32 v66, v66
    v_rcp_f32 v67, v67
    v_mul_f32 v80, v80, v64
    v_mul_f32 v81, v81, v65
    v_mul_f32 v82, v82, v66
    v_mul_f32 v83, v83, v67
    v_cvt_pk_bf16_f32 v64, v80, v81
    v_cvt_pk_bf16_f32 v65, v82, v83
    v_mul_f32 v32, v68, v68
    s_add_u32 s93, s95, 32768
    buffer_load_dwordx4 v[128:131], v2, s[20:23], s93 offen offset:0 sc0 sc1
    v_mul_f32 v33, v69, v69
    v_mul_f32 v34, v70, v70
    v_mul_f32 v35, v71, v71
    v_fma_f32 v32, v32, v28, v27
    v_fma_f32 v33, v33, v28, v27
    v_fma_f32 v34, v34, v28, v27
    v_fma_f32 v35, v35, v28, v27
    v_mul_f32 v84, v68, v84
    v_mul_f32 v68, v32, v68
    v_mul_f32 v85, v69, v85
    v_mul_f32 v69, v33, v69
    v_mul_f32 v86, v70, v86
    v_mul_f32 v70, v34, v70
    v_mul_f32 v87, v71, v87
    v_mul_f32 v71, v35, v71
    v_exp_f32 v68, v68
    buffer_load_dwordx4 v[132:135], v2, s[20:23], s93 offen offset:1024 sc0 sc1
    v_exp_f32 v69, v69
    v_exp_f32 v70, v70
    v_exp_f32 v71, v71
    v_fma_f32 v68, v68, v29, v29
    v_fma_f32 v69, v69, v29, v29
    v_fma_f32 v70, v70, v29, v29
    v_fma_f32 v71, v71, v29, v29
    v_rcp_f32 v68, v68
    v_rcp_f32 v69, v69
    v_rcp_f32 v70, v70
    buffer_load_dwordx4 v[136:139], v2, s[20:23], s93 offen offset:2048 sc0 sc1
    v_rcp_f32 v71, v71
    v_mul_f32 v84, v84, v68
    v_mul_f32 v85, v85, v69
    v_mul_f32 v86, v86, v70
    v_mul_f32 v87, v87, v71
    v_cvt_pk_bf16_f32 v66, v84, v85
    v_cvt_pk_bf16_f32 v67, v86, v87
    s_nop 0
    v_permlane16_swap_b32 v64, v66
    v_permlane16_swap_b32 v65, v67
    s_lshl_b32 s70, s36, 12
    s_add_u32 s70, s70, s68
    buffer_store_dwordx4 v[64:67], v3, s[20:23], s70 offen sc0 sc1
    v_mul_f32 v32, v72, v72
    v_mul_f32 v33, v73, v73
    v_mul_f32 v34, v74, v74
    v_mul_f32 v35, v75, v75
    v_fma_f32 v32, v32, v25, v24
    v_fma_f32 v33, v33, v25, v24
    v_fma_f32 v34, v34, v25, v24
    buffer_load_dwordx4 v[140:143], v2, s[20:23], s93 offen offset:3072 sc0 sc1
    v_fma_f32 v35, v35, v25, v24
    v_mul_f32 v88, v72, v88
    v_mul_f32 v72, v32, v72
    v_mul_f32 v89, v73, v89
    v_mul_f32 v73, v33, v73
    v_mul_f32 v90, v74, v90
    v_mul_f32 v74, v34, v74
    v_mul_f32 v91, v75, v91
    v_mul_f32 v75, v35, v75
    v_exp_f32 v72, v72
    v_exp_f32 v73, v73
    v_exp_f32 v74, v74
    v_exp_f32 v75, v75
    s_add_u32 s93, s95, 65536
    buffer_load_dwordx4 v[144:147], v2, s[20:23], s93 offen offset:0 sc0 sc1
    v_fma_f32 v72, v72, v26, v26
    v_fma_f32 v73, v73, v26, v26
    v_fma_f32 v74, v74, v26, v26
    v_fma_f32 v75, v75, v26, v26
    v_rcp_f32 v72, v72
    v_rcp_f32 v73, v73
    v_rcp_f32 v74, v74
    v_rcp_f32 v75, v75
    v_mul_f32 v88, v88, v72
    v_mul_f32 v89, v89, v73
    v_mul_f32 v90, v90, v74
    buffer_load_dwordx4 v[148:151], v2, s[20:23], s93 offen offset:1024 sc0 sc1
    v_mul_f32 v91, v91, v75
    v_cvt_pk_bf16_f32 v72, v88, v89
    v_cvt_pk_bf16_f32 v73, v90, v91
    v_mul_f32 v32, v76, v76
    v_mul_f32 v33, v77, v77
    v_mul_f32 v34, v78, v78
    v_mul_f32 v35, v79, v79
    v_fma_f32 v32, v32, v28, v27
    v_fma_f32 v33, v33, v28, v27
    v_fma_f32 v34, v34, v28, v27
    v_fma_f32 v35, v35, v28, v27
    v_mul_f32 v92, v76, v92
    v_mul_f32 v76, v32, v76
    v_mul_f32 v93, v77, v93
    v_mul_f32 v77, v33, v77
    v_mul_f32 v94, v78, v94
    buffer_load_dwordx4 v[152:155], v2, s[20:23], s93 offen offset:2048 sc0 sc1
    v_mul_f32 v78, v34, v78
    v_mul_f32 v95, v79, v95
    v_mul_f32 v79, v35, v79
    v_exp_f32 v76, v76
    v_exp_f32 v77, v77
    v_exp_f32 v78, v78
    v_exp_f32 v79, v79
    v_fma_f32 v76, v76, v29, v29
    v_fma_f32 v77, v77, v29, v29
    v_fma_f32 v78, v78, v29, v29
    v_fma_f32 v79, v79, v29, v29
    v_rcp_f32 v76, v76
    buffer_load_dwordx4 v[156:159], v2, s[20:23], s93 offen offset:3072 sc0 sc1
    v_rcp_f32 v77, v77
    v_rcp_f32 v78, v78
    v_rcp_f32 v79, v79
    v_mul_f32 v92, v92, v76
    v_mul_f32 v93, v93, v77
    v_mul_f32 v94, v94, v78
    v_mul_f32 v95, v95, v79
    v_cvt_pk_bf16_f32 v74, v92, v93
    v_cvt_pk_bf16_f32 v75, v94, v95
    s_nop 0
    v_permlane16_swap_b32 v72, v74
    v_permlane16_swap_b32 v73, v75
    s_lshl_b32 s70, s36, 12
    s_add_u32 s70, s70, s69
    buffer_store_dwordx4 v[72:75], v3, s[20:23], s70 offen sc0 sc1
    v_mfma_f32_16x16x32_bf16 v[96:99], v[40:43], v[192:195], v[96:99]
    ds_read_b64_tr_b16 v[56:57], v4 offset:4096
    s_add_u32 s93, s95, 36864
    v_mfma_f32_16x16x32_bf16 v[96:99], v[44:47], v[200:203], v[96:99]
    ds_read_b64_tr_b16 v[58:59], v4 offset:4352
    buffer_load_dwordx4 v[160:163], v2, s[20:23], s93 offen offset:0 sc0 sc1
    v_mfma_f32_16x16x32_bf16 v[100:103], v[40:43], v[196:199], v[100:103]
    ds_read_b64_tr_b16 v[60:61], v6 offset:4096
    buffer_load_dwordx4 v[164:167], v2, s[20:23], s93 offen offset:1024 sc0 sc1
    v_mfma_f32_16x16x32_bf16 v[100:103], v[44:47], v[204:207], v[100:103]
    ds_read_b64_tr_b16 v[62:63], v6 offset:4352
    v_mfma_f32_16x16x32_bf16 v[16:19], v[8:11], v[40:43], v[16:19]
    v_mfma_f32_16x16x32_bf16 v[112:115], v[48:51], v[192:195], v[112:115]
    ds_read_b64_tr_b16 v[40:41], v4 offset:20480
    buffer_load_dwordx4 v[168:171], v2, s[20:23], s93 offen offset:2048 sc0 sc1
    v_mfma_f32_16x16x32_bf16 v[112:115], v[52:55], v[200:203], v[112:115]
    ds_read_b64_tr_b16 v[42:43], v4 offset:20736
    v_mfma_f32_16x16x32_bf16 v[116:119], v[48:51], v[196:199], v[116:119]
    ds_read_b64_tr_b16 v[44:45], v6 offset:20480
    v_mfma_f32_16x16x32_bf16 v[116:119], v[52:55], v[204:207], v[116:119]
    ds_read_b64_tr_b16 v[46:47], v6 offset:20736
    v_mfma_f32_16x16x32_bf16 v[16:19], v[12:15], v[48:51], v[16:19]
    s_waitcnt lgkmcnt(4)
    v_mfma_f32_16x16x32_bf16 v[96:99], v[56:59], v[208:211], v[96:99]
    ds_read_b64_tr_b16 v[48:49], v4 offset:8192
    buffer_load_dwordx4 v[172:175], v2, s[20:23], s93 offen offset:3072 sc0 sc1
    v_mfma_f32_16x16x32_bf16 v[96:99], v[60:63], v[216:219], v[96:99]
    ds_read_b64_tr_b16 v[50:51], v4 offset:8448
    v_mfma_f32_16x16x32_bf16 v[100:103], v[56:59], v[212:215], v[100:103]
    ds_read_b64_tr_b16 v[52:53], v6 offset:8192
    v_mfma_f32_16x16x32_bf16 v[100:103], v[60:63], v[220:223], v[100:103]
    ds_read_b64_tr_b16 v[54:55], v6 offset:8448
    v_mfma_f32_16x16x32_bf16 v[16:19], v[8:11], v[56:59], v[16:19]
    s_waitcnt lgkmcnt(4)
    v_mfma_f32_16x16x32_bf16 v[112:115], v[40:43], v[208:211], v[112:115]
    ds_read_b64_tr_b16 v[56:57], v4 offset:24576
    s_add_u32 s93, s95, 69632
    v_mfma_f32_16x16x32_bf16 v[112:115], v[44:47], v[216:219], v[112:115]
    ds_read_b64_tr_b16 v[58:59], v4 offset:24832
    buffer_load_dwordx4 v[176:179], v2, s[20:23], s93 offen offset:0 sc0 sc1
    v_mfma_f32_16x16x32_bf16 v[116:119], v[40:43], v[212:215], v[116:119]
    ds_read_b64_tr_b16 v[60:61], v6 offset:24576
    v_mfma_f32_16x16x32_bf16 v[116:119], v[44:47], v[220:223], v[116:119]
    ds_read_b64_tr_b16 v[62:63], v6 offset:24832
    v_mfma_f32_16x16x32_bf16 v[16:19], v[12:15], v[40:43], v[16:19]
    s_waitcnt lgkmcnt(4)
    v_mfma_f32_16x16x32_bf16 v[96:99], v[48:51], v[224:227], v[96:99]
    ds_read_b64_tr_b16 v[40:41], v4 offset:12288
    buffer_load_dwordx4 v[180:183], v2, s[20:23], s93 offen offset:1024 sc0 sc1
    v_mfma_f32_16x16x32_bf16 v[96:99], v[52:55], v[232:235], v[96:99]
    ds_read_b64_tr_b16 v[42:43], v4 offset:12544
    v_mfma_f32_16x16x32_bf16 v[100:103], v[48:51], v[228:231], v[100:103]
    ds_read_b64_tr_b16 v[44:45], v6 offset:12288
    v_mfma_f32_16x16x32_bf16 v[100:103], v[52:55], v[236:239], v[100:103]
    ds_read_b64_tr_b16 v[46:47], v6 offset:12544
    v_mfma_f32_16x16x32_bf16 v[16:19], v[8:11], v[48:51], v[16:19]
    s_waitcnt lgkmcnt(4)
    v_mfma_f32_16x16x32_bf16 v[112:115], v[56:59], v[224:227], v[112:115]
    ds_read_b64_tr_b16 v[48:49], v4 offset:28672
    buffer_load_dwordx4 v[184:187], v2, s[20:23], s93 offen offset:2048 sc0 sc1
    v_mfma_f32_16x16x32_bf16 v[112:115], v[60:63], v[232:235], v[112:115]
    ds_read_b64_tr_b16 v[50:51], v4 offset:28928
    v_mfma_f32_16x16x32_bf16 v[116:119], v[56:59], v[228:231], v[116:119]
    ds_read_b64_tr_b16 v[52:53], v6 offset:28672
    v_mfma_f32_16x16x32_bf16 v[116:119], v[60:63], v[236:239], v[116:119]
    ds_read_b64_tr_b16 v[54:55], v6 offset:28928
    v_mfma_f32_16x16x32_bf16 v[16:19], v[12:15], v[56:59], v[16:19]
    buffer_load_dword v31, off, s[20:23], s96 offset:128 sc0 sc1
    s_waitcnt lgkmcnt(4)
    v_mfma_f32_16x16x32_bf16 v[96:99], v[40:43], v[240:243], v[96:99]
    buffer_load_dwordx4 v[188:191], v2, s[20:23], s93 offen offset:3072 sc0 sc1
    v_mfma_f32_16x16x32_bf16 v[96:99], v[44:47], v[248:251], v[96:99]
    v_mfma_f32_16x16x32_bf16 v[100:103], v[40:43], v[244:247], v[100:103]
    v_mfma_f32_16x16x32_bf16 v[100:103], v[44:47], v[252:255], v[100:103]
    v_mfma_f32_16x16x32_bf16 v[16:19], v[8:11], v[40:43], v[16:19]
    s_waitcnt lgkmcnt(0)
    v_mfma_f32_16x16x32_bf16 v[112:115], v[48:51], v[240:243], v[112:115]
    v_mfma_f32_16x16x32_bf16 v[112:115], v[52:55], v[248:251], v[112:115]
    v_mfma_f32_16x16x32_bf16 v[116:119], v[48:51], v[244:247], v[116:119]
    v_mfma_f32_16x16x32_bf16 v[116:119], v[52:55], v[252:255], v[116:119]
    v_mfma_f32_16x16x32_bf16 v[16:19], v[12:15], v[48:51], v[16:19]
    v_and_b32 v32, 15, v0
    v_lshrrev_b32 v33, 5, v0
    v_lshl_add_u32 v32, v32, 2, s74
    v_lshl_add_u32 v32, v33, 8, v32
    s_nop 3
    v_cvt_pk_bf16_f32 v33, v16, v16
    v_lshlrev_b32 v33, 16, v33
    v_sub_f32 v33, v16, v33
    v_cvt_pk_bf16_f32 v33, v16, v33
    ds_write_b32 v32, v33 offset:2048
    s_waitcnt vmcnt(24)
    s_waitcnt lgkmcnt(0)
    s_barrier
    v_and_b32 v33, 31, v0
    v_lshl_add_u32 v33, v33, 2, s75
    v_xor_b32 v35, 128, v33
    ds_read_b32 v32, v33 offset:2048
    ds_read_b32 v34, v33 offset:2304
    s_waitcnt lgkmcnt(1)
    v_mfma_f32_16x16x16_bf16 v[96:99], v[32:33], v[20:21], v[96:99]
    v_mfma_f32_16x16x16_bf16 v[100:103], v[32:33], v[22:23], v[100:103]
    s_waitcnt lgkmcnt(0)
    v_mfma_f32_16x16x16_bf16 v[112:115], v[34:35], v[20:21], v[112:115]
    v_mfma_f32_16x16x16_bf16 v[116:119], v[34:35], v[22:23], v[116:119]
    s_nop 3
    v_mul_f32 v32, v96, v96
    s_add_u32 m0, s38, 65536
    s_mov_b32 s39, 1114112
    buffer_load_dwordx4 v30, s[40:43], s39 offen lds
    v_mul_f32 v33, v97, v97
    v_mul_f32 v34, v98, v98
    v_mul_f32 v35, v99, v99
    v_fma_f32 v32, v32, v25, v24
    v_fma_f32 v33, v33, v25, v24
    v_fma_f32 v34, v34, v25, v24
    v_fma_f32 v35, v35, v25, v24
    v_mul_f32 v112, v96, v112
    v_mul_f32 v96, v32, v96
    v_mul_f32 v113, v97, v113
    v_mul_f32 v97, v33, v97
    v_mul_f32 v114, v98, v114
    v_mul_f32 v98, v34, v98
    v_mul_f32 v115, v99, v115
    v_mul_f32 v99, v35, v99
    v_exp_f32 v96, v96
    v_exp_f32 v97, v97
    v_exp_f32 v98, v98
    s_add_u32 m0, s38, 73728
    s_mov_b32 s39, 1245184
    buffer_load_dwordx4 v30, s[40:43], s39 offen lds
    v_exp_f32 v99, v99
    v_fma_f32 v96, v96, v26, v26
    v_fma_f32 v97, v97, v26, v26
    v_fma_f32 v98, v98, v26, v26
    v_fma_f32 v99, v99, v26, v26
    v_rcp_f32 v96, v96
    v_rcp_f32 v97, v97
    v_rcp_f32 v98, v98
    v_rcp_f32 v99, v99
    v_mul_f32 v112, v112, v96
    v_mul_f32 v113, v113, v97
    v_mul_f32 v114, v114, v98
    v_mul_f32 v115, v115, v99
    v_cvt_pk_bf16_f32 v96, v112, v113
    s_add_u32 m0, s38, 81920
    s_mov_b32 s39, 1376256
    buffer_load_dwordx4 v30, s[40:43], s39 offen lds
    v_cvt_pk_bf16_f32 v97, v114, v115
    v_mul_f32 v32, v100, v100
    v_mul_f32 v33, v101, v101
    v_mul_f32 v34, v102, v102
    v_mul_f32 v35, v103, v103
    v_fma_f32 v32, v32, v28, v27
    v_fma_f32 v33, v33, v28, v27
    v_fma_f32 v34, v34, v28, v27
    v_fma_f32 v35, v35, v28, v27
    v_mul_f32 v116, v100, v116
    v_mul_f32 v100, v32, v100
    v_mul_f32 v117, v101, v117
    v_mul_f32 v101, v33, v101
    v_mul_f32 v118, v102, v118
    v_mul_f32 v102, v34, v102
    v_mul_f32 v119, v103, v119
    v_mul_f32 v103, v35, v103
    v_exp_f32 v100, v100
    v_exp_f32 v101, v101
    s_add_u32 m0, s38, 90112
    s_mov_b32 s39, 1507328
    buffer_load_dwordx4 v30, s[40:43], s39 offen lds
    v_exp_f32 v102, v102
    v_exp_f32 v103, v103
    v_fma_f32 v100, v100, v29, v29
    v_fma_f32 v101, v101, v29, v29
    v_fma_f32 v102, v102, v29, v29
    v_fma_f32 v103, v103, v29, v29
    v_rcp_f32 v100, v100
    v_rcp_f32 v101, v101
    v_rcp_f32 v102, v102
    v_rcp_f32 v103, v103
    v_mul_f32 v116, v116, v100
    v_mul_f32 v117, v117, v101
    v_mul_f32 v118, v118, v102
    v_mul_f32 v119, v119, v103
    v_cvt_pk_bf16_f32 v98, v116, v117
    v_cvt_pk_bf16_f32 v99, v118, v119
    s_nop 0
    v_permlane16_swap_b32 v96, v98
    v_permlane16_swap_b32 v97, v99
    s_min_u32 s70, s68, s69
    s_lshl_b32 s71, s34, 10
    s_sub_u32 s70, s70, s71
    s_lshl_b32 s71, s36, 11
    s_add_u32 s70, s70, s71
    s_add_u32 s70, s70, 98304
    buffer_store_dwordx4 v[96:99], v3, s[20:23], s70 offen sc0 sc1
    s_waitcnt vmcnt(6)
    v_readfirstlane_b32 s71, v31
    s_cmp_ge_u32 s71, 8
    s_cbranch_scc1 K1_ok_6
    s_mov_b32 s72, 0
K1_poll_5:
    buffer_load_dword v31, off, s[20:23], s96 offset:128 sc0 sc1
    s_waitcnt vmcnt(0)
    v_readfirstlane_b32 s71, v31
    s_add_u32 s72, s72, 1
    s_cmp_ge_u32 s72, 0x20000
    s_cbranch_scc1 K1_ok_6
    s_cmp_lt_u32 s71, 8
    s_cbranch_scc1 K1_poll_5
K1_ok_6:
    v_lshrrev_b32 v32, 5, v0
    v_bfe_u32 v33, v0, 2, 2
    v_lshl_add_u32 v32, v32, 3, v33
    s_lshl_b32 s70, s33, 13
    s_add_u32 s71, s70, 65536
    v_lshl_add_u32 v32, v32, 7, s71
    v_bfe_u32 v33, v0, 3, 1
    v_bfe_u32 v34, v0, 4, 1
    v_lshl_or_b32 v33, v33, 1, v34
    v_xor_b32 v33, s33, v33
    v_lshl_add_u32 v32, v33, 5, v32
    v_and_b32 v33, 1, v0
    v_lshl_add_u32 v32, v33, 4, v32
    v_bfe_u32 v33, v0, 1, 1
    v_lshl_add_u32 v4, v33, 3, v32
    v_xor_b32 v5, 64, v4
    ds_read_b64_tr_b16 v[40:41], v4 offset:32768
    ds_read_b64_tr_b16 v[42:43], v4 offset:33280
    ds_read_b64_tr_b16 v[44:45], v5 offset:32768
    ds_read_b64_tr_b16 v[46:47], v5 offset:33280
    ds_read_b64_tr_b16 v[48:49], v4 offset:34816
    ds_read_b64_tr_b16 v[50:51], v4 offset:35328
    ds_read_b64_tr_b16 v[52:53], v5 offset:34816
    ds_read_b64_tr_b16 v[54:55], v5 offset:35328
    s_lshl_b32 s71, s34, 15
    s_add_u32 s70, s70, s71
    v_add_u32 v16, s70, v2
    v_xor_b32 v13, 0x2000, v16
    v_xor_b32 v14, 0x4000, v16
    v_xor_b32 v15, 0x6000, v16
    v_add_u32 v36, 98304, v13
    v_add_u32 v37, 98304, v14
    v_add_u32 v38, 98304, v15
    v_add_u32 v39, 98304, v16
    v_and_b32 v32, 31, v0
    v_lshrrev_b32 v33, 5, v0
    v_lshlrev_b32 v33, 4, v33
    v_lshl_add_u32 v12, v32, 10, v33
    s_waitcnt lgkmcnt(4)
    v_mfma_f32_32x32x16_bf16 v[96:111], v[40:43], v[128:131], 0
    ds_read_b64_tr_b16 v[56:57], v4 offset:36864
    ds_read_b64_tr_b16 v[58:59], v4 offset:37376
    v_mfma_f32_32x32x16_bf16 v[112:127], v[44:47], v[128:131], 0
    ds_read_b64_tr_b16 v[60:61], v5 offset:36864
    ds_read_b64_tr_b16 v[62:63], v5 offset:37376
    s_add_u32 s93, s94, 0
    buffer_load_dwordx4 v[192:195], v2, s[20:23], s93 offen offset:0 sc0 sc1
    s_waitcnt lgkmcnt(4)
    v_mfma_f32_32x32x16_bf16 v[96:111], v[48:51], v[132:135], v[96:111]
    ds_read_b64_tr_b16 v[40:41], v4 offset:38912
    ds_read_b64_tr_b16 v[42:43], v4 offset:39424
    buffer_load_dwordx4 v[196:199], v2, s[20:23], s93 offen offset:1024 sc0 sc1
    v_mfma_f32_32x32x16_bf16 v[112:127], v[52:55], v[132:135], v[112:127]
    ds_read_b64_tr_b16 v[44:45], v5 offset:38912
    ds_read_b64_tr_b16 v[46:47], v5 offset:39424
    buffer_load_dwordx4 v[200:203], v2, s[20:23], s93 offen offset:2048 sc0 sc1
    s_waitcnt lgkmcnt(4)
    v_mfma_f32_32x32x16_bf16 v[96:111], v[56:59], v[136:139], v[96:111]
    v_add_u32 v4, 0xffff0000, v4
    v_add_u32 v5, 0xffff0000, v5
    ds_read_b64_tr_b16 v[48:49], v4 offset:0
    ds_read_b64_tr_b16 v[50:51], v4 offset:512
    v_mfma_f32_32x32x16_bf16 v[112:127], v[60:63], v[136:139], v[112:127]
    ds_read_b64_tr_b16 v[52:53], v5 offset:0
    ds_read_b64_tr_b16 v[54:55], v5 offset:512
    buffer_load_dwordx4 v[204:207], v2, s[20:23], s93 offen offset:3072 sc0 sc1
    s_waitcnt lgkmcnt(4)
    v_mfma_f32_32x32x16_bf16 v[96:111], v[40:43], v[140:143], v[96:111]
    ds_read_b64_tr_b16 v[56:57], v4 offset:2048
    ds_read_b64_tr_b16 v[58:59], v4 offset:2560
    s_add_u32 s93, s94, 16384
    buffer_load_dwordx4 v[208:211], v2, s[20:23], s93 offen offset:0 sc0 sc1
    v_mfma_f32_32x32x16_bf16 v[112:127], v[44:47], v[140:143], v[112:127]
    ds_read_b64_tr_b16 v[60:61], v5 offset:2048
    ds_read_b64_tr_b16 v[62:63], v5 offset:2560
    buffer_load_dwordx4 v[212:215], v2, s[20:23], s93 offen offset:1024 sc0 sc1
    s_waitcnt lgkmcnt(4)
    v_mfma_f32_32x32x16_bf16 v[96:111], v[48:51], v[144:147], v[96:111]
    ds_read_b64_tr_b16 v[40:41], v4 offset:4096
    ds_read_b64_tr_b16 v[42:43], v4 offset:4608
    v_mfma_f32_32x32x16_bf16 v[112:127], v[52:55], v[144:147], v[112:127]
    ds_read_b64_tr_b16 v[44:45], v5 offset:4096
    ds_read_b64_tr_b16 v[46:47], v5 offset:4608
    buffer_load_dwordx4 v[216:219], v2, s[20:23], s93 offen offset:2048 sc0 sc1
    s_waitcnt lgkmcnt(4)
    v_mfma_f32_32x32x16_bf16 v[96:111], v[56:59], v[148:151], v[96:111]
    ds_read_b64_tr_b16 v[48:49], v4 offset:6144
    ds_read_b64_tr_b16 v[50:51], v4 offset:6656
    v_mfma_f32_32x32x16_bf16 v[112:127], v[60:63], v[148:151], v[112:127]
    ds_read_b64_tr_b16 v[52:53], v5 offset:6144
    ds_read_b64_tr_b16 v[54:55], v5 offset:6656
    buffer_load_dwordx4 v[220:223], v2, s[20:23], s93 offen offset:3072 sc0 sc1
    s_waitcnt lgkmcnt(4)
    v_mfma_f32_32x32x16_bf16 v[96:111], v[40:43], v[152:155], v[96:111]
    s_waitcnt vmcnt(9)
    s_waitcnt lgkmcnt(0)
    s_barrier
    ds_read_b64_tr_b16 v[56:57], v4 offset:32768
    ds_read_b64_tr_b16 v[58:59], v4 offset:33280
    v_mfma_f32_32x32x16_bf16 v[112:127], v[44:47], v[152:155], v[112:127]
    ds_read_b64_tr_b16 v[60:61], v5 offset:32768
    ds_read_b64_tr_b16 v[62:63], v5 offset:33280
    s_add_u32 m0, s38, 155648
    s_mov_b32 s39, 196608
    buffer_load_dwordx4 v30, s[40:43], s39 offen lds
    v_mfma_f32_32x32x16_bf16 v[96:111], v[48:51], v[156:159], v[96:111]
    ds_read_b64_tr_b16 v[40:41], v4 offset:34816
    ds_read_b64_tr_b16 v[42:43], v4 offset:35328
    v_mfma_f32_32x32x16_bf16 v[112:127], v[52:55], v[156:159], v[112:127]
    ds_read_b64_tr_b16 v[44:45], v5 offset:34816
    ds_read_b64_tr_b16 v[46:47], v5 offset:35328
    s_add_u32 m0, s38, 98304
    s_mov_b32 s39, 262144
    buffer_load_dwordx4 v30, s[40:43], s39 offen lds
    v_max3_u32 v32, v160, v161, v162
    v_max_u32 v32, v32, v163
    v_cmp_eq_u32 vcc, -1, v32
    s_cbranch_vccnz K1_re_7
K1_bk_9:
    s_waitcnt lgkmcnt(4)
    v_mfma_f32_32x32x16_bf16 v[96:111], v[56:59], v[160:163], v[96:111]
    ds_read_b64_tr_b16 v[48:49], v4 offset:36864
    ds_read_b64_tr_b16 v[50:51], v4 offset:37376
    s_add_u32 m0, s38, 106496
    s_mov_b32 s39, 327680
    buffer_load_dwordx4 v30, s[40:43], s39 offen lds
    v_mfma_f32_32x32x16_bf16 v[112:127], v[60:63], v[160:163], v[112:127]
    ds_read_b64_tr_b16 v[52:53], v5 offset:36864
    ds_read_b64_tr_b16 v[54:55], v5 offset:37376
    v_max3_u32 v32, v164, v165, v166
    v_max_u32 v32, v32, v167
    v_cmp_eq_u32 vcc, -1, v32
    s_cbranch_vccnz K1_re_10
K1_bk_12:
    s_waitcnt lgkmcnt(4)
    v_mfma_f32_32x32x16_bf16 v[96:111], v[40:43], v[164:167], v[96:111]
    ds_read_b64_tr_b16 v[56:57], v4 offset:38912
    ds_read_b64_tr_b16 v[58:59], v4 offset:39424
    s_add_u32 m0, s38, 114688
    s_mov_b32 s39, 393216
    buffer_load_dwordx4 v30, s[40:43], s39 offen lds
    v_mfma_f32_32x32x16_bf16 v[112:127], v[44:47], v[164:167], v[112:127]
    ds_read_b64_tr_b16 v[60:61], v5 offset:38912
    ds_read_b64_tr_b16 v[62:63], v5 offset:39424
    v_max3_u32 v32, v168, v169, v170
    v_max_u32 v32, v32, v171
    v_cmp_eq_u32 vcc, -1, v32
    s_cbranch_vccnz K1_re_13
K1_bk_15:
    s_waitcnt lgkmcnt(4)
    v_mfma_f32_32x32x16_bf16 v[96:111], v[48:51], v[168:171], v[96:111]
    v_add_u32 v4, 0x10000, v4
    v_add_u32 v5, 0x10000, v5
    ds_read_b64_tr_b16 v[40:41], v4 offset:0
    ds_read_b64_tr_b16 v[42:43], v4 offset:512
    s_add_u32 m0, s38, 122880
    s_mov_b32 s39, 458752
    buffer_load_dwordx4 v30, s[40:43], s39 offen lds
    v_mfma_f32_32x32x16_bf16 v[112:127], v[52:55], v[168:171], v[112:127]
    ds_read_b64_tr_b16 v[44:45], v5 offset:0
    ds_read_b64_tr_b16 v[46:47], v5 offset:512
    s_add_u32 m0, s38, 0
    s_mov_b32 s39, 1572864
    buffer_load_dwordx4 v30, s[40:43], s39 offen lds
    v_max3_u32 v32, v172, v173, v174
    v_max_u32 v32, v32, v175
    v_cmp_eq_u32 vcc, -1, v32
    s_cbranch_vccnz K1_re_16
K1_bk_18:
    s_waitcnt lgkmcnt(4)
    v_mfma_f32_32x32x16_bf16 v[96:111], v[56:59], v[172:175], v[96:111]
    ds_read_b64_tr_b16 v[48:49], v4 offset:2048
    ds_read_b64_tr_b16 v[50:51], v4 offset:2560
    v_mfma_f32_32x32x16_bf16 v[112:127], v[60:63], v[172:175], v[112:127]
    ds_read_b64_tr_b16 v[52:53], v5 offset:2048
    ds_read_b64_tr_b16 v[54:55], v5 offset:2560
    s_add_u32 m0, s38, 8192
    s_mov_b32 s39, 1638400
    buffer_load_dwordx4 v30, s[40:43], s39 offen lds
    v_max3_u32 v32, v176, v177, v178
    v_max_u32 v32, v32, v179
    v_cmp_eq_u32 vcc, -1, v32
    s_cbranch_vccnz K1_re_19
K1_bk_21:
    s_waitcnt lgkmcnt(4)
    v_mfma_f32_32x32x16_bf16 v[96:111], v[40:43], v[176:179], v[96:111]
    ds_read_b64_tr_b16 v[56:57], v4 offset:4096
    ds_read_b64_tr_b16 v[58:59], v4 offset:4608
    v_mfma_f32_32x32x16_bf16 v[112:127], v[44:47], v[176:179], v[112:127]
    ds_read_b64_tr_b16 v[60:61], v5 offset:4096
    ds_read_b64_tr_b16 v[62:63], v5 offset:4608
    s_add_u32 m0, s38, 16384
    s_mov_b32 s39, 1703936
    buffer_load_dwordx4 v30, s[40:43], s39 offen lds
    v_max3_u32 v32, v180, v181, v182
    v_max_u32 v32, v32, v183
    v_cmp_eq_u32 vcc, -1, v32
    s_cbranch_vccnz K1_re_22
K1_bk_24:
    s_waitcnt lgkmcnt(4)
    v_mfma_f32_32x32x16_bf16 v[96:111], v[48:51], v[180:183], v[96:111]
    ds_read_b64_tr_b16 v[40:41], v4 offset:6144
    ds_read_b64_tr_b16 v[42:43], v4 offset:6656
    s_add_u32 m0, s38, 24576
    s_mov_b32 s39, 1769472
    buffer_load_dwordx4 v30, s[40:43], s39 offen lds
    v_mfma_f32_32x32x16_bf16 v[112:127], v[52:55], v[180:183], v[112:127]
    ds_read_b64_tr_b16 v[44:45], v5 offset:6144
    ds_read_b64_tr_b16 v[46:47], v5 offset:6656
    v_max3_u32 v32, v184, v185, v186
    v_max_u32 v32, v32, v187
    v_cmp_eq_u32 vcc, -1, v32
    s_cbranch_vccnz K1_re_25
K1_bk_27:
    s_waitcnt lgkmcnt(4)
    v_mfma_f32_32x32x16_bf16 v[96:111], v[56:59], v[184:187], v[96:111]
    s_waitcnt vmcnt(8)
    s_waitcnt lgkmcnt(0)
    s_barrier
    v_add_u32 v4, 0x10000, v4
    v_add_u32 v5, 0x10000, v5
    ds_read_b64_tr_b16 v[48:49], v4 offset:0
    ds_read_b64_tr_b16 v[50:51], v4 offset:512
    s_add_u32 s93, s94, 98304
    buffer_load_dwordx4 v[64:67], v2, s[20:23], s93 offen offset:0 sc0 sc1
    v_mfma_f32_32x32x16_bf16 v[112:127], v[60:63], v[184:187], v[112:127]
    ds_read_b64_tr_b16 v[52:53], v5 offset:0
    ds_read_b64_tr_b16 v[54:55], v5 offset:512
    buffer_load_dwordx4 v[68:71], v2, s[20:23], s93 offen offset:1024 sc0 sc1
    v_max3_u32 v32, v188, v189, v190
    v_max_u32 v32, v32, v191
    v_cmp_eq_u32 vcc, -1, v32
    s_cbranch_vccnz K1_re_28
K1_bk_30:
    v_mfma_f32_32x32x16_bf16 v[96:111], v[40:43], v[188:191], v[96:111]
    ds_read_b64_tr_b16 v[56:57], v4 offset:2048
    ds_read_b64_tr_b16 v[58:59], v4 offset:2560
    v_mfma_f32_32x32x16_bf16 v[112:127], v[44:47], v[188:191], v[112:127]
    ds_read_b64_tr_b16 v[60:61], v5 offset:2048
    ds_read_b64_tr_b16 v[62:63], v5 offset:2560
    buffer_load_dwordx4 v[72:75], v2, s[20:23], s93 offen offset:2048 sc0 sc1
    v_max3_u32 v32, v192, v193, v194
    v_max_u32 v32, v32, v195
    v_cmp_eq_u32 vcc, -1, v32
    s_cbranch_vccnz K1_re_31
K1_bk_33:
    s_waitcnt lgkmcnt(4)
    v_mfma_f32_32x32x16_bf16 v[96:111], v[48:51], v[192:195], v[96:111]
    ds_read_b64_tr_b16 v[40:41], v4 offset:4096
    ds_read_b64_tr_b16 v[42:43], v4 offset:4608
    buffer_load_dwordx4 v[76:79], v2, s[20:23], s93 offen offset:3072 sc0 sc1
    v_mfma_f32_32x32x16_bf16 v[112:127], v[52:55], v[192:195], v[112:127]
    ds_read_b64_tr_b16 v[44:45], v5 offset:4096
    ds_read_b64_tr_b16 v[46:47], v5 offset:4608
    v_max3_u32 v32, v196, v197, v198
    v_max_u32 v32, v32, v199
    v_cmp_eq_u32 vcc, -1, v32
    s_cbranch_vccnz K1_re_34
K1_bk_36:
    s_waitcnt lgkmcnt(4)
    v_mfma_f32_32x32x16_bf16 v[96:111], v[56:59], v[196:199], v[96:111]
    ds_read_b64_tr_b16 v[48:49], v4 offset:6144
    ds_read_b64_tr_b16 v[50:51], v4 offset:6656
    s_add_u32 m0, s38, 32768
    s_nop 0
    buffer_load_dwordx4 v30, s[44:47], 0 offen lds
    v_mfma_f32_32x32x16_bf16 v[112:127], v[60:63], v[196:199], v[112:127]
    ds_read_b64_tr_b16 v[52:53], v5 offset:6144
    ds_read_b64_tr_b16 v[54:55], v5 offset:6656
    s_add_u32 m0, s38, 40960
    s_mov_b32 s39, 65536
    buffer_load_dwordx4 v30, s[44:47], s39 offen lds
    v_max3_u32 v32, v200, v201, v202
    v_max_u32 v32, v32, v203
    v_cmp_eq_u32 vcc, -1, v32
    s_cbranch_vccnz K1_re_37
K1_bk_39:
    s_waitcnt lgkmcnt(4)
    v_mfma_f32_32x32x16_bf16 v[96:111], v[40:43], v[200:203], v[96:111]
    s_waitcnt vmcnt(10)
    s_waitcnt lgkmcnt(0)
    s_barrier
    v_add_u32 v4, 0xffff0000, v4
    v_add_u32 v5, 0xffff0000, v5
    ds_read_b64_tr_b16 v[56:57], v4 offset:32768
    ds_read_b64_tr_b16 v[58:59], v4 offset:33280
    v_mfma_f32_32x32x16_bf16 v[112:127], v[44:47], v[200:203], v[112:127]
    ds_read_b64_tr_b16 v[60:61], v5 offset:32768
    ds_read_b64_tr_b16 v[62:63], v5 offset:33280
    s_add_u32 m0, s38, 49152
    s_mov_b32 s39, 131072
    buffer_load_dwordx4 v30, s[44:47], s39 offen lds
    v_max3_u32 v32, v204, v205, v206
    v_max_u32 v32, v32, v207
    v_cmp_eq_u32 vcc, -1, v32
    s_cbranch_vccnz K1_re_40
K1_bk_42:
    v_mfma_f32_32x32x16_bf16 v[96:111], v[48:51], v[204:207], v[96:111]
    ds_read_b64_tr_b16 v[40:41], v4 offset:34816
    ds_read_b64_tr_b16 v[42:43], v4 offset:35328
    s_add_u32 m0, s38, 57344
    s_mov_b32 s39, 196608
    buffer_load_dwordx4 v30, s[44:47], s39 offen lds
    v_mfma_f32_32x32x16_bf16 v[112:127], v[52:55], v[204:207], v[112:127]
    ds_read_b64_tr_b16 v[44:45], v5 offset:34816
    ds_read_b64_tr_b16 v[46:47], v5 offset:35328
    s_add_u32 s93, s94, 114688
    buffer_load_dwordx4 v[224:227], v2, s[20:23], s93 offen offset:0 sc0 sc1
    v_max3_u32 v32, v208, v209, v210
    v_max_u32 v32, v32, v211
    v_cmp_eq_u32 vcc, -1, v32
    s_cbranch_vccnz K1_re_43
K1_bk_45:
    s_waitcnt lgkmcnt(4)
    v_mfma_f32_32x32x16_bf16 v[96:111], v[56:59], v[208:211], v[96:111]
    ds_read_b64_tr_b16 v[48:49], v4 offset:36864
    ds_read_b64_tr_b16 v[50:51], v4 offset:37376
    v_mfma_f32_32x32x16_bf16 v[112:127], v[60:63], v[208:211], v[112:127]
    ds_read_b64_tr_b16 v[52:53], v5 offset:36864
    ds_read_b64_tr_b16 v[54:55], v5 offset:37376
    buffer_load_dwordx4 v[228:231], v2, s[20:23], s93 offen offset:1024 sc0 sc1
    v_max3_u32 v32, v212, v213, v214
    v_max_u32 v32, v32, v215
    v_cmp_eq_u32 vcc, -1, v32
    s_cbranch_vccnz K1_re_46
K1_bk_48:
    s_waitcnt lgkmcnt(4)
    v_mfma_f32_32x32x16_bf16 v[96:111], v[40:43], v[212:215], v[96:111]
    ds_read_b64_tr_b16 v[56:57], v4 offset:38912
    ds_read_b64_tr_b16 v[58:59], v4 offset:39424
    buffer_load_dwordx4 v[232:235], v2, s[20:23], s93 offen offset:2048 sc0 sc1
    v_mfma_f32_32x32x16_bf16 v[112:127], v[44:47], v[212:215], v[112:127]
    ds_read_b64_tr_b16 v[60:61], v5 offset:38912
    ds_read_b64_tr_b16 v[62:63], v5 offset:39424
    buffer_load_dwordx4 v[236:239], v2, s[20:23], s93 offen offset:3072 sc0 sc1
    v_max3_u32 v32, v216, v217, v218
    v_max_u32 v32, v32, v219
    v_cmp_eq_u32 vcc, -1, v32
    s_cbranch_vccnz K1_re_49
K1_bk_51:
    s_waitcnt lgkmcnt(4)
    v_mfma_f32_32x32x16_bf16 v[96:111], v[48:51], v[216:219], v[96:111]
    s_waitcnt vmcnt(12)
    s_waitcnt lgkmcnt(0)
    s_barrier
    v_add_u32 v4, 0xffff0000, v4
    v_add_u32 v5, 0xffff0000, v5
    ds_read_b64_tr_b16 v[40:41], v4 offset:0
    ds_read_b64_tr_b16 v[42:43], v4 offset:512
    v_mfma_f32_32x32x16_bf16 v[112:127], v[52:55], v[216:219], v[112:127]
    ds_read_b64_tr_b16 v[44:45], v5 offset:0
    ds_read_b64_tr_b16 v[46:47], v5 offset:512
    s_add_u32 m0, s38, 65536
    s_mov_b32 s39, 262144
    buffer_load_dwordx4 v30, s[44:47], s39 offen lds
    v_max3_u32 v32, v220, v221, v222
    v_max_u32 v32, v32, v223
    v_cmp_eq_u32 vcc, -1, v32
    s_cbranch_vccnz K1_re_52
K1_bk_54:
    v_mfma_f32_32x32x16_bf16 v[96:111], v[56:59], v[220:223], v[96:111]
    ds_read_b64_tr_b16 v[48:49], v4 offset:2048
    ds_read_b64_tr_b16 v[50:51], v4 offset:2560
    s_add_u32 m0, s38, 73728
    s_mov_b32 s39, 327680
    buffer_load_dwordx4 v30, s[44:47], s39 offen lds
    v_mfma_f32_32x32x16_bf16 v[112:127], v[60:63], v[220:223], v[112:127]
    ds_read_b64_tr_b16 v[52:53], v5 offset:2048
    ds_read_b64_tr_b16 v[54:55], v5 offset:2560
    s_add_u32 m0, s38, 81920
    s_mov_b32 s39, 393216
    buffer_load_dwordx4 v30, s[44:47], s39 offen lds
    s_waitcnt vmcnt(14)
    v_max3_u32 v32, v64, v65, v66
    v_max_u32 v32, v32, v67
    v_cmp_eq_u32 vcc, -1, v32
    s_cbranch_vccnz K1_re_55
K1_bk_57:
    s_waitcnt lgkmcnt(4)
    v_mfma_f32_32x32x16_bf16 v[96:111], v[40:43], v[64:67], v[96:111]
    ds_read_b64_tr_b16 v[56:57], v4 offset:4096
    ds_read_b64_tr_b16 v[58:59], v4 offset:4608
    v_mfma_f32_32x32x16_bf16 v[112:127], v[44:47], v[64:67], v[112:127]
    ds_read_b64_tr_b16 v[60:61], v5 offset:4096
    ds_read_b64_tr_b16 v[62:63], v5 offset:4608
    s_add_u32 m0, s38, 90112
    s_mov_b32 s39, 458752
    buffer_load_dwordx4 v30, s[44:47], s39 offen lds
    s_waitcnt vmcnt(14)
    v_max3_u32 v32, v68, v69, v70
    v_max_u32 v32, v32, v71
    v_cmp_eq_u32 vcc, -1, v32
    s_cbranch_vccnz K1_re_58
K1_bk_60:
    s_waitcnt lgkmcnt(4)
    v_mfma_f32_32x32x16_bf16 v[96:111], v[48:51], v[68:71], v[96:111]
    ds_read_b64_tr_b16 v[40:41], v4 offset:6144
    ds_read_b64_tr_b16 v[42:43], v4 offset:6656
    buffer_load_dwordx4 v[8:11], v12, s[4:7], s98 offen
    v_mfma_f32_32x32x16_bf16 v[112:127], v[52:55], v[68:71], v[112:127]
    ds_read_b64_tr_b16 v[44:45], v5 offset:6144
    ds_read_b64_tr_b16 v[46:47], v5 offset:6656
    s_add_u32 s93, s94, 131072
    buffer_load_dwordx4 v[240:243], v2, s[20:23], s93 offen offset:0 sc0 sc1
    s_waitcnt vmcnt(15)
    v_max3_u32 v32, v72, v73, v74
    v_max_u32 v32, v32, v75
    v_cmp_eq_u32 vcc, -1, v32
    s_cbranch_vccnz K1_re_61
K1_bk_63:
    s_waitcnt lgkmcnt(4)
    v_mfma_f32_32x32x16_bf16 v[96:111], v[56:59], v[72:75], v[96:111]
    s_waitcnt vmcnt(10)
    s_waitcnt lgkmcnt(0)
    s_barrier
    ds_read_b64_tr_b16 v[48:49], v4 offset:32768
    ds_read_b64_tr_b16 v[50:51], v4 offset:33280
    v_mfma_f32_32x32x16_bf16 v[112:127], v[60:63], v[72:75], v[112:127]
    ds_read_b64_tr_b16 v[52:53], v5 offset:32768
    ds_read_b64_tr_b16 v[54:55], v5 offset:33280
    buffer_load_dwordx4 v[244:247], v2, s[20:23], s93 offen offset:1024 sc0 sc1
    v_max3_u32 v32, v76, v77, v78
    v_max_u32 v32, v32, v79
    v_cmp_eq_u32 vcc, -1, v32
    s_cbranch_vccnz K1_re_64
K1_bk_66:
    v_mfma_f32_32x32x16_bf16 v[96:111], v[40:43], v[76:79], v[96:111]
    ds_read_b64_tr_b16 v[56:57], v4 offset:34816
    ds_read_b64_tr_b16 v[58:59], v4 offset:35328
    buffer_load_dwordx4 v[248:251], v2, s[20:23], s93 offen offset:2048 sc0 sc1
    v_mfma_f32_32x32x16_bf16 v[112:127], v[44:47], v[76:79], v[112:127]
    ds_read_b64_tr_b16 v[60:61], v5 offset:34816
    ds_read_b64_tr_b16 v[62:63], v5 offset:35328
    buffer_load_dwordx4 v[252:255], v2, s[20:23], s93 offen offset:3072 sc0 sc1
    s_waitcnt vmcnt(12)
    v_max3_u32 v32, v224, v225, v226
    v_max_u32 v32, v32, v227
    v_cmp_eq_u32 vcc, -1, v32
    s_cbranch_vccnz K1_re_67
K1_bk_69:
    s_waitcnt lgkmcnt(4)
    v_mfma_f32_32x32x16_bf16 v[160:175], v[48:51], v[224:227], 0
    ds_read_b64_tr_b16 v[40:41], v4 offset:36864
    ds_read_b64_tr_b16 v[42:43], v4 offset:37376
    v_mfma_f32_32x32x16_bf16 v[176:191], v[52:55], v[224:227], 0
    ds_read_b64_tr_b16 v[44:45], v5 offset:36864
    ds_read_b64_tr_b16 v[46:47], v5 offset:37376
    ds_write_b128 v37, v[112:115] offset:4096
    s_waitcnt vmcnt(11)
    v_max3_u32 v32, v228, v229, v230
    v_max_u32 v32, v32, v231
    v_cmp_eq_u32 vcc, -1, v32
    s_cbranch_vccnz K1_re_70
K1_bk_72:
    s_waitcnt lgkmcnt(5)
    v_mfma_f32_32x32x16_bf16 v[160:175], v[56:59], v[228:231], v[160:175]
    ds_read_b64_tr_b16 v[48:49], v4 offset:38912
    ds_read_b64_tr_b16 v[50:51], v4 offset:39424
    v_mfma_f32_32x32x16_bf16 v[176:191], v[60:63], v[228:231], v[176:191]
    ds_read_b64_tr_b16 v[52:53], v5 offset:38912
    ds_read_b64_tr_b16 v[54:55], v5 offset:39424
    ds_write_b128 v37, v[116:119] offset:5120
    s_waitcnt vmcnt(10)
    v_max3_u32 v32, v232, v233, v234
    v_max_u32 v32, v32, v235
    v_cmp_eq_u32 vcc, -1, v32
    s_cbranch_vccnz K1_re_73
K1_bk_75:
    s_waitcnt lgkmcnt(6)
    v_mfma_f32_32x32x16_bf16 v[160:175], v[40:43], v[232:235], v[160:175]
    s_waitcnt vmcnt(5)
    s_waitcnt lgkmcnt(0)
    s_barrier
    v_add_u32 v4, 0x10000, v4
    v_add_u32 v5, 0x10000, v5
    ds_read_b64_tr_b16 v[56:57], v4 offset:0
    ds_read_b64_tr_b16 v[58:59], v4 offset:512
    v_mfma_f32_32x32x16_bf16 v[176:191], v[44:47], v[232:235], v[176:191]
    ds_read_b64_tr_b16 v[60:61], v5 offset:0
    ds_read_b64_tr_b16 v[62:63], v5 offset:512
    ds_write_b128 v38, v[120:123] offset:6144
    v_max3_u32 v32, v236, v237, v238
    v_max_u32 v32, v32, v239
    v_cmp_eq_u32 vcc, -1, v32
    s_cbranch_vccnz K1_re_76
K1_bk_78:
    v_mfma_f32_32x32x16_bf16 v[160:175], v[48:51], v[236:239], v[160:175]
    ds_read_b64_tr_b16 v[40:41], v4 offset:2048
    ds_read_b64_tr_b16 v[42:43], v4 offset:2560
    v_mfma_f32_32x32x16_bf16 v[176:191], v[52:55], v[236:239], v[176:191]
    ds_read_b64_tr_b16 v[44:45], v5 offset:2048
    ds_read_b64_tr_b16 v[46:47], v5 offset:2560
    ds_write_b128 v38, v[124:127] offset:7168
    s_waitcnt vmcnt(3)
    v_max3_u32 v32, v240, v241, v242
    v_max_u32 v32, v32, v243
    v_cmp_eq_u32 vcc, -1, v32
    s_cbranch_vccnz K1_re_79
K1_bk_81:
    s_waitcnt lgkmcnt(6)
    v_mfma_f32_32x32x16_bf16 v[160:175], v[56:59], v[240:243], v[160:175]
    ds_read_b64_tr_b16 v[48:49], v4 offset:4096
    ds_read_b64_tr_b16 v[50:51], v4 offset:4608
    v_mfma_f32_32x32x16_bf16 v[176:191], v[60:63], v[240:243], v[176:191]
    ds_read_b64_tr_b16 v[52:53], v5 offset:4096
    ds_read_b64_tr_b16 v[54:55], v5 offset:4608
    ds_write_b128 v36, v[104:107] offset:2048
    s_waitcnt vmcnt(2)
    v_max3_u32 v32, v244, v245, v246
    v_max_u32 v32, v32, v247
    v_cmp_eq_u32 vcc, -1, v32
    s_cbranch_vccnz K1_re_82
K1_bk_84:
    s_waitcnt lgkmcnt(6)
    v_mfma_f32_32x32x16_bf16 v[160:175], v[40:43], v[244:247], v[160:175]
    ds_read_b64_tr_b16 v[56:57], v4 offset:6144
    ds_read_b64_tr_b16 v[58:59], v4 offset:6656
    v_mfma_f32_32x32x16_bf16 v[176:191], v[44:47], v[244:247], v[176:191]
    ds_read_b64_tr_b16 v[60:61], v5 offset:6144
    ds_read_b64_tr_b16 v[62:63], v5 offset:6656
    ds_write_b128 v36, v[108:111] offset:3072
    s_waitcnt vmcnt(1)
    v_max3_u32 v32, v248, v249, v250
    v_max_u32 v32, v32, v251
    v_cmp_eq_u32 vcc, -1, v32
    s_cbranch_vccnz K1_re_85
K1_bk_87:
    s_waitcnt lgkmcnt(6)
    v_mfma_f32_32x32x16_bf16 v[160:175], v[48:51], v[248:251], v[160:175]
    s_waitcnt lgkmcnt(0)
    s_barrier
    ds_read_b128 v[128:131], v39 offset:2048
    ds_read_b128 v[132:135], v39 offset:3072
    ds_read_b128 v[136:139], v39 offset:4096
    ds_read_b128 v[140:143], v39 offset:5120
    ds_read_b128 v[144:147], v39 offset:6144
    ds_read_b128 v[148:151], v39 offset:7168
    v_mfma_f32_32x32x16_bf16 v[176:191], v[52:55], v[248:251], v[176:191]
    v_lshlrev_b32 v152, 16, v8
    v_and_b32 v153, 0xffff0000, v8
    v_lshlrev_b32 v154, 16, v9
    v_and_b32 v155, 0xffff0000, v9
    s_waitcnt vmcnt(0)
    v_max3_u32 v32, v252, v253, v254
    v_max_u32 v32, v32, v255
    v_cmp_eq_u32 vcc, -1, v32
    s_cbranch_vccnz K1_re_88
K1_bk_90:
    v_mfma_f32_32x32x16_bf16 v[160:175], v[56:59], v[252:255], v[160:175]
    v_lshlrev_b32 v156, 16, v10
    v_and_b32 v157, 0xffff0000, v10
    v_lshlrev_b32 v158, 16, v11
    v_and_b32 v159, 0xffff0000, v11
    v_mfma_f32_32x32x16_bf16 v[176:191], v[60:63], v[252:255], v[176:191]
    s_waitcnt lgkmcnt(5)
    v_add_f32 v128, v128, v96
    v_add_f32 v129, v129, v97
    v_add_f32 v130, v130, v98
    v_add_f32 v131, v131, v99
    s_waitcnt lgkmcnt(4)
    v_add_f32 v132, v132, v100
    v_add_f32 v133, v133, v101
    v_add_f32 v134, v134, v102
    v_add_f32 v135, v135, v103
    s_waitcnt lgkmcnt(1)
    v_add_f32 v136, v136, v144
    v_add_f32 v137, v137, v145
    v_add_f32 v138, v138, v146
    v_add_f32 v139, v139, v147
    s_waitcnt lgkmcnt(0)
    v_add_f32 v140, v140, v148
    v_add_f32 v141, v141, v149
    v_add_f32 v142, v142, v150
    v_add_f32 v143, v143, v151
    ds_write_b128 v14, v[176:179] offset:4096
    v_add_f32 v128, v128, v136
    v_add_f32 v129, v129, v137
    v_add_f32 v130, v130, v138
    v_add_f32 v131, v131, v139
    v_add_f32 v132, v132, v140
    v_add_f32 v133, v133, v141
    v_add_f32 v134, v134, v142
    v_add_f32 v135, v135, v143
    v_mul_f32 v136, 0xbfb8aa3b, v128
    v_mul_f32 v137, 0xbfb8aa3b, v129
    v_mul_f32 v138, 0xbfb8aa3b, v130
    v_mul_f32 v139, 0xbfb8aa3b, v131
    ds_write_b128 v14, v[180:183] offset:5120
    v_mul_f32 v140, 0xbfb8aa3b, v132
    v_mul_f32 v141, 0xbfb8aa3b, v133
    v_mul_f32 v142, 0xbfb8aa3b, v134
    v_mul_f32 v143, 0xbfb8aa3b, v135
    v_exp_f32 v136, v136
    v_exp_f32 v137, v137
    v_exp_f32 v138, v138
    v_exp_f32 v139, v139
    ds_write_b128 v15, v[184:187] offset:6144
    v_exp_f32 v140, v140
    v_exp_f32 v141, v141
    v_exp_f32 v142, v142
    v_exp_f32 v143, v143
    v_add_f32 v136, 1.0, v136
    v_add_f32 v137, 1.0, v137
    v_add_f32 v138, 1.0, v138
    v_add_f32 v139, 1.0, v139
    ds_write_b128 v15, v[188:191] offset:7168
    v_add_f32 v140, 1.0, v140
    v_add_f32 v141, 1.0, v141
    v_add_f32 v142, 1.0, v142
    v_add_f32 v143, 1.0, v143
    v_rcp_f32 v136, v136
    v_rcp_f32 v137, v137
    v_rcp_f32 v138, v138
    v_rcp_f32 v139, v139
    ds_write_b128 v13, v[168:171] offset:2048
    v_rcp_f32 v140, v140
    v_rcp_f32 v141, v141
    v_rcp_f32 v142, v142
    v_rcp_f32 v143, v143
    v_mul_f32 v128, v128, v136
    v_mul_f32 v129, v129, v137
    v_mul_f32 v130, v130, v138
    v_mul_f32 v131, v131, v139
    ds_write_b128 v13, v[172:175] offset:3072
    v_mul_f32 v132, v132, v140
    v_mul_f32 v133, v133, v141
    s_waitcnt lgkmcnt(0)
    s_barrier
    ds_read_b128 v[192:195], v16 offset:2048
    ds_read_b128 v[196:199], v16 offset:3072
    ds_read_b128 v[200:203], v16 offset:4096
    ds_read_b128 v[204:207], v16 offset:5120
    ds_read_b128 v[208:211], v16 offset:6144
    ds_read_b128 v[212:215], v16 offset:7168
    v_mul_f32 v134, v134, v142
    v_mul_f32 v135, v135, v143
    s_waitcnt lgkmcnt(5)
    v_add_f32 v160, v160, v192
    v_add_f32 v161, v161, v193
    v_add_f32 v162, v162, v194
    v_add_f32 v163, v163, v195
    s_waitcnt lgkmcnt(4)
    v_add_f32 v164, v164, v196
    v_add_f32 v165, v165, v197
    v_add_f32 v166, v166, v198
    v_add_f32 v167, v167, v199
    s_waitcnt lgkmcnt(3)
    v_add_f32 v160, v160, v200
    v_add_f32 v161, v161, v201
    v_add_f32 v162, v162, v202
    v_add_f32 v163, v163, v203
    s_waitcnt lgkmcnt(2)
    v_add_f32 v164, v164, v204
    v_add_f32 v165, v165, v205
    v_add_f32 v166, v166, v206
    v_add_f32 v167, v167, v207
    s_waitcnt lgkmcnt(1)
    v_add_f32 v160, v160, v208
    v_add_f32 v161, v161, v209
    v_add_f32 v162, v162, v210
    v_add_f32 v163, v163, v211
    s_waitcnt lgkmcnt(0)
    v_add_f32 v164, v164, v212
    v_add_f32 v165, v165, v213
    v_add_f32 v166, v166, v214
    v_add_f32 v167, v167, v215
    v_fmac_f32 v152, v160, v128
    v_fmac_f32 v153, v161, v129
    v_fmac_f32 v154, v162, v130
    v_fmac_f32 v155, v163, v131
    v_fmac_f32 v156, v164, v132
    v_fmac_f32 v157, v165, v133
    v_fmac_f32 v158, v166, v134
    v_fmac_f32 v159, v167, v135
    v_cvt_pk_bf16_f32 v152, v152, v153
    v_cvt_pk_bf16_f32 v153, v154, v155
    v_cvt_pk_bf16_f32 v154, v156, v157
    v_cvt_pk_bf16_f32 v155, v158, v159
    buffer_store_dwordx4 v[152:155], v12, s[48:51], s98 offen
    s_endpgm
K1_TYPEB:
    s_add_u32 m0, s38, 0
    s_nop 0
    buffer_load_dwordx4 v64, s[4:7], 0 offen lds
    s_add_u32 m0, s38, 16384
    s_nop 0
    buffer_load_dwordx4 v2, s[12:15], 0 offen lds
    s_add_u32 m0, s38, 8192
    s_mov_b32 s39, 65536
    buffer_load_dwordx4 v64, s[4:7], s39 offen lds
    s_add_u32 m0, s38, 24576
    s_nop 0
    buffer_load_dwordx4 v2, s[16:19], 0 offen lds
    s_mov_b32 s22, 9519104
    s_mov_b32 s23, 0x20000
    s_mov_b32 s26, 16384
    s_mov_b32 s27, 0x20000
    s_mov_b32 s30, 256
    s_mov_b32 s31, 0x20000
    s_mov_b32 s42, 1835008
    s_mov_b32 s43, 0x20000
    s_mov_b32 s46, 524288
    s_mov_b32 s47, 0x20000
    s_mov_b32 s50, 2097152
    s_mov_b32 s51, 0x20000
    v_and_b32 v0, 63, v0
    s_and_b32 s33, s32, 3
    s_lshr_b32 s34, s32, 2
    v_lshlrev_b32 v34, 2, v34
    v_xor_b32 v33, v33, v34
    s_lshr_b32 s70, s2, 5
    s_lshl_b32 s70, s70, 7
    v_lshl_add_u32 v33, v33, 4, s70
    v_lshl_add_u32 v30, v32, 10, v33
    s_mul_i32 s90, s36, 10240
    s_add_u32 s90, s90, 9437184
    v_lshl_add_u32 v32, v0, 4, s38
    s_cmp_eq_u32 s35, 0
    s_cselect_b32 s70, s90, 2146435072
    v_mov_b32 v36, 0
    v_mov_b32 v37, 0
    v_mov_b32 v38, 0
    v_mov_b32 v39, 0
    buffer_store_dwordx4 v[36:39], v32, s[20:23], s70 offen sc0 sc1
    s_cmp_lt_u32 s32, 2
    s_cselect_b32 s70, s70, 2146435072
    s_add_u32 s70, s70, 8192
    buffer_store_dwordx4 v[36:39], v32, s[20:23], s70 offen sc0 sc1
    v_lshrrev_b32 v32, 4, v0
    v_bfe_u32 v33, v0, 2, 2
    v_lshl_add_u32 v34, v32, 3, v33
    v_lshlrev_b32 v34, 7, v34
    v_bfe_u32 v35, v0, 3, 2
    s_lshl_b32 s70, s34, 1
    s_and_b32 s71, s33, 1
    s_or_b32 s70, s70, s71
    v_xor_b32 v35, s70, v35
    v_lshl_add_u32 v34, v35, 5, v34
    v_and_b32 v35, 3, v0
    v_lshl_add_u32 v34, v35, 3, v34
    s_lshr_b32 s71, s33, 1
    s_lshl_b32 s72, s71, 12
    v_add_u32 v4, s72, v34
    v_xor_b32 v5, 32, v4
    v_xor_b32 v6, 0x1000, v4
    v_xor_b32 v7, 0x1020, v4
    v_and_b32 v33, 15, v0
    s_lshl_b32 s72, s33, 5
    s_lshl_b32 s73, s34, 4
    s_add_u32 s72, s72, s73
    v_add_u32 v34, s72, v33
    s_lshl_b32 s71, s71, 2
    v_or_b32 v35, s71, v32
    v_lshrrev_b32 v36, 1, v33
    v_xor_b32 v35, v35, v36
    v_lshlrev_b32 v35, 4, v35
    v_lshl_add_u32 v66, v34, 7, v35
    v_xor_b32 v67, 64, v66
    v_xor_b32 v68, 0x800, v66
    v_xor_b32 v69, 0x840, v66
    v_xor_b32 v3, s73, v0
    v_lshlrev_b32 v3, 4, v3
    s_mov_b32 s76, 0x22222222
    s_mov_b32 s77, 0x22222222
    s_mov_b32 s78, 0x44444444
    s_mov_b32 s79, 0x44444444
    s_mov_b32 s80, 0x88888888
    s_mov_b32 s81, 0x88888888
    s_mov_b32 s82, 0x0
    s_mov_b32 s83, 0xffffffff
    s_mov_b32 s84, 0xffff0000
    s_mov_b32 s85, 0xffff0000
    s_mov_b32 s86, 0xf0f0f0f
    s_mov_b32 s87, 0xf0f0f0f
    s_mov_b32 s88, 0xf0f0f0f0
    s_mov_b32 s89, 0xf0f0f0f0
    s_mov_b32 vcc_lo, 0x00ff00ff
    s_mov_b32 vcc_hi, 0x00ff00ff
    v_mov_b32 v72, 0x3f803f80
    v_mov_b32 v73, v72
    v_mov_b32 v74, v72
    v_mov_b32 v75, v72
    v_cndmask_b32 v8, 0, v72, vcc
    v_xor_b32 v12, v8, v72
    v_mov_b32 v9, v8
    v_mov_b32 v13, v12
    v_mov_b32 v10, v8
    v_mov_b32 v14, v12
    v_mov_b32 v11, v8
    v_mov_b32 v15, v12
    s_lshl_b32 s70, s35, 2
    s_add_u32 s70, s70, s33
    s_mul_i32 s70, s70, 147456
    s_lshl_b32 s71, s34, 11
    s_add_u32 s70, s70, s71
    s_and_b32 s71, s33, 1
    s_lshl_b32 s72, s71, 10
    s_add_u32 s68, s70, s72
    s_xor_b32 s72, s72, 1024
    s_add_u32 s69, s70, s72
    s_lshl_b32 s70, s34, 9
    s_lshl_b32 s71, s71, 7
    s_add_u32 s70, s70, s71
    s_add_u32 s75, s70, 157696
    s_lshr_b32 s71, s33, 1
    s_lshl_b32 s71, s71, 6
    s_add_u32 s74, s75, s71
    s_lshr_b32 s70, s35, 1
    s_mul_i32 s70, s70, 10240
    s_and_b32 s71, s35, 1
    s_mul_i32 s71, s71, 384
    s_add_u32 s70, s70, s71
    s_add_u32 s97, s70, 9446144
    s_cmp_eq_u32 s32, 0
    s_cselect_b32 s97, s97, 2146435072
    s_and_b32 s70, s2, 3
    s_lshl_b32 s70, s70, 3
    s_and_b32 s71, s2, 4
    s_add_u32 s70, s70, s71
    s_bfe_u32 s71, s2, 0x20003
    s_add_u32 s70, s70, s71
    s_lshr_b32 s71, s70, 2
    s_mul_i32 s71, s71, 10240
    s_bfe_u32 s72, s70, 0x10001
    s_mul_i32 s72, s72, 384
    s_add_u32 s71, s71, s72
    s_add_u32 s96, s71, 9446144
    s_lshl_b32 s70, s70, 1
    s_add_u32 s70, s70, s34
    s_mul_i32 s71, s70, 147456
    s_lshl_b32 s72, s33, 12
    s_add_u32 s94, s71, s72
    s_add_u32 s95, s94, s72
    s_lshl_b32 s70, s70, 15
    s_lshr_b32 s71, s2, 5
    s_lshl_b32 s71, s71, 7
    s_add_u32 s70, s70, s71
    s_lshl_b32 s71, s33, 5
    s_add_u32 s98, s70, s71
    s_add_u32 m0, s38, 32768
    s_mov_b32 s39, 128
    buffer_load_dwordx4 v64, s[4:7], s39 offen lds
    s_add_u32 m0, s38, 49152
    s_mov_b32 s39, 229376
    buffer_load_dwordx4 v2, s[12:15], s39 offen lds
    s_add_u32 m0, s38, 40960
    s_mov_b32 s39, 65664
    buffer_load_dwordx4 v64, s[4:7], s39 offen lds
    s_add_u32 m0, s38, 57344
    s_mov_b32 s39, 229376
    buffer_load_dwordx4 v2, s[16:19], s39 offen lds
    v_lshlrev_b32 v32, 4, v0
    s_lshl_b32 s70, s36, 11
    s_and_b32 s71, s38, 1024
    s_add_u32 s70, s70, s71
    s_add_u32 m0, s71, 160768
    s_nop 0
    buffer_load_dwordx4 v32, s[24:27], s70 offen lds
    s_waitcnt vmcnt(7)
    s_barrier
    ds_read_b128 v[128:131], v66 offset:0
    ds_read_b128 v[136:139], v67 offset:0
    ds_read_b128 v[132:135], v68 offset:0
    ds_read_b128 v[140:143], v69 offset:0
    v_lshlrev_b32 v70, 7, v0
    s_lshl_b32 s92, s2, 3
    s_add_u32 s92, s92, s32
    s_mov_b32 m0, 156672
    s_mul_i32 s93, s92, 768
    s_mov_b64 exec, 63
    buffer_load_dword v70, s[8:11], s93 offen lds
    s_mov_b64 exec, -1
    ds_read_b64_tr_b16 v[40:41], v4 offset:16384
    ds_read_b64_tr_b16 v[42:43], v4 offset:16896
    ds_read_b64_tr_b16 v[44:45], v6 offset:16384
    ds_read_b64_tr_b16 v[46:47], v6 offset:16896
    ds_read_b64_tr_b16 v[48:49], v4 offset:24576
    ds_read_b64_tr_b16 v[50:51], v4 offset:25088
    ds_read_b64_tr_b16 v[52:53], v6 offset:24576
    ds_read_b64_tr_b16 v[54:55], v6 offset:25088
    s_waitcnt lgkmcnt(4)
    v_mfma_f32_16x16x32_bf16 v[96:99], v[40:43], v[128:131], 0
    ds_read_b64_tr_b16 v[56:57], v5 offset:16384
    v_mfma_f32_16x16x32_bf16 v[96:99], v[44:47], v[136:139], v[96:99]
    ds_read_b64_tr_b16 v[58:59], v5 offset:16896
    s_add_u32 m0, s38, 65536
    s_mov_b32 s39, 256
    buffer_load_dwordx4 v64, s[4:7], s39 offen lds
    v_mfma_f32_16x16x32_bf16 v[100:103], v[40:43], v[132:135], 0
    ds_read_b64_tr_b16 v[60:61], v7 offset:16384
    v_mfma_f32_16x16x32_bf16 v[100:103], v[44:47], v[140:143], v[100:103]
    ds_read_b64_tr_b16 v[62:63], v7 offset:16896
    s_add_u32 m0, s38, 81920
    s_mov_b32 s39, 458752
    buffer_load_dwordx4 v2, s[12:15], s39 offen lds
    v_mfma_f32_16x16x32_bf16 v[16:19], v[8:11], v[40:43], 0
    s_waitcnt lgkmcnt(4)
    v_mfma_f32_16x16x32_bf16 v[112:115], v[48:51], v[128:131], 0
    ds_read_b64_tr_b16 v[40:41], v5 offset:24576
    v_mfma_f32_16x16x32_bf16 v[112:115], v[52:55], v[136:139], v[112:115]
    ds_read_b64_tr_b16 v[42:43], v5 offset:25088
    s_add_u32 m0, s38, 73728
    s_mov_b32 s39, 65792
    buffer_load_dwordx4 v64, s[4:7], s39 offen lds
    v_mfma_f32_16x16x32_bf16 v[116:119], v[48:51], v[132:135], 0
    ds_read_b64_tr_b16 v[44:45], v7 offset:24576
    v_mfma_f32_16x16x32_bf16 v[116:119], v[52:55], v[140:143], v[116:119]
    ds_read_b64_tr_b16 v[46:47], v7 offset:25088
    s_add_u32 m0, s38, 90112
    s_mov_b32 s39, 458752
    buffer_load_dwordx4 v2, s[16:19], s39 offen lds
    v_mfma_f32_16x16x32_bf16 v[16:19], v[12:15], v[48:51], v[16:19]
    s_waitcnt lgkmcnt(4)
    v_mfma_f32_16x16x32_bf16 v[88:91], v[72:75], v[128:131], 0
    v_mfma_f32_16x16x32_bf16 v[88:91], v[72:75], v[136:139], v[88:91]
    s_waitcnt vmcnt(6)
    s_waitcnt lgkmcnt(0)
    s_barrier
    v_lshlrev_b32 v70, 7, v0
    s_lshl_b32 s92, s2, 3
    s_add_u32 s92, s92, s32
    s_mov_b32 m0, 156672
    s_mul_i32 s93, s92, 896
    s_mov_b64 exec, 127
    buffer_load_dword v70, s[12:15], s93 offen lds
    s_mov_b64 exec, -1
    ds_read_b64_tr_b16 v[48:49], v4 offset:49152
    v_mfma_f32_16x16x32_bf16 v[104:107], v[56:59], v[128:131], 0
    ds_read_b64_tr_b16 v[50:51], v4 offset:49664
    ds_read_b128 v[144:147], v66 offset:32768
    v_mfma_f32_16x16x32_bf16 v[104:107], v[60:63], v[136:139], v[104:107]
    ds_read_b64_tr_b16 v[52:53], v6 offset:49152
    s_add_u32 m0, s38, 98304
    s_mov_b32 s39, 384
    buffer_load_dwordx4 v64, s[4:7], s39 offen lds
    v_mfma_f32_16x16x32_bf16 v[108:111], v[56:59], v[132:135], 0
    ds_read_b64_tr_b16 v[54:55], v6 offset:49664
    ds_read_b128 v[152:155], v67 offset:32768
    v_mfma_f32_16x16x32_bf16 v[108:111], v[60:63], v[140:143], v[108:111]
    v_mfma_f32_16x16x32_bf16 v[92:95], v[128:131], v[128:131], 0
    ds_read_b64_tr_b16 v[56:57], v4 offset:57344
    v_mfma_f32_16x16x32_bf16 v[92:95], v[136:139], v[136:139], v[92:95]
    ds_read_b64_tr_b16 v[58:59], v4 offset:57856
    s_add_u32 m0, s38, 114688
    s_mov_b32 s39, 688128
    buffer_load_dwordx4 v2, s[12:15], s39 offen lds
    v_mfma_f32_16x16x32_bf16 v[120:123], v[40:43], v[128:131], 0
    ds_read_b64_tr_b16 v[60:61], v6 offset:57344
    ds_read_b128 v[148:151], v68 offset:32768
    v_mfma_f32_16x16x32_bf16 v[120:123], v[44:47], v[136:139], v[120:123]
    ds_read_b64_tr_b16 v[62:63], v6 offset:57856
    s_add_u32 m0, s38, 106496
    s_mov_b32 s39, 65920
    buffer_load_dwordx4 v64, s[4:7], s39 offen lds
    v_mfma_f32_16x16x32_bf16 v[124:127], v[40:43], v[132:135], 0
    ds_read_b128 v[156:159], v69 offset:32768
    v_mfma_f32_16x16x32_bf16 v[124:127], v[44:47], v[140:143], v[124:127]
    s_waitcnt lgkmcnt(7)
    v_mfma_f32_16x16x32_bf16 v[96:99], v[48:51], v[144:147], v[96:99]
    ds_read_b64_tr_b16 v[40:41], v5 offset:49152
    s_waitcnt lgkmcnt(7)
    v_mfma_f32_16x16x32_bf16 v[96:99], v[52:55], v[152:155], v[96:99]
    ds_read_b64_tr_b16 v[42:43], v5 offset:49664
    s_add_u32 m0, s38, 122880
    s_mov_b32 s39, 688128
    buffer_load_dwordx4 v2, s[16:19], s39 offen lds
    s_waitcnt lgkmcnt(4)
    v_mfma_f32_16x16x32_bf16 v[100:103], v[48:51], v[148:151], v[100:103]
    ds_read_b64_tr_b16 v[44:45], v7 offset:49152
    s_waitcnt lgkmcnt(3)
    v_mfma_f32_16x16x32_bf16 v[100:103], v[52:55], v[156:159], v[100:103]
    ds_read_b64_tr_b16 v[46:47], v7 offset:49664
    s_add_u32 m0, s38, 0
    s_mov_b32 s39, 512
    buffer_load_dwordx4 v64, s[4:7], s39 offen lds
    v_mfma_f32_16x16x32_bf16 v[16:19], v[8:11], v[48:51], v[16:19]
    v_mfma_f32_16x16x32_bf16 v[112:115], v[56:59], v[144:147], v[112:115]
    ds_read_b64_tr_b16 v[48:49], v5 offset:57344
    v_mfma_f32_16x16x32_bf16 v[112:115], v[60:63], v[152:155], v[112:115]
    ds_read_b64_tr_b16 v[50:51], v5 offset:57856
    s_add_u32 m0, s38, 16384
    s_mov_b32 s39, 917504
    buffer_load_dwordx4 v2, s[12:15], s39 offen lds
    v_mfma_f32_16x16x32_bf16 v[116:119], v[56:59], v[148:151], v[116:119]
    ds_read_b64_tr_b16 v[52:53], v7 offset:57344
    v_mfma_f32_16x16x32_bf16 v[116:119], v[60:63], v[156:159], v[116:119]
    ds_read_b64_tr_b16 v[54:55], v7 offset:57856
    v_mfma_f32_16x16x32_bf16 v[16:19], v[12:15], v[56:59], v[16:19]
    s_waitcnt lgkmcnt(4)
    v_mfma_f32_16x16x32_bf16 v[88:91], v[72:75], v[144:147], v[88:91]
    v_mfma_f32_16x16x32_bf16 v[88:91], v[72:75], v[152:155], v[88:91]
    s_waitcnt vmcnt(7)
    s_waitcnt lgkmcnt(0)
    s_barrier
    v_add_u32 v66, 0x10000, v66
    v_add_u32 v67, 0x10000, v67
    v_add_u32 v68, 0x10000, v68
    v_add_u32 v69, 0x10000, v69
    s_lshl_b32 s70, s36, 5
    s_or_b32 s71, s35, s32
    s_cmp_eq_u32 s71, 0
    s_cselect_b32 s70, s70, 2146435072
    v_lshlrev_b32 v28, 8, v0
    v_mov_b32 v29, 1
    buffer_store_dword v29, v28, s[28:31], s70 offen sc0 sc1
    v_lshlrev_b32 v70, 7, v0
    s_lshl_b32 s92, s2, 3
    s_add_u32 s92, s92, s32
    s_mov_b32 m0, 156672
    s_mul_i32 s93, s92, 896
    s_mov_b64 exec, 127
    buffer_load_dword v70, s[16:19], s93 offen lds
    s_mov_b64 exec, -1
    v_add_u32 v4, 0x10000, v4
    v_add_u32 v5, 0x10000, v5
    v_add_u32 v6, 0x10000, v6
    v_add_u32 v7, 0x10000, v7
    ds_read_b64_tr_b16 v[56:57], v4 offset:16384
    v_mfma_f32_16x16x32_bf16 v[104:107], v[40:43], v[144:147], v[104:107]
    ds_read_b64_tr_b16 v[58:59], v4 offset:16896
    ds_read_b128 v[160:163], v66 offset:0
    v_mfma_f32_16x16x32_bf16 v[104:107], v[44:47], v[152:155], v[104:107]
    ds_read_b64_tr_b16 v[60:61], v6 offset:16384
    s_add_u32 m0, s38, 8192
    s_mov_b32 s39, 66048
    buffer_load_dwordx4 v64, s[4:7], s39 offen lds
    v_mfma_f32_16x16x32_bf16 v[108:111], v[40:43], v[148:151], v[108:111]
    ds_read_b64_tr_b16 v[62:63], v6 offset:16896
    ds_read_b128 v[168:171], v67 offset:0
    v_mfma_f32_16x16x32_bf16 v[108:111], v[44:47], v[156:159], v[108:111]
    v_mfma_f32_16x16x32_bf16 v[92:95], v[144:147], v[144:147], v[92:95]
    ds_read_b64_tr_b16 v[40:41], v4 offset:24576
    v_mfma_f32_16x16x32_bf16 v[92:95], v[152:155], v[152:155], v[92:95]
    ds_read_b64_tr_b16 v[42:43], v4 offset:25088
    s_add_u32 m0, s38, 24576
    s_mov_b32 s39, 917504
    buffer_load_dwordx4 v2, s[16:19], s39 offen lds
    v_mfma_f32_16x16x32_bf16 v[120:123], v[48:51], v[144:147], v[120:123]
    ds_read_b64_tr_b16 v[44:45], v6 offset:24576
    ds_read_b128 v[164:167], v68 offset:0
    v_mfma_f32_16x16x32_bf16 v[120:123], v[52:55], v[152:155], v[120:123]
    ds_read_b64_tr_b16 v[46:47], v6 offset:25088
    s_add_u32 m0, s38, 32768
    s_mov_b32 s39, 640
    buffer_load_dwordx4 v64, s[4:7], s39 offen lds
    v_mfma_f32_16x16x32_bf16 v[124:127], v[48:51], v[148:151], v[124:127]
    ds_read_b128 v[172:175], v69 offset:0
    v_mfma_f32_16x16x32_bf16 v[124:127], v[52:55], v[156:159], v[124:127]
    s_waitcnt lgkmcnt(7)
    v_mfma_f32_16x16x32_bf16 v[96:99], v[56:59], v[160:163], v[96:99]
    ds_read_b64_tr_b16 v[48:49], v5 offset:16384
    s_waitcnt lgkmcnt(7)
    v_mfma_f32_16x16x32_bf16 v[96:99], v[60:63], v[168:171], v[96:99]
    ds_read_b64_tr_b16 v[50:51], v5 offset:16896
    s_add_u32 m0, s38, 49152
    s_mov_b32 s39, 1146880
    buffer_load_dwordx4 v2, s[12:15], s39 offen lds
    s_waitcnt lgkmcnt(4)
    v_mfma_f32_16x16x32_bf16 v[100:103], v[56:59], v[164:167], v[100:103]
    ds_read_b64_tr_b16 v[52:53], v7 offset:16384
    s_waitcnt lgkmcnt(3)
    v_mfma_f32_16x16x32_bf16 v[100:103], v[60:63], v[172:175], v[100:103]
    ds_read_b64_tr_b16 v[54:55], v7 offset:16896
    v_mfma_f32_16x16x32_bf16 v[16:19], v[8:11], v[56:59], v[16:19]
    v_mfma_f32_16x16x32_bf16 v[112:115], v[40:43], v[160:163], v[112:115]
    ds_read_b64_tr_b16 v[56:57], v5 offset:24576
    v_mfma_f32_16x16x32_bf16 v[112:115], v[44:47], v[168:171], v[112:115]
    ds_read_b64_tr_b16 v[58:59], v5 offset:25088
    s_add_u32 m0, s38, 40960
    s_mov_b32 s39, 66176
    buffer_load_dwordx4 v64, s[4:7], s39 offen lds
    v_mfma_f32_16x16x32_bf16 v[116:119], v[40:43], v[164:167], v[116:119]
    ds_read_b64_tr_b16 v[60:61], v7 offset:24576
    v_mfma_f32_16x16x32_bf16 v[116:119], v[44:47], v[172:175], v[116:119]
    ds_read_b64_tr_b16 v[62:63], v7 offset:25088
    v_mfma_f32_16x16x32_bf16 v[16:19], v[12:15], v[40:43], v[16:19]
    s_waitcnt lgkmcnt(4)
    v_mfma_f32_16x16x32_bf16 v[88:91], v[72:75], v[160:163], v[88:91]
    v_mfma_f32_16x16x32_bf16 v[88:91], v[72:75], v[168:171], v[88:91]
    s_waitcnt vmcnt(9)
    s_waitcnt lgkmcnt(0)
    s_barrier
    ds_read_b64_tr_b16 v[40:41], v4 offset:49152
    v_mfma_f32_16x16x32_bf16 v[104:107], v[48:51], v[160:163], v[104:107]
    ds_read_b64_tr_b16 v[42:43], v4 offset:49664
    ds_read_b128 v[176:179], v66 offset:32768
    v_mfma_f32_16x16x32_bf16 v[104:107], v[52:55], v[168:171], v[104:107]
    ds_read_b64_tr_b16 v[44:45], v6 offset:49152
    s_add_u32 m0, s38, 57344
    s_mov_b32 s39, 1146880
    buffer_load_dwordx4 v2, s[16:19], s39 offen lds
    v_mfma_f32_16x16x32_bf16 v[108:111], v[48:51], v[164:167], v[108:111]
    ds_read_b64_tr_b16 v[46:47], v6 offset:49664
    ds_read_b128 v[184:187], v67 offset:32768
    v_mfma_f32_16x16x32_bf16 v[108:111], v[52:55], v[172:175], v[108:111]
    v_and_b32 v24, 15, v0
    v_lshrrev_b32 v25, 5, v0
    s_lshl_b32 s70, s33, 8
    v_mfma_f32_16x16x32_bf16 v[92:95], v[160:163], v[160:163], v[92:95]
    v_lshl_add_u32 v20, v24, 2, s74
    s_lshl_b32 s71, s34, 7
    v_lshl_add_u32 v20, v25, 8, v20
    ds_read_b64_tr_b16 v[48:49], v4 offset:57344
    v_mfma_f32_16x16x32_bf16 v[92:95], v[168:171], v[168:171], v[92:95]
    ds_read_b64_tr_b16 v[50:51], v4 offset:57856
    s_add_u32 m0, s38, 65536
    s_mov_b32 s39, 768
    buffer_load_dwordx4 v64, s[4:7], s39 offen lds
    v_mfma_f32_16x16x32_bf16 v[120:123], v[56:59], v[160:163], v[120:123]
    s_add_u32 s70, s70, s71
    s_add_u32 s70, s70, 155648
    ds_read_b64_tr_b16 v[52:53], v6 offset:57344
    ds_read_b128 v[180:183], v68 offset:32768
    v_mfma_f32_16x16x32_bf16 v[120:123], v[60:63], v[168:171], v[120:123]
    ds_read_b64_tr_b16 v[54:55], v6 offset:57856
    s_add_u32 m0, s38, 81920
    s_mov_b32 s39, 1376256
    buffer_load_dwordx4 v2, s[12:15], s39 offen lds
    v_mfma_f32_16x16x32_bf16 v[124:127], v[56:59], v[164:167], v[124:127]
    v_lshl_add_u32 v22, v24, 3, s70
    s_mov_b32 vcc_lo, 0x00f0000f
    s_mov_b32 vcc_hi, 0xf0000f00
    ds_read_b128 v[188:191], v69 offset:32768
    v_mfma_f32_16x16x32_bf16 v[124:127], v[60:63], v[172:175], v[124:127]
    v_mov_b32 v21, 156672
    v_xor_b32 v23, 128, v22
    s_waitcnt lgkmcnt(7)
    v_mfma_f32_16x16x32_bf16 v[96:99], v[40:43], v[176:179], v[96:99]
    v_cndmask_b32 v21, v21, v22, vcc
    v_and_b32 v28, 31, v0
    ds_read_b64_tr_b16 v[56:57], v5 offset:49152
    s_waitcnt lgkmcnt(7)
    v_mfma_f32_16x16x32_bf16 v[96:99], v[44:47], v[184:187], v[96:99]
    ds_read_b64_tr_b16 v[58:59], v5 offset:49664
    s_add_u32 m0, s38, 73728
    s_mov_b32 s39, 66304
    buffer_load_dwordx4 v64, s[4:7], s39 offen lds
    s_waitcnt lgkmcnt(4)
    v_mfma_f32_16x16x32_bf16 v[100:103], v[40:43], v[180:183], v[100:103]
    v_lshl_add_u32 v26, v28, 2, s75
    v_mov_b32 v33, 0
    ds_read_b64_tr_b16 v[60:61], v7 offset:49152
    s_waitcnt lgkmcnt(3)
    v_mfma_f32_16x16x32_bf16 v[100:103], v[44:47], v[188:191], v[100:103]
    v_xor_b32 v27, 128, v26
    v_mov_b32 v35, 0
    ds_read_b64_tr_b16 v[62:63], v7 offset:49664
    v_mfma_f32_16x16x32_bf16 v[16:19], v[8:11], v[40:43], v[16:19]
    v_mov_b32 v37, 0
    v_mov_b32 v39, 0
    v_mfma_f32_16x16x32_bf16 v[112:115], v[48:51], v[176:179], v[112:115]
    ds_read_b64_tr_b16 v[40:41], v5 offset:57344
    v_mfma_f32_16x16x32_bf16 v[112:115], v[52:55], v[184:187], v[112:115]
    ds_read_b64_tr_b16 v[42:43], v5 offset:57856
    s_add_u32 m0, s38, 90112
    s_mov_b32 s39, 1376256
    buffer_load_dwordx4 v2, s[16:19], s39 offen lds
    v_mfma_f32_16x16x32_bf16 v[116:119], v[48:51], v[180:183], v[116:119]
    ds_read_b64_tr_b16 v[44:45], v7 offset:57344
    v_mfma_f32_16x16x32_bf16 v[116:119], v[52:55], v[188:191], v[116:119]
    ds_read_b64_tr_b16 v[46:47], v7 offset:57856
    v_mfma_f32_16x16x32_bf16 v[16:19], v[12:15], v[48:51], v[16:19]
    s_waitcnt lgkmcnt(4)
    v_mfma_f32_16x16x32_bf16 v[88:91], v[72:75], v[176:179], v[88:91]
    v_mfma_f32_16x16x32_bf16 v[88:91], v[72:75], v[184:187], v[88:91]
    s_waitcnt vmcnt(8)
    s_waitcnt lgkmcnt(0)
    s_barrier
    v_add_u32 v66, 0xffff0000, v66
    v_add_u32 v67, 0xffff0000, v67
    v_add_u32 v68, 0xffff0000, v68
    v_add_u32 v69, 0xffff0000, v69
    v_add_u32 v4, 0xffff0000, v4
    v_add_u32 v5, 0xffff0000, v5
    v_add_u32 v6, 0xffff0000, v6
    v_add_u32 v7, 0xffff0000, v7
    ds_read_b64_tr_b16 v[48:49], v4 offset:16384
    v_mfma_f32_16x16x32_bf16 v[104:107], v[56:59], v[176:179], v[104:107]
    ds_read_b64_tr_b16 v[50:51], v4 offset:16896
    ds_read_b128 v[192:195], v66 offset:0
    v_mfma_f32_16x16x32_bf16 v[104:107], v[60:63], v[184:187], v[104:107]
    ds_read_b64_tr_b16 v[52:53], v6 offset:16384
    s_add_u32 m0, s38, 98304
    s_mov_b32 s39, 896
    buffer_load_dwordx4 v64, s[4:7], s39 offen lds
    v_mfma_f32_16x16x32_bf16 v[108:111], v[56:59], v[180:183], v[108:111]
    ds_read_b64_tr_b16 v[54:55], v6 offset:16896
    ds_read_b128 v[200:203], v67 offset:0
    v_mfma_f32_16x16x32_bf16 v[108:111], v[60:63], v[188:191], v[108:111]
    v_mfma_f32_16x16x32_bf16 v[92:95], v[176:179], v[176:179], v[92:95]
    ds_read_b64_tr_b16 v[56:57], v4 offset:24576
    v_mfma_f32_16x16x32_bf16 v[92:95], v[184:187], v[184:187], v[92:95]
    ds_read_b64_tr_b16 v[58:59], v4 offset:25088
    s_add_u32 m0, s38, 114688
    s_mov_b32 s39, 1605632
    buffer_load_dwordx4 v2, s[12:15], s39 offen lds
    v_mfma_f32_16x16x32_bf16 v[120:123], v[40:43], v[176:179], v[120:123]
    ds_read_b64_tr_b16 v[60:61], v6 offset:24576
    ds_read_b128 v[196:199], v68 offset:0
    v_mfma_f32_16x16x32_bf16 v[120:123], v[44:47], v[184:187], v[120:123]
    ds_read_b64_tr_b16 v[62:63], v6 offset:25088
    v_mfma_f32_16x16x32_bf16 v[124:127], v[40:43], v[180:183], v[124:127]
    ds_read_b128 v[204:207], v69 offset:0
    v_mfma_f32_16x16x32_bf16 v[124:127], v[44:47], v[188:191], v[124:127]
    s_waitcnt lgkmcnt(7)
    v_mfma_f32_16x16x32_bf16 v[96:99], v[48:51], v[192:195], v[96:99]
    ds_read_b64_tr_b16 v[40:41], v5 offset:16384
    s_waitcnt lgkmcnt(7)
    v_mfma_f32_16x16x32_bf16 v[96:99], v[52:55], v[200:203], v[96:99]
    ds_read_b64_tr_b16 v[42:43], v5 offset:16896
    s_add_u32 m0, s38, 106496
    s_mov_b32 s39, 66432
    buffer_load_dwordx4 v64, s[4:7], s39 offen lds
    s_waitcnt lgkmcnt(4)
    v_mfma_f32_16x16x32_bf16 v[100:103], v[48:51], v[196:199], v[100:103]
    ds_read_b64_tr_b16 v[44:45], v7 offset:16384
    s_waitcnt lgkmcnt(3)
    v_mfma_f32_16x16x32_bf16 v[100:103], v[52:55], v[204:207], v[100:103]
    ds_read_b64_tr_b16 v[46:47], v7 offset:16896
    v_mfma_f32_16x16x32_bf16 v[16:19], v[8:11], v[48:51], v[16:19]
    v_mfma_f32_16x16x32_bf16 v[112:115], v[56:59], v[192:195], v[112:115]
    ds_read_b64_tr_b16 v[48:49], v5 offset:24576
    v_mfma_f32_16x16x32_bf16 v[112:115], v[60:63], v[200:203], v[112:115]
    ds_read_b64_tr_b16 v[50:51], v5 offset:25088
    s_add_u32 m0, s38, 122880
    s_mov_b32 s39, 1605632
    buffer_load_dwordx4 v2, s[16:19], s39 offen lds
    v_mfma_f32_16x16x32_bf16 v[116:119], v[56:59], v[196:199], v[116:119]
    ds_read_b64_tr_b16 v[52:53], v7 offset:24576
    v_mfma_f32_16x16x32_bf16 v[116:119], v[60:63], v[204:207], v[116:119]
    ds_read_b64_tr_b16 v[54:55], v7 offset:25088
    v_mfma_f32_16x16x32_bf16 v[16:19], v[12:15], v[56:59], v[16:19]
    s_waitcnt lgkmcnt(4)
    v_mfma_f32_16x16x32_bf16 v[88:91], v[72:75], v[192:195], v[88:91]
    v_mfma_f32_16x16x32_bf16 v[88:91], v[72:75], v[200:203], v[88:91]
    s_waitcnt vmcnt(8)
    s_waitcnt lgkmcnt(0)
    s_barrier
    ds_read_b64_tr_b16 v[56:57], v4 offset:49152
    v_mfma_f32_16x16x32_bf16 v[104:107], v[40:43], v[192:195], v[104:107]
    ds_read_b64_tr_b16 v[58:59], v4 offset:49664
    ds_read_b128 v[208:211], v66 offset:32768
    v_mfma_f32_16x16x32_bf16 v[104:107], v[44:47], v[200:203], v[104:107]
    ds_read_b64_tr_b16 v[60:61], v6 offset:49152
    s_add_u32 m0, s38, 0
    s_mov_b32 s39, 128
    buffer_load_dwordx4 v2, s[12:15], s39 offen lds
    v_mfma_f32_16x16x32_bf16 v[108:111], v[40:43], v[196:199], v[108:111]
    ds_read_b64_tr_b16 v[62:63], v6 offset:49664
    ds_read_b128 v[216:219], v67 offset:32768
    v_mfma_f32_16x16x32_bf16 v[108:111], v[44:47], v[204:207], v[108:111]
    v_mfma_f32_16x16x32_bf16 v[92:95], v[192:195], v[192:195], v[92:95]
    ds_read_b64_tr_b16 v[40:41], v4 offset:57344
    v_mfma_f32_16x16x32_bf16 v[92:95], v[200:203], v[200:203], v[92:95]
    ds_read_b64_tr_b16 v[42:43], v4 offset:57856
    s_add_u32 m0, s38, 8192
    s_mov_b32 s39, 128
    buffer_load_dwordx4 v2, s[16:19], s39 offen lds
    v_mfma_f32_16x16x32_bf16 v[120:123], v[48:51], v[192:195], v[120:123]
    ds_read_b64_tr_b16 v[44:45], v6 offset:57344
    ds_read_b128 v[212:215], v68 offset:32768
    v_mfma_f32_16x16x32_bf16 v[120:123], v[52:55], v[200:203], v[120:123]
    ds_read_b64_tr_b16 v[46:47], v6 offset:57856
    v_mfma_f32_16x16x32_bf16 v[124:127], v[48:51], v[196:199], v[124:127]
    ds_read_b128 v[220:223], v69 offset:32768
    v_mfma_f32_16x16x32_bf16 v[124:127], v[52:55], v[204:207], v[124:127]
    s_waitcnt lgkmcnt(7)
    v_mfma_f32_16x16x32_bf16 v[96:99], v[56:59], v[208:211], v[96:99]
    ds_read_b64_tr_b16 v[48:49], v5 offset:49152
    s_waitcnt lgkmcnt(7)
    v_mfma_f32_16x16x32_bf16 v[96:99], v[60:63], v[216:219], v[96:99]
    ds_read_b64_tr_b16 v[50:51], v5 offset:49664
    s_add_u32 m0, s38, 16384
    s_mov_b32 s39, 229504
    buffer_load_dwordx4 v2, s[12:15], s39 offen lds
    s_waitcnt lgkmcnt(4)
    v_mfma_f32_16x16x32_bf16 v[100:103], v[56:59], v[212:215], v[100:103]
    ds_read_b64_tr_b16 v[52:53], v7 offset:49152
    s_waitcnt lgkmcnt(3)
    v_mfma_f32_16x16x32_bf16 v[100:103], v[60:63], v[220:223], v[100:103]
    ds_read_b64_tr_b16 v[54:55], v7 offset:49664
    v_mfma_f32_16x16x32_bf16 v[16:19], v[8:11], v[56:59], v[16:19]
    v_mfma_f32_16x16x32_bf16 v[112:115], v[40:43], v[208:211], v[112:115]
    ds_read_b64_tr_b16 v[56:57], v5 offset:57344
    v_mfma_f32_16x16x32_bf16 v[112:115], v[44:47], v[216:219], v[112:115]
    ds_read_b64_tr_b16 v[58:59], v5 offset:57856
    s_add_u32 m0, s38, 24576
    s_mov_b32 s39, 229504
    buffer_load_dwordx4 v2, s[16:19], s39 offen lds
    v_mfma_f32_16x16x32_bf16 v[116:119], v[40:43], v[212:215], v[116:119]
    ds_read_b64_tr_b16 v[60:61], v7 offset:57344
    v_mfma_f32_16x16x32_bf16 v[116:119], v[44:47], v[220:223], v[116:119]
    ds_read_b64_tr_b16 v[62:63], v7 offset:57856
    v_mfma_f32_16x16x32_bf16 v[16:19], v[12:15], v[40:43], v[16:19]
    s_waitcnt lgkmcnt(4)
    v_mfma_f32_16x16x32_bf16 v[88:91], v[72:75], v[208:211], v[88:91]
    v_mfma_f32_16x16x32_bf16 v[88:91], v[72:75], v[216:219], v[88:91]
    s_waitcnt vmcnt(8)
    s_waitcnt lgkmcnt(0)
    s_barrier
    v_add_u32 v66, 0x10000, v66
    v_add_u32 v67, 0x10000, v67
    v_add_u32 v68, 0x10000, v68
    v_add_u32 v69, 0x10000, v69
    v_lshlrev_b32 v28, 5, v0
    buffer_load_dword v29, v28, s[28:31], 0 offen sc0 sc1
    v_add_u32 v4, 0x10000, v4
    v_add_u32 v5, 0x10000, v5
    v_add_u32 v6, 0x10000, v6
    v_add_u32 v7, 0x10000, v7
    ds_read_b64_tr_b16 v[40:41], v4 offset:16384
    v_mfma_f32_16x16x32_bf16 v[104:107], v[48:51], v[208:211], v[104:107]
    ds_read_b64_tr_b16 v[42:43], v4 offset:16896
    ds_read_b128 v[224:227], v66 offset:0
    v_mfma_f32_16x16x32_bf16 v[104:107], v[52:55], v[216:219], v[104:107]
    ds_read_b64_tr_b16 v[44:45], v6 offset:16384
    s_add_u32 m0, s38, 32768
    s_mov_b32 s39, 458880
    buffer_load_dwordx4 v2, s[12:15], s39 offen lds
    v_mfma_f32_16x16x32_bf16 v[108:111], v[48:51], v[212:215], v[108:111]
    ds_read_b64_tr_b16 v[46:47], v6 offset:16896
    ds_read_b128 v[232:235], v67 offset:0
    v_mfma_f32_16x16x32_bf16 v[108:111], v[52:55], v[220:223], v[108:111]
    v_mfma_f32_16x16x32_bf16 v[92:95], v[208:211], v[208:211], v[92:95]
    ds_read_b64_tr_b16 v[48:49], v4 offset:24576
    v_mfma_f32_16x16x32_bf16 v[92:95], v[216:219], v[216:219], v[92:95]
    ds_read_b64_tr_b16 v[50:51], v4 offset:25088
    s_add_u32 m0, s38, 40960
    s_mov_b32 s39, 458880
    buffer_load_dwordx4 v2, s[16:19], s39 offen lds
    v_mfma_f32_16x16x32_bf16 v[120:123], v[56:59], v[208:211], v[120:123]
    ds_read_b64_tr_b16 v[52:53], v6 offset:24576
    ds_read_b128 v[228:231], v68 offset:0
    v_mfma_f32_16x16x32_bf16 v[120:123], v[60:63], v[216:219], v[120:123]
    ds_read_b64_tr_b16 v[54:55], v6 offset:25088
    v_mfma_f32_16x16x32_bf16 v[124:127], v[56:59], v[212:215], v[124:127]
    ds_read_b128 v[236:239], v69 offset:0
    v_mfma_f32_16x16x32_bf16 v[124:127], v[60:63], v[220:223], v[124:127]
    s_waitcnt lgkmcnt(7)
    v_mfma_f32_16x16x32_bf16 v[96:99], v[40:43], v[224:227], v[96:99]
    ds_read_b64_tr_b16 v[56:57], v5 offset:16384
    s_waitcnt lgkmcnt(7)
    v_mfma_f32_16x16x32_bf16 v[96:99], v[44:47], v[232:235], v[96:99]
    ds_read_b64_tr_b16 v[58:59], v5 offset:16896
    s_add_u32 m0, s38, 49152
    s_mov_b32 s39, 688256
    buffer_load_dwordx4 v2, s[12:15], s39 offen lds
    s_waitcnt lgkmcnt(4)
    v_mfma_f32_16x16x32_bf16 v[100:103], v[40:43], v[228:231], v[100:103]
    ds_read_b64_tr_b16 v[60:61], v7 offset:16384
    s_waitcnt lgkmcnt(3)
    v_mfma_f32_16x16x32_bf16 v[100:103], v[44:47], v[236:239], v[100:103]
    ds_read_b64_tr_b16 v[62:63], v7 offset:16896
    v_mfma_f32_16x16x32_bf16 v[16:19], v[8:11], v[40:43], v[16:19]
    v_mfma_f32_16x16x32_bf16 v[112:115], v[48:51], v[224:227], v[112:115]
    ds_read_b64_tr_b16 v[40:41], v5 offset:24576
    v_mfma_f32_16x16x32_bf16 v[112:115], v[52:55], v[232:235], v[112:115]
    ds_read_b64_tr_b16 v[42:43], v5 offset:25088
    s_add_u32 m0, s38, 57344
    s_mov_b32 s39, 688256
    buffer_load_dwordx4 v2, s[16:19], s39 offen lds
    v_mfma_f32_16x16x32_bf16 v[116:119], v[48:51], v[228:231], v[116:119]
    ds_read_b64_tr_b16 v[44:45], v7 offset:24576
    v_mfma_f32_16x16x32_bf16 v[116:119], v[52:55], v[236:239], v[116:119]
    ds_read_b64_tr_b16 v[46:47], v7 offset:25088
    v_mfma_f32_16x16x32_bf16 v[16:19], v[12:15], v[48:51], v[16:19]
    s_waitcnt lgkmcnt(4)
    v_mfma_f32_16x16x32_bf16 v[88:91], v[72:75], v[224:227], v[88:91]
    v_mfma_f32_16x16x32_bf16 v[88:91], v[72:75], v[232:235], v[88:91]
    s_waitcnt vmcnt(9)
    s_waitcnt lgkmcnt(0)
    s_barrier
    ds_read_b64_tr_b16 v[48:49], v4 offset:49152
    v_mfma_f32_16x16x32_bf16 v[104:107], v[56:59], v[224:227], v[104:107]
    ds_read_b64_tr_b16 v[50:51], v4 offset:49664
    ds_read_b128 v[240:243], v66 offset:32768
    v_mfma_f32_16x16x32_bf16 v[104:107], v[60:63], v[232:235], v[104:107]
    ds_read_b64_tr_b16 v[52:53], v6 offset:49152
    s_add_u32 m0, s38, 65536
    s_mov_b32 s39, 917632
    buffer_load_dwordx4 v2, s[12:15], s39 offen lds
    v_mfma_f32_16x16x32_bf16 v[108:111], v[56:59], v[228:231], v[108:111]
    ds_read_b64_tr_b16 v[54:55], v6 offset:49664
    ds_read_b128 v[248:251], v67 offset:32768
    v_mfma_f32_16x16x32_bf16 v[108:111], v[60:63], v[236:239], v[108:111]
    v_mfma_f32_16x16x32_bf16 v[92:95], v[224:227], v[224:227], v[92:95]
    ds_read_b64_tr_b16 v[56:57], v4 offset:57344
    v_mfma_f32_16x16x32_bf16 v[92:95], v[232:235], v[232:235], v[92:95]
    ds_read_b64_tr_b16 v[58:59], v4 offset:57856
    s_add_u32 m0, s38, 73728
    s_mov_b32 s39, 917632
    buffer_load_dwordx4 v2, s[16:19], s39 offen lds
    v_mfma_f32_16x16x32_bf16 v[120:123], v[40:43], v[224:227], v[120:123]
    ds_read_b64_tr_b16 v[60:61], v6 offset:57344
    ds_read_b128 v[244:247], v68 offset:32768
    v_mfma_f32_16x16x32_bf16 v[120:123], v[44:47], v[232:235], v[120:123]
    ds_read_b64_tr_b16 v[62:63], v6 offset:57856
    v_mfma_f32_16x16x32_bf16 v[124:127], v[40:43], v[228:231], v[124:127]
    ds_read_b128 v[252:255], v69 offset:32768
    v_mfma_f32_16x16x32_bf16 v[124:127], v[44:47], v[236:239], v[124:127]
    s_waitcnt lgkmcnt(7)
    v_mfma_f32_16x16x32_bf16 v[96:99], v[48:51], v[240:243], v[96:99]
    ds_read_b64_tr_b16 v[40:41], v5 offset:49152
    s_waitcnt lgkmcnt(7)
    v_mfma_f32_16x16x32_bf16 v[96:99], v[52:55], v[248:251], v[96:99]
    ds_read_b64_tr_b16 v[42:43], v5 offset:49664
    s_add_u32 m0, s38, 81920
    s_mov_b32 s39, 1147008
    buffer_load_dwordx4 v2, s[12:15], s39 offen lds
    s_waitcnt lgkmcnt(4)
    v_mfma_f32_16x16x32_bf16 v[100:103], v[48:51], v[244:247], v[100:103]
    ds_read_b64_tr_b16 v[44:45], v7 offset:49152
    s_waitcnt lgkmcnt(3)
    v_mfma_f32_16x16x32_bf16 v[100:103], v[52:55], v[252:255], v[100:103]
    ds_read_b64_tr_b16 v[46:47], v7 offset:49664
    v_mfma_f32_16x16x32_bf16 v[16:19], v[8:11], v[48:51], v[16:19]
    v_mfma_f32_16x16x32_bf16 v[112:115], v[56:59], v[240:243], v[112:115]
    ds_read_b64_tr_b16 v[48:49], v5 offset:57344
    v_mfma_f32_16x16x32_bf16 v[112:115], v[60:63], v[248:251], v[112:115]
    ds_read_b64_tr_b16 v[50:51], v5 offset:57856
    s_add_u32 m0, s38, 90112
    s_mov_b32 s39, 1147008
    buffer_load_dwordx4 v2, s[16:19], s39 offen lds
    v_mfma_f32_16x16x32_bf16 v[116:119], v[56:59], v[244:247], v[116:119]
    ds_read_b64_tr_b16 v[52:53], v7 offset:57344
    v_mfma_f32_16x16x32_bf16 v[116:119], v[60:63], v[252:255], v[116:119]
    ds_read_b64_tr_b16 v[54:55], v7 offset:57856
    v_mfma_f32_16x16x32_bf16 v[16:19], v[12:15], v[56:59], v[16:19]
    s_waitcnt lgkmcnt(4)
    v_mfma_f32_16x16x32_bf16 v[88:91], v[72:75], v[240:243], v[88:91]
    v_mfma_f32_16x16x32_bf16 v[88:91], v[72:75], v[248:251], v[88:91]
    s_waitcnt vmcnt(9)
    s_waitcnt lgkmcnt(0)
    s_barrier
    s_waitcnt vmcnt(8)
    v_cmp_eq_u32 vcc, 1, v29
    s_nop 3
    s_cmp_eq_u32 vcc_lo, 0xff
    s_cbranch_scc1 K1_ok_92
    s_mov_b32 s72, 0
K1_poll_91:
    buffer_load_dword v29, v28, s[28:31], 0 offen sc0 sc1
    s_waitcnt vmcnt(0)
    v_cmp_eq_u32 vcc, 1, v29
    s_add_u32 s72, s72, 1
    s_cmp_ge_u32 s72, 0x20000
    s_cbranch_scc1 K1_ok_92
    s_nop 1
    s_cmp_lg_u32 vcc_lo, 0xff
    s_cbranch_scc1 K1_poll_91
K1_ok_92:
    v_lshlrev_b32 v70, 7, v0
    s_lshl_b32 s92, s2, 3
    s_add_u32 s92, s92, s32
    s_mov_b32 m0, 156672
    s_mul_i32 s93, s92, 896
    s_mov_b64 exec, 127
    buffer_load_dword v70, s[40:43], s93 offen lds
    s_mul_i32 s93, s92, 256
    s_mov_b64 exec, 3
    buffer_load_dword v70, s[44:47], s93 offen lds
    s_mov_b64 exec, -1
    v_add_u32 v4, 0xffff0000, v4
    v_add_u32 v5, 0xffff0000, v5
    v_add_u32 v6, 0xffff0000, v6
    v_add_u32 v7, 0xffff0000, v7
    ds_read_b64_tr_b16 v[56:57], v4 offset:0
    v_mfma_f32_16x16x32_bf16 v[104:107], v[40:43], v[240:243], v[104:107]
    ds_read_b64_tr_b16 v[58:59], v4 offset:512
    v_mfma_f32_16x16x32_bf16 v[104:107], v[44:47], v[248:251], v[104:107]
    ds_read_b64_tr_b16 v[60:61], v6 offset:0
    s_add_u32 m0, s38, 98304
    s_mov_b32 s39, 524288
    buffer_load_dwordx4 v30, s[40:43], s39 offen lds
    v_mfma_f32_16x16x32_bf16 v[108:111], v[40:43], v[244:247], v[108:111]
    ds_read_b64_tr_b16 v[62:63], v6 offset:512
    v_mfma_f32_16x16x32_bf16 v[108:111], v[44:47], v[252:255], v[108:111]
    v_mfma_f32_16x16x32_bf16 v[92:95], v[240:243], v[240:243], v[92:95]
    ds_read_b64_tr_b16 v[40:41], v4 offset:8192
    v_mfma_f32_16x16x32_bf16 v[92:95], v[248:251], v[248:251], v[92:95]
    ds_read_b64_tr_b16 v[42:43], v4 offset:8704
    s_add_u32 m0, s38, 106496
    s_mov_b32 s39, 655360
    buffer_load_dwordx4 v30, s[40:43], s39 offen lds
    v_mfma_f32_16x16x32_bf16 v[120:123], v[48:51], v[240:243], v[120:123]
    ds_read_b64_tr_b16 v[44:45], v6 offset:8192
    v_mfma_f32_16x16x32_bf16 v[120:123], v[52:55], v[248:251], v[120:123]
    ds_read_b64_tr_b16 v[46:47], v6 offset:8704
    v_mfma_f32_16x16x32_bf16 v[124:127], v[48:51], v[244:247], v[124:127]
    v_mfma_f32_16x16x32_bf16 v[124:127], v[52:55], v[252:255], v[124:127]
    v_cvt_pk_bf16_f32 v24, v16, v16
    v_lshlrev_b32 v24, 16, v24
    v_sub_f32 v24, v16, v24
    v_cvt_pk_bf16_f32 v24, v16, v24
    ds_write_b32 v20, v24 offset:0
    v_cndmask_b32 v89, v92, v93, s[76:77]
    v_cndmask_b32 v89, v89, v94, s[78:79]
    v_cndmask_b32 v89, v89, v95, s[80:81]
    ds_write_b64 v21, v[88:89]
    s_waitcnt lgkmcnt(6)
    v_mfma_f32_16x16x32_bf16 v[64:67], v[56:59], v[128:131], 0
    ds_read_b64_tr_b16 v[48:49], v5 offset:0
    v_mfma_f32_16x16x32_bf16 v[64:67], v[60:63], v[136:139], v[64:67]
    ds_read_b64_tr_b16 v[50:51], v5 offset:512
    v_mfma_f32_16x16x32_bf16 v[68:71], v[56:59], v[132:135], 0
    s_waitcnt lgkmcnt(2)
    s_barrier
    ds_read_b64 v[24:25], v22
    ds_read_b64 v[28:29], v23
    ds_read_b32 v32, v26 offset:0
    ds_read_b32 v34, v26 offset:256
    ds_read_b32 v36, v27 offset:0
    ds_read_b32 v38, v27 offset:256
    s_lshl_b32 s70, s36, 13
    ds_read_b64_tr_b16 v[52:53], v7 offset:0
    v_mfma_f32_16x16x32_bf16 v[68:71], v[60:63], v[140:143], v[68:71]
    s_add_u32 s70, s70, 36864
    s_add_u32 s70, s70, s68
    ds_read_b64_tr_b16 v[54:55], v7 offset:512
    v_mfma_f32_16x16x32_bf16 v[16:19], v[8:11], v[56:59], 0
    v_mfma_f32_16x16x32_bf16 v[80:83], v[40:43], v[128:131], 0
    ds_read_b64_tr_b16 v[56:57], v5 offset:8192
    v_mfma_f32_16x16x32_bf16 v[80:83], v[44:47], v[136:139], v[80:83]
    ds_read_b64_tr_b16 v[58:59], v5 offset:8704
    v_mfma_f32_16x16x32_bf16 v[84:87], v[40:43], v[132:135], 0
    s_waitcnt lgkmcnt(9)
    v_mul_f32 v24, 0xbb000000, v24
    v_mul_f32 v25, 0x3b000000, v25
    v_cvt_pk_bf16_f32 v20, v24, v24
    v_fma_f32 v25, -v24, v24, v25
    v_lshlrev_b32 v21, 16, v20
    v_max_f32 v25, 0, v25
    v_sub_f32 v21, v24, v21
    v_add_f32 v26, 0x3727c5ac, v25
    ds_read_b64_tr_b16 v[60:61], v7 offset:8192
    v_mfma_f32_16x16x32_bf16 v[84:87], v[44:47], v[140:143], v[84:87]
    v_rsq_f32 v25, v26
    v_cvt_pk_bf16_f32 v21, v21, v21
    v_mul_f32 v24, 0xc0135761, v25
    v_cndmask_b32 v20, v20, v21, s[82:83]
    v_mov_b32 v21, 0
    v_mul_f32 v25, v25, v25
    s_waitcnt lgkmcnt(9)
    v_mul_f32 v28, 0xbb000000, v28
    s_waitcnt lgkmcnt(8)
    v_mfma_f32_16x16x16_bf16 v[96:99], v[32:33], v[20:21], v[96:99]
    v_mul_f32 v25, 0x3d372713, v25
    v_mul_f32 v29, 0x3b000000, v29
    v_mul_f32 v25, v25, v24
    v_fma_f32 v29, -v28, v28, v29
    v_cvt_pk_bf16_f32 v22, v28, v28
    v_max_f32 v29, 0, v29
    v_lshlrev_b32 v23, 16, v22
    v_add_f32 v29, 0x3727c5ac, v29
    s_waitcnt lgkmcnt(7)
    v_mfma_f32_16x16x16_bf16 v[112:115], v[34:35], v[20:21], v[112:115]
    v_sub_f32 v23, v28, v23
    v_rsq_f32 v27, v29
    v_cvt_pk_bf16_f32 v23, v23, v23
    v_mul_f32 v28, v27, v27
    v_cndmask_b32 v22, v22, v23, s[82:83]
    v_mov_b32 v23, 0
    v_mul_f32 v27, 0xc0135761, v27
    s_nop 0
    v_mfma_f32_16x16x16_bf16 v[100:103], v[32:33], v[22:23], v[100:103]
    v_mul_f32 v28, 0x3d372713, v28
    v_mfma_f32_16x16x16_bf16 v[116:119], v[34:35], v[22:23], v[116:119]
    v_mul_f32 v28, v28, v27
    s_waitcnt lgkmcnt(6)
    v_mfma_f32_16x16x16_bf16 v[108:111], v[36:37], v[22:23], v[108:111]
    s_waitcnt lgkmcnt(5)
    v_mfma_f32_16x16x16_bf16 v[120:123], v[38:39], v[20:21], v[120:123]
    v_mfma_f32_16x16x16_bf16 v[124:127], v[38:39], v[22:23], v[124:127]
    v_mul_f32 v32, v96, v96
    v_mul_f32 v33, v97, v97
    v_mul_f32 v34, v98, v98
    v_mul_f32 v35, v99, v99
    v_fma_f32 v32, v32, v25, v24
    v_fma_f32 v33, v33, v25, v24
    v_fma_f32 v34, v34, v25, v24
    v_fma_f32 v35, v35, v25, v24
    v_mfma_f32_16x16x16_bf16 v[104:107], v[36:37], v[20:21], v[104:107]
    v_mov_b32 v38, -1
    v_mov_b32 v39, -1
    v_mul_f32 v112, v96, v112
    v_mul_f32 v96, v32, v96
    v_mul_f32 v113, v97, v113
    v_mul_f32 v97, v33, v97
    v_mul_f32 v114, v98, v114
    v_mul_f32 v98, v34, v98
    ds_read_b64_tr_b16 v[62:63], v7 offset:8704
    v_mfma_f32_16x16x32_bf16 v[16:19], v[12:15], v[40:43], v[16:19]
    v_mov_b32 v36, -1
    v_mov_b32 v37, -1
    v_mul_f32 v115, v99, v115
    buffer_store_dwordx4 v[36:39], v3, s[20:23], s70 offen sc0 sc1
    v_mul_f32 v99, v35, v99
    v_exp_f32 v96, v96
    v_exp_f32 v97, v97
    s_lshl_b32 s70, s36, 13
    s_add_u32 s70, s70, 36864
    s_waitcnt lgkmcnt(4)
    v_mfma_f32_16x16x32_bf16 v[72:75], v[48:51], v[128:131], 0
    v_exp_f32 v98, v98
    v_exp_f32 v99, v99
    v_fma_f32 v96, v96, v26, v26
    v_fma_f32 v97, v97, v26, v26
    v_fma_f32 v98, v98, v26, v26
    v_fma_f32 v99, v99, v26, v26
    s_add_u32 s70, s70, s69
    ds_read_b64_tr_b16 v[40:41], v4 offset:16384
    v_mfma_f32_16x16x32_bf16 v[72:75], v[52:55], v[136:139], v[72:75]
    v_rcp_f32 v96, v96
    v_rcp_f32 v97, v97
    v_rcp_f32 v98, v98
    v_rcp_f32 v99, v99
    ds_read_b64_tr_b16 v[42:43], v4 offset:16896
    v_mfma_f32_16x16x32_bf16 v[76:79], v[48:51], v[132:135], 0
    v_mul_f32 v112, v112, v96
    v_mul_f32 v113, v113, v97
    v_mul_f32 v114, v114, v98
    v_mul_f32 v115, v115, v99
    v_cvt_pk_bf16_f32 v96, v112, v113
    v_cvt_pk_bf16_f32 v97, v114, v115
    v_mul_f32 v32, v100, v100
    v_mul_f32 v33, v101, v101
    ds_read_b64_tr_b16 v[44:45], v6 offset:16384
    v_mfma_f32_16x16x32_bf16 v[76:79], v[52:55], v[140:143], v[76:79]
    buffer_store_dwordx4 v[36:39], v3, s[20:23], s70 offen sc0 sc1
    v_mul_f32 v34, v102, v102
    v_mul_f32 v35, v103, v103
    v_fma_f32 v32, v32, v28, v27
    v_fma_f32 v33, v33, v28, v27
    v_fma_f32 v34, v34, v28, v27
    v_fma_f32 v35, v35, v28, v27
    v_mul_f32 v116, v100, v116
    ds_read_b64_tr_b16 v[46:47], v6 offset:16896
    s_waitcnt lgkmcnt(4)
    v_mfma_f32_16x16x32_bf16 v[88:91], v[56:59], v[128:131], 0
    v_mul_f32 v100, v32, v100
    v_mul_f32 v117, v101, v117
    v_mul_f32 v101, v33, v101
    v_mul_f32 v118, v102, v118
    v_mul_f32 v102, v34, v102
    v_mul_f32 v119, v103, v119
    v_mul_f32 v103, v35, v103
    s_lshl_b32 s70, s36, 12
    s_add_u32 s70, s70, 114688
    ds_read_b64_tr_b16 v[48:49], v4 offset:24576
    v_mfma_f32_16x16x32_bf16 v[88:91], v[60:63], v[136:139], v[88:91]
    v_exp_f32 v100, v100
    s_add_u32 s70, s70, s68
    v_exp_f32 v101, v101
    v_exp_f32 v102, v102
    v_exp_f32 v103, v103
    ds_read_b64_tr_b16 v[50:51], v4 offset:25088
    v_mfma_f32_16x16x32_bf16 v[92:95], v[56:59], v[132:135], 0
    v_fma_f32 v100, v100, v29, v29
    v_fma_f32 v101, v101, v29, v29
    v_fma_f32 v102, v102, v29, v29
    v_fma_f32 v103, v103, v29, v29
    v_rcp_f32 v100, v100
    v_rcp_f32 v101, v101
    ds_read_b64_tr_b16 v[52:53], v6 offset:24576
    v_mfma_f32_16x16x32_bf16 v[92:95], v[60:63], v[140:143], v[92:95]
    buffer_store_dwordx4 v[36:39], v3, s[20:23], s70 offen sc0 sc1
    v_rcp_f32 v102, v102
    v_rcp_f32 v103, v103
    v_mul_f32 v116, v116, v100
    v_mul_f32 v117, v117, v101
    v_mul_f32 v118, v118, v102
    v_mul_f32 v119, v119, v103
    s_lshl_b32 s70, s36, 13
    ds_read_b64_tr_b16 v[54:55], v6 offset:25088
    s_waitcnt lgkmcnt(4)
    v_mfma_f32_16x16x32_bf16 v[64:67], v[40:43], v[144:147], v[64:67]
    v_cvt_pk_bf16_f32 v98, v116, v117
    v_cvt_pk_bf16_f32 v99, v118, v119
    s_nop 0
    v_permlane16_swap_b32 v96, v98
    v_permlane16_swap_b32 v97, v99
    s_add_u32 s70, s70, 32768
    s_add_u32 s70, s70, s68
    v_mul_f32 v32, v104, v104
    v_mul_f32 v33, v105, v105
    v_mul_f32 v34, v106, v106
    ds_read_b64_tr_b16 v[56:57], v5 offset:16384
    v_mfma_f32_16x16x32_bf16 v[64:67], v[44:47], v[152:155], v[64:67]
    v_mul_f32 v35, v107, v107
    v_fma_f32 v32, v32, v25, v24
    v_fma_f32 v33, v33, v25, v24
    v_fma_f32 v34, v34, v25, v24
    v_fma_f32 v35, v35, v25, v24
    v_mul_f32 v120, v104, v120
    v_mul_f32 v104, v32, v104
    v_mul_f32 v121, v105, v121
    ds_read_b64_tr_b16 v[58:59], v5 offset:16896
    v_mfma_f32_16x16x32_bf16 v[68:71], v[40:43], v[148:151], v[68:71]
    v_mul_f32 v105, v33, v105
    v_mul_f32 v122, v106, v122
    v_mul_f32 v106, v34, v106
    v_mul_f32 v123, v107, v123
    v_mul_f32 v107, v35, v107
    v_exp_f32 v104, v104
    v_mul_f32 v32, v108, v108
    ds_read_b64_tr_b16 v[60:61], v7 offset:16384
    v_mfma_f32_16x16x32_bf16 v[68:71], v[44:47], v[156:159], v[68:71]
    buffer_store_dwordx4 v[96:99], v3, s[20:23], s70 offen sc0 sc1
    s_lshl_b32 s70, s36, 12
    s_add_u32 s70, s70, 114688
    s_add_u32 s70, s70, s69
    v_exp_f32 v105, v105
    v_exp_f32 v106, v106
    v_exp_f32 v107, v107
    v_fma_f32 v104, v104, v26, v26
    v_fma_f32 v105, v105, v26, v26
    ds_read_b64_tr_b16 v[62:63], v7 offset:16896
    v_mfma_f32_16x16x32_bf16 v[16:19], v[8:11], v[40:43], v[16:19]
    v_fma_f32 v106, v106, v26, v26
    v_fma_f32 v107, v107, v26, v26
    v_rcp_f32 v104, v104
    v_rcp_f32 v105, v105
    v_rcp_f32 v106, v106
    s_waitcnt lgkmcnt(4)
    v_mfma_f32_16x16x32_bf16 v[80:83], v[48:51], v[144:147], v[80:83]
    v_rcp_f32 v107, v107
    v_mul_f32 v120, v120, v104
    v_mul_f32 v121, v121, v105
    v_mul_f32 v122, v122, v106
    v_mul_f32 v123, v123, v107
    v_cvt_pk_bf16_f32 v104, v120, v121
    v_cvt_pk_bf16_f32 v105, v122, v123
    ds_read_b64_tr_b16 v[40:41], v5 offset:24576
    v_mfma_f32_16x16x32_bf16 v[80:83], v[52:55], v[152:155], v[80:83]
    v_mul_f32 v33, v109, v109
    v_mul_f32 v34, v110, v110
    v_mul_f32 v35, v111, v111
    v_fma_f32 v32, v32, v28, v27
    v_fma_f32 v33, v33, v28, v27
    v_fma_f32 v34, v34, v28, v27
    v_fma_f32 v35, v35, v28, v27
    v_mul_f32 v124, v108, v124
    ds_read_b64_tr_b16 v[42:43], v5 offset:25088
    v_mfma_f32_16x16x32_bf16 v[84:87], v[48:51], v[148:151], v[84:87]
    buffer_store_dwordx4 v[36:39], v3, s[20:23], s70 offen sc0 sc1
    v_mul_f32 v108, v32, v108
    v_mul_f32 v125, v109, v125
    v_mul_f32 v109, v33, v109
    v_mul_f32 v126, v110, v126
    v_mul_f32 v110, v34, v110
    v_mul_f32 v127, v111, v127
    v_mul_f32 v111, v35, v111
    s_lshl_b32 s70, s36, 13
    ds_read_b64_tr_b16 v[44:45], v7 offset:24576
    v_mfma_f32_16x16x32_bf16 v[84:87], v[52:55], v[156:159], v[84:87]
    v_exp_f32 v108, v108
    v_exp_f32 v109, v109
    v_exp_f32 v110, v110
    v_exp_f32 v111, v111
    s_add_u32 s70, s70, 32768
    s_add_u32 s70, s70, s69
    ds_read_b64_tr_b16 v[46:47], v7 offset:25088
    v_mfma_f32_16x16x32_bf16 v[16:19], v[12:15], v[48:51], v[16:19]
    v_fma_f32 v108, v108, v29, v29
    v_fma_f32 v109, v109, v29, v29
    v_fma_f32 v110, v110, v29, v29
    v_fma_f32 v111, v111, v29, v29
    v_rcp_f32 v108, v108
    v_rcp_f32 v109, v109
    s_waitcnt lgkmcnt(4)
    v_mfma_f32_16x16x32_bf16 v[72:75], v[56:59], v[144:147], v[72:75]
    v_rcp_f32 v110, v110
    v_rcp_f32 v111, v111
    v_mul_f32 v124, v124, v108
    v_mul_f32 v125, v125, v109
    v_mul_f32 v126, v126, v110
    v_mul_f32 v127, v127, v111
    v_mfma_f32_16x16x32_bf16 v[72:75], v[60:63], v[152:155], v[72:75]
    v_cvt_pk_bf16_f32 v106, v124, v125
    v_cvt_pk_bf16_f32 v107, v126, v127
    s_nop 0
    v_permlane16_swap_b32 v104, v106
    v_permlane16_swap_b32 v105, v107
    buffer_store_dwordx4 v[104:107], v3, s[20:23], s70 offen sc0 sc1
    s_waitcnt vmcnt(14)
    s_waitcnt lgkmcnt(0)
    s_barrier
    ds_read_b64_tr_b16 v[48:49], v4 offset:32768
    ds_read_b64_tr_b16 v[50:51], v4 offset:33280
    v_mfma_f32_16x16x32_bf16 v[76:79], v[56:59], v[148:151], v[76:79]
    ds_read_b64_tr_b16 v[52:53], v6 offset:32768
    ds_read_b64_tr_b16 v[54:55], v6 offset:33280
    v_mfma_f32_16x16x32_bf16 v[76:79], v[60:63], v[156:159], v[76:79]
    v_mfma_f32_16x16x32_bf16 v[88:91], v[40:43], v[144:147], v[88:91]
    ds_read_b64_tr_b16 v[56:57], v4 offset:40960
    s_add_u32 m0, s38, 0
    v_mfma_f32_16x16x32_bf16 v[88:91], v[44:47], v[152:155], v[88:91]
    ds_read_b64_tr_b16 v[58:59], v4 offset:41472
    s_mov_b32 s39, 1376384
    v_mfma_f32_16x16x32_bf16 v[92:95], v[40:43], v[148:151], v[92:95]
    ds_read_b64_tr_b16 v[60:61], v6 offset:40960
    buffer_load_dwordx4 v2, s[12:15], s39 offen lds
    v_mfma_f32_16x16x32_bf16 v[92:95], v[44:47], v[156:159], v[92:95]
    ds_read_b64_tr_b16 v[62:63], v6 offset:41472
    s_waitcnt lgkmcnt(4)
    v_mfma_f32_16x16x32_bf16 v[64:67], v[48:51], v[160:163], v[64:67]
    ds_read_b64_tr_b16 v[40:41], v5 offset:32768
    s_add_u32 m0, s38, 8192
    v_mfma_f32_16x16x32_bf16 v[64:67], v[52:55], v[168:171], v[64:67]
    ds_read_b64_tr_b16 v[42:43], v5 offset:33280
    s_mov_b32 s39, 1376384
    v_mfma_f32_16x16x32_bf16 v[68:71], v[48:51], v[164:167], v[68:71]
    ds_read_b64_tr_b16 v[44:45], v7 offset:32768
    buffer_load_dwordx4 v2, s[16:19], s39 offen lds
    v_mfma_f32_16x16x32_bf16 v[68:71], v[52:55], v[172:175], v[68:71]
    ds_read_b64_tr_b16 v[46:47], v7 offset:33280
    v_mfma_f32_16x16x32_bf16 v[16:19], v[8:11], v[48:51], v[16:19]
    s_waitcnt lgkmcnt(4)
    v_mfma_f32_16x16x32_bf16 v[80:83], v[56:59], v[160:163], v[80:83]
    ds_read_b64_tr_b16 v[48:49], v5 offset:40960
    s_add_u32 m0, s38, 16384
    v_mfma_f32_16x16x32_bf16 v[80:83], v[60:63], v[168:171], v[80:83]
    ds_read_b64_tr_b16 v[50:51], v5 offset:41472
    s_mov_b32 s39, 1605760
    v_mfma_f32_16x16x32_bf16 v[84:87], v[56:59], v[164:167], v[84:87]
    ds_read_b64_tr_b16 v[52:53], v7 offset:40960
    buffer_load_dwordx4 v2, s[12:15], s39 offen lds
    v_mfma_f32_16x16x32_bf16 v[84:87], v[60:63], v[172:175], v[84:87]
    ds_read_b64_tr_b16 v[54:55], v7 offset:41472
    v_mfma_f32_16x16x32_bf16 v[16:19], v[12:15], v[56:59], v[16:19]
    s_waitcnt lgkmcnt(4)
    v_mfma_f32_16x16x32_bf16 v[72:75], v[40:43], v[160:163], v[72:75]
    ds_read_b64_tr_b16 v[56:57], v4 offset:49152
    s_add_u32 m0, s38, 24576
    v_mfma_f32_16x16x32_bf16 v[72:75], v[44:47], v[168:171], v[72:75]
    ds_read_b64_tr_b16 v[58:59], v4 offset:49664
    s_mov_b32 s39, 1605760
    v_mfma_f32_16x16x32_bf16 v[76:79], v[40:43], v[164:167], v[76:79]
    ds_read_b64_tr_b16 v[60:61], v6 offset:49152
    buffer_load_dwordx4 v2, s[16:19], s39 offen lds
    v_mfma_f32_16x16x32_bf16 v[76:79], v[44:47], v[172:175], v[76:79]
    ds_read_b64_tr_b16 v[62:63], v6 offset:49664
    s_waitcnt lgkmcnt(4)
    v_mfma_f32_16x16x32_bf16 v[88:91], v[48:51], v[160:163], v[88:91]
    ds_read_b64_tr_b16 v[40:41], v4 offset:57344
    s_add_u32 m0, s38, 114688
    v_mfma_f32_16x16x32_bf16 v[88:91], v[52:55], v[168:171], v[88:91]
    ds_read_b64_tr_b16 v[42:43], v4 offset:57856
    s_mov_b32 s39, 786432
    v_mfma_f32_16x16x32_bf16 v[92:95], v[48:51], v[164:167], v[92:95]
    ds_read_b64_tr_b16 v[44:45], v6 offset:57344
    buffer_load_dwordx4 v30, s[40:43], s39 offen lds
    v_mfma_f32_16x16x32_bf16 v[92:95], v[52:55], v[172:175], v[92:95]
    ds_read_b64_tr_b16 v[46:47], v6 offset:57856
    s_waitcnt lgkmcnt(4)
    v_mfma_f32_16x16x32_bf16 v[64:67], v[56:59], v[176:179], v[64:67]
    ds_read_b64_tr_b16 v[48:49], v5 offset:49152
    s_add_u32 m0, s38, 122880
    v_mfma_f32_16x16x32_bf16 v[64:67], v[60:63], v[184:187], v[64:67]
    ds_read_b64_tr_b16 v[50:51], v5 offset:49664
    s_mov_b32 s39, 917504
    v_mfma_f32_16x16x32_bf16 v[68:71], v[56:59], v[180:183], v[68:71]
    ds_read_b64_tr_b16 v[52:53], v7 offset:49152
    buffer_load_dwordx4 v30, s[40:43], s39 offen lds
    v_mfma_f32_16x16x32_bf16 v[68:71], v[60:63], v[188:191], v[68:71]
    ds_read_b64_tr_b16 v[54:55], v7 offset:49664
    v_mfma_f32_16x16x32_bf16 v[16:19], v[8:11], v[56:59], v[16:19]
    s_waitcnt lgkmcnt(4)
    v_mfma_f32_16x16x32_bf16 v[80:83], v[40:43], v[176:179], v[80:83]
    ds_read_b64_tr_b16 v[56:57], v5 offset:57344
    v_mfma_f32_16x16x32_bf16 v[80:83], v[44:47], v[184:187], v[80:83]
    ds_read_b64_tr_b16 v[58:59], v5 offset:57856
    v_mfma_f32_16x16x32_bf16 v[84:87], v[40:43], v[180:183], v[84:87]
    ds_read_b64_tr_b16 v[60:61], v7 offset:57344
    v_mfma_f32_16x16x32_bf16 v[84:87], v[44:47], v[188:191], v[84:87]
    ds_read_b64_tr_b16 v[62:63], v7 offset:57856
    v_mfma_f32_16x16x32_bf16 v[16:19], v[12:15], v[40:43], v[16:19]
    s_waitcnt lgkmcnt(4)
    v_mfma_f32_16x16x32_bf16 v[72:75], v[48:51], v[176:179], v[72:75]
    v_mfma_f32_16x16x32_bf16 v[72:75], v[52:55], v[184:187], v[72:75]
    s_waitcnt vmcnt(16)
    s_waitcnt vmcnt(6)
    s_waitcnt lgkmcnt(0)
    s_barrier
    s_mov_b64 exec, 1
    buffer_atomic_inc v8, off, s[20:23], s97 offset:0 sc1
    s_mov_b64 exec, -1
    v_add_u32 v4, 0x10000, v4
    v_add_u32 v5, 0x10000, v5
    v_add_u32 v6, 0x10000, v6
    v_add_u32 v7, 0x10000, v7
    ds_read_b64_tr_b16 v[40:41], v4 offset:0
    ds_read_b64_tr_b16 v[42:43], v4 offset:512
    v_mfma_f32_16x16x32_bf16 v[76:79], v[48:51], v[180:183], v[76:79]
    ds_read_b64_tr_b16 v[44:45], v6 offset:0
    ds_read_b64_tr_b16 v[46:47], v6 offset:512
    v_mfma_f32_16x16x32_bf16 v[76:79], v[52:55], v[188:191], v[76:79]
    v_mfma_f32_16x16x32_bf16 v[88:91], v[56:59], v[176:179], v[88:91]
    ds_read_b64_tr_b16 v[48:49], v4 offset:8192
    s_add_u32 m0, s38, 32768
    v_mfma_f32_16x16x32_bf16 v[88:91], v[60:63], v[184:187], v[88:91]
    ds_read_b64_tr_b16 v[50:51], v4 offset:8704
    buffer_load_dwordx4 v1, s[8:11], 0 offen lds
    v_mfma_f32_16x16x32_bf16 v[92:95], v[56:59], v[180:183], v[92:95]
    ds_read_b64_tr_b16 v[52:53], v6 offset:8192
    v_mfma_f32_16x16x32_bf16 v[92:95], v[60:63], v[188:191], v[92:95]
    ds_read_b64_tr_b16 v[54:55], v6 offset:8704
    s_waitcnt lgkmcnt(4)
    v_mfma_f32_16x16x32_bf16 v[64:67], v[40:43], v[192:195], v[64:67]
    ds_read_b64_tr_b16 v[56:57], v5 offset:0
    s_add_u32 m0, s38, 40960
    v_mfma_f32_16x16x32_bf16 v[64:67], v[44:47], v[200:203], v[64:67]
    ds_read_b64_tr_b16 v[58:59], v5 offset:512
    s_mov_b32 s39, 196608
    v_mfma_f32_16x16x32_bf16 v[68:71], v[40:43], v[196:199], v[68:71]
    ds_read_b64_tr_b16 v[60:61], v7 offset:0
    buffer_load_dwordx4 v1, s[8:11], s39 offen lds
    v_mfma_f32_16x16x32_bf16 v[68:71], v[44:47], v[204:207], v[68:71]
    ds_read_b64_tr_b16 v[62:63], v7 offset:512
    v_mfma_f32_16x16x32_bf16 v[16:19], v[8:11], v[40:43], v[16:19]
    s_waitcnt lgkmcnt(4)
    v_mfma_f32_16x16x32_bf16 v[80:83], v[48:51], v[192:195], v[80:83]
    ds_read_b64_tr_b16 v[40:41], v5 offset:8192
    s_add_u32 m0, s38, 49152
    v_mfma_f32_16x16x32_bf16 v[80:83], v[52:55], v[200:203], v[80:83]
    ds_read_b64_tr_b16 v[42:43], v5 offset:8704
    s_mov_b32 s39, 393216
    v_mfma_f32_16x16x32_bf16 v[84:87], v[48:51], v[196:199], v[84:87]
    ds_read_b64_tr_b16 v[44:45], v7 offset:8192
    buffer_load_dwordx4 v1, s[8:11], s39 offen lds
    v_mfma_f32_16x16x32_bf16 v[84:87], v[52:55], v[204:207], v[84:87]
    ds_read_b64_tr_b16 v[46:47], v7 offset:8704
    v_mfma_f32_16x16x32_bf16 v[16:19], v[12:15], v[48:51], v[16:19]
    s_waitcnt lgkmcnt(4)
    v_mfma_f32_16x16x32_bf16 v[72:75], v[56:59], v[192:195], v[72:75]
    ds_read_b64_tr_b16 v[48:49], v4 offset:16384
    s_add_u32 m0, s38, 57344
    v_mfma_f32_16x16x32_bf16 v[72:75], v[60:63], v[200:203], v[72:75]
    ds_read_b64_tr_b16 v[50:51], v4 offset:16896
    s_mov_b32 s39, 589824
    v_mfma_f32_16x16x32_bf16 v[76:79], v[56:59], v[196:199], v[76:79]
    ds_read_b64_tr_b16 v[52:53], v6 offset:16384
    buffer_load_dwordx4 v1, s[8:11], s39 offen lds
    v_mfma_f32_16x16x32_bf16 v[76:79], v[60:63], v[204:207], v[76:79]
    ds_read_b64_tr_b16 v[54:55], v6 offset:16896
    s_waitcnt lgkmcnt(4)
    v_mfma_f32_16x16x32_bf16 v[88:91], v[40:43], v[192:195], v[88:91]
    ds_read_b64_tr_b16 v[56:57], v4 offset:24576
    s_add_u32 m0, s38, 131072
    v_mfma_f32_16x16x32_bf16 v[88:91], v[44:47], v[200:203], v[88:91]
    ds_read_b64_tr_b16 v[58:59], v4 offset:25088
    buffer_load_dwordx4 v30, s[40:43], 0 offen lds
    v_mfma_f32_16x16x32_bf16 v[92:95], v[40:43], v[196:199], v[92:95]
    ds_read_b64_tr_b16 v[60:61], v6 offset:24576
    v_mfma_f32_16x16x32_bf16 v[92:95], v[44:47], v[204:207], v[92:95]
    ds_read_b64_tr_b16 v[62:63], v6 offset:25088
    s_waitcnt lgkmcnt(4)
    v_mfma_f32_16x16x32_bf16 v[64:67], v[48:51], v[208:211], v[64:67]
    ds_read_b64_tr_b16 v[40:41], v5 offset:16384
    v_mfma_f32_16x16x32_bf16 v[64:67], v[52:55], v[216:219], v[64:67]
    ds_read_b64_tr_b16 v[42:43], v5 offset:16896
    v_mfma_f32_16x16x32_bf16 v[68:71], v[48:51], v[212:215], v[68:71]
    ds_read_b64_tr_b16 v[44:45], v7 offset:16384
    v_mfma_f32_16x16x32_bf16 v[68:71], v[52:55], v[220:223], v[68:71]
    ds_read_b64_tr_b16 v[46:47], v7 offset:16896
    v_mfma_f32_16x16x32_bf16 v[16:19], v[8:11], v[48:51], v[16:19]
    s_waitcnt lgkmcnt(4)
    v_mfma_f32_16x16x32_bf16 v[80:83], v[56:59], v[208:211], v[80:83]
    ds_read_b64_tr_b16 v[48:49], v5 offset:24576
    v_mfma_f32_16x16x32_bf16 v[80:83], v[60:63], v[216:219], v[80:83]
    ds_read_b64_tr_b16 v[50:51], v5 offset:25088
    v_mfma_f32_16x16x32_bf16 v[84:87], v[56:59], v[212:215], v[84:87]
    ds_read_b64_tr_b16 v[52:53], v7 offset:24576
    v_mfma_f32_16x16x32_bf16 v[84:87], v[60:63], v[220:223], v[84:87]
    ds_read_b64_tr_b16 v[54:55], v7 offset:25088
    v_mfma_f32_16x16x32_bf16 v[16:19], v[12:15], v[56:59], v[16:19]
    s_waitcnt lgkmcnt(4)
    v_mfma_f32_16x16x32_bf16 v[72:75], v[40:43], v[208:211], v[72:75]
    v_mfma_f32_16x16x32_bf16 v[72:75], v[44:47], v[216:219], v[72:75]
    s_waitcnt vmcnt(8)
    s_waitcnt lgkmcnt(0)
    s_barrier
    v_add_u32 v4, 0xffff0000, v4
    v_add_u32 v5, 0xffff0000, v5
    v_add_u32 v6, 0xffff0000, v6
    v_add_u32 v7, 0xffff0000, v7
    ds_read_b64_tr_b16 v[56:57], v4 offset:0
    ds_read_b64_tr_b16 v[58:59], v4 offset:512
    v_mfma_f32_16x16x32_bf16 v[76:79], v[40:43], v[212:215], v[76:79]
    ds_read_b64_tr_b16 v[60:61], v6 offset:0
    ds_read_b64_tr_b16 v[62:63], v6 offset:512
    v_mfma_f32_16x16x32_bf16 v[76:79], v[44:47], v[220:223], v[76:79]
    v_mfma_f32_16x16x32_bf16 v[88:91], v[48:51], v[208:211], v[88:91]
    ds_read_b64_tr_b16 v[40:41], v4 offset:8192
    s_add_u32 m0, s38, 65536
    v_mfma_f32_16x16x32_bf16 v[88:91], v[52:55], v[216:219], v[88:91]
    ds_read_b64_tr_b16 v[42:43], v4 offset:8704
    s_mov_b32 s39, 786432
    v_mfma_f32_16x16x32_bf16 v[92:95], v[48:51], v[212:215], v[92:95]
    ds_read_b64_tr_b16 v[44:45], v6 offset:8192
    buffer_load_dwordx4 v1, s[8:11], s39 offen lds
    v_mfma_f32_16x16x32_bf16 v[92:95], v[52:55], v[220:223], v[92:95]
    ds_read_b64_tr_b16 v[46:47], v6 offset:8704
    s_waitcnt lgkmcnt(4)
    v_mfma_f32_16x16x32_bf16 v[64:67], v[56:59], v[224:227], v[64:67]
    ds_read_b64_tr_b16 v[48:49], v5 offset:0
    s_add_u32 m0, s38, 73728
    v_mfma_f32_16x16x32_bf16 v[64:67], v[60:63], v[232:235], v[64:67]
    ds_read_b64_tr_b16 v[50:51], v5 offset:512
    s_mov_b32 s39, 983040
    v_mfma_f32_16x16x32_bf16 v[68:71], v[56:59], v[228:231], v[68:71]
    ds_read_b64_tr_b16 v[52:53], v7 offset:0
    buffer_load_dwordx4 v1, s[8:11], s39 offen lds
    v_mfma_f32_16x16x32_bf16 v[68:71], v[60:63], v[236:239], v[68:71]
    ds_read_b64_tr_b16 v[54:55], v7 offset:512
    v_mfma_f32_16x16x32_bf16 v[16:19], v[8:11], v[56:59], v[16:19]
    s_waitcnt lgkmcnt(4)
    v_mfma_f32_16x16x32_bf16 v[80:83], v[40:43], v[224:227], v[80:83]
    ds_read_b64_tr_b16 v[56:57], v5 offset:8192
    s_add_u32 m0, s38, 81920
    v_mfma_f32_16x16x32_bf16 v[80:83], v[44:47], v[232:235], v[80:83]
    ds_read_b64_tr_b16 v[58:59], v5 offset:8704
    s_mov_b32 s39, 1179648
    v_mfma_f32_16x16x32_bf16 v[84:87], v[40:43], v[228:231], v[84:87]
    ds_read_b64_tr_b16 v[60:61], v7 offset:8192
    buffer_load_dwordx4 v1, s[8:11], s39 offen lds
    v_mfma_f32_16x16x32_bf16 v[84:87], v[44:47], v[236:239], v[84:87]
    ds_read_b64_tr_b16 v[62:63], v7 offset:8704
    v_mfma_f32_16x16x32_bf16 v[16:19], v[12:15], v[40:43], v[16:19]
    s_waitcnt lgkmcnt(4)
    v_mfma_f32_16x16x32_bf16 v[72:75], v[48:51], v[224:227], v[72:75]
    ds_read_b64_tr_b16 v[40:41], v4 offset:16384
    s_add_u32 m0, s38, 90112
    v_mfma_f32_16x16x32_bf16 v[72:75], v[52:55], v[232:235], v[72:75]
    ds_read_b64_tr_b16 v[42:43], v4 offset:16896
    s_mov_b32 s39, 1376256
    v_mfma_f32_16x16x32_bf16 v[76:79], v[48:51], v[228:231], v[76:79]
    ds_read_b64_tr_b16 v[44:45], v6 offset:16384
    buffer_load_dwordx4 v1, s[8:11], s39 offen lds
    v_mfma_f32_16x16x32_bf16 v[76:79], v[52:55], v[236:239], v[76:79]
    ds_read_b64_tr_b16 v[46:47], v6 offset:16896
    s_waitcnt lgkmcnt(4)
    v_mfma_f32_16x16x32_bf16 v[88:91], v[56:59], v[224:227], v[88:91]
    ds_read_b64_tr_b16 v[48:49], v4 offset:24576
    s_add_u32 m0, s38, 139264
    v_mfma_f32_16x16x32_bf16 v[88:91], v[60:63], v[232:235], v[88:91]
    ds_read_b64_tr_b16 v[50:51], v4 offset:25088
    s_mov_b32 s39, 65536
    v_mfma_f32_16x16x32_bf16 v[92:95], v[56:59], v[228:231], v[92:95]
    ds_read_b64_tr_b16 v[52:53], v6 offset:24576
    buffer_load_dwordx4 v30, s[40:43], s39 offen lds
    v_mfma_f32_16x16x32_bf16 v[92:95], v[60:63], v[236:239], v[92:95]
    ds_read_b64_tr_b16 v[54:55], v6 offset:25088
    s_waitcnt lgkmcnt(4)
    v_mfma_f32_16x16x32_bf16 v[64:67], v[40:43], v[240:243], v[64:67]
    ds_read_b64_tr_b16 v[56:57], v5 offset:16384
    v_mfma_f32_16x16x32_bf16 v[64:67], v[44:47], v[248:251], v[64:67]
    ds_read_b64_tr_b16 v[58:59], v5 offset:16896
    v_mfma_f32_16x16x32_bf16 v[68:71], v[40:43], v[244:247], v[68:71]
    ds_read_b64_tr_b16 v[60:61], v7 offset:16384
    v_mfma_f32_16x16x32_bf16 v[68:71], v[44:47], v[252:255], v[68:71]
    ds_read_b64_tr_b16 v[62:63], v7 offset:16896
    v_mfma_f32_16x16x32_bf16 v[16:19], v[8:11], v[40:43], v[16:19]
    s_waitcnt lgkmcnt(4)
    v_mfma_f32_16x16x32_bf16 v[80:83], v[48:51], v[240:243], v[80:83]
    ds_read_b64_tr_b16 v[40:41], v5 offset:24576
    v_mfma_f32_16x16x32_bf16 v[80:83], v[52:55], v[248:251], v[80:83]
    ds_read_b64_tr_b16 v[42:43], v5 offset:25088
    v_mfma_f32_16x16x32_bf16 v[84:87], v[48:51], v[244:247], v[84:87]
    ds_read_b64_tr_b16 v[44:45], v7 offset:24576
    v_mfma_f32_16x16x32_bf16 v[84:87], v[52:55], v[252:255], v[84:87]
    ds_read_b64_tr_b16 v[46:47], v7 offset:25088
    v_mfma_f32_16x16x32_bf16 v[16:19], v[12:15], v[48:51], v[16:19]
    s_waitcnt lgkmcnt(4)
    v_mfma_f32_16x16x32_bf16 v[72:75], v[56:59], v[240:243], v[72:75]
    v_mfma_f32_16x16x32_bf16 v[72:75], v[60:63], v[248:251], v[72:75]
    s_waitcnt vmcnt(6)
    s_waitcnt lgkmcnt(0)
    s_barrier
    v_lshlrev_b32 v2, 4, v0
    ds_read_b64_tr_b16 v[48:49], v4 offset:32768
    ds_read_b64_tr_b16 v[50:51], v4 offset:33280
    v_mfma_f32_16x16x32_bf16 v[76:79], v[56:59], v[244:247], v[76:79]
    ds_read_b64_tr_b16 v[52:53], v6 offset:32768
    ds_read_b64_tr_b16 v[54:55], v6 offset:33280
    v_mfma_f32_16x16x32_bf16 v[76:79], v[60:63], v[252:255], v[76:79]
    v_mfma_f32_16x16x32_bf16 v[88:91], v[40:43], v[240:243], v[88:91]
    ds_read_b64_tr_b16 v[56:57], v5 offset:32768
    s_add_u32 m0, s38, 147456
    v_mfma_f32_16x16x32_bf16 v[88:91], v[44:47], v[248:251], v[88:91]
    ds_read_b64_tr_b16 v[58:59], v5 offset:33280
    s_mov_b32 s39, 131072
    v_mfma_f32_16x16x32_bf16 v[92:95], v[40:43], v[244:247], v[92:95]
    ds_read_b64_tr_b16 v[60:61], v7 offset:32768
    buffer_load_dwordx4 v30, s[40:43], s39 offen lds
    v_mfma_f32_16x16x32_bf16 v[92:95], v[44:47], v[252:255], v[92:95]
    ds_read_b64_tr_b16 v[62:63], v7 offset:33280
    v_and_b32 v32, 15, v0
    v_lshrrev_b32 v33, 5, v0
    v_lshl_add_u32 v32, v32, 2, s74
    v_lshl_add_u32 v32, v33, 8, v32
    v_cvt_pk_bf16_f32 v33, v16, v16
    v_lshlrev_b32 v33, 16, v33
    v_sub_f32 v33, v16, v33
    v_cvt_pk_bf16_f32 v33, v16, v33
    ds_write_b32 v32, v33 offset:1024
    s_waitcnt lgkmcnt(5)
    v_mfma_f32_16x16x32_bf16 v[96:99], v[48:51], v[128:131], 0
    ds_read_b64_tr_b16 v[40:41], v4 offset:40960
    s_add_u32 m0, s38, 0
    v_mfma_f32_16x16x32_bf16 v[96:99], v[52:55], v[136:139], v[96:99]
    ds_read_b64_tr_b16 v[42:43], v4 offset:41472
    s_mov_b32 s39, 1048576
    v_mfma_f32_16x16x32_bf16 v[100:103], v[48:51], v[132:135], 0
    ds_read_b64_tr_b16 v[44:45], v6 offset:40960
    buffer_load_dwordx4 v30, s[40:43], s39 offen lds
    v_mfma_f32_16x16x32_bf16 v[100:103], v[52:55], v[140:143], v[100:103]
    ds_read_b64_tr_b16 v[46:47], v6 offset:41472
    v_mfma_f32_16x16x32_bf16 v[16:19], v[8:11], v[48:51], 0
    s_waitcnt lgkmcnt(5)
    v_mfma_f32_16x16x32_bf16 v[104:107], v[56:59], v[128:131], 0
    ds_read_b64_tr_b16 v[48:49], v5 offset:40960
    s_add_u32 m0, s38, 8192
    v_mfma_f32_16x16x32_bf16 v[104:107], v[60:63], v[136:139], v[104:107]
    ds_read_b64_tr_b16 v[50:51], v5 offset:41472
    s_mov_b32 s39, 1179648
    v_mfma_f32_16x16x32_bf16 v[108:111], v[56:59], v[132:135], 0
    ds_read_b64_tr_b16 v[52:53], v7 offset:40960
    buffer_load_dwordx4 v30, s[40:43], s39 offen lds
    v_mfma_f32_16x16x32_bf16 v[108:111], v[60:63], v[140:143], v[108:111]
    ds_read_b64_tr_b16 v[54:55], v7 offset:41472
    s_waitcnt lgkmcnt(4)
    v_mfma_f32_16x16x32_bf16 v[96:99], v[40:43], v[144:147], v[96:99]
    ds_read_b64_tr_b16 v[56:57], v4 offset:49152
    s_add_u32 m0, s38, 16384
    v_mfma_f32_16x16x32_bf16 v[96:99], v[44:47], v[152:155], v[96:99]
    ds_read_b64_tr_b16 v[58:59], v4 offset:49664
    s_mov_b32 s39, 1310720
    v_mfma_f32_16x16x32_bf16 v[100:103], v[40:43], v[148:151], v[100:103]
    ds_read_b64_tr_b16 v[60:61], v6 offset:49152
    buffer_load_dwordx4 v30, s[40:43], s39 offen lds
    v_mfma_f32_16x16x32_bf16 v[100:103], v[44:47], v[156:159], v[100:103]
    ds_read_b64_tr_b16 v[62:63], v6 offset:49664
    v_mfma_f32_16x16x32_bf16 v[16:19], v[8:11], v[40:43], v[16:19]
    s_waitcnt lgkmcnt(4)
    v_mfma_f32_16x16x32_bf16 v[104:107], v[48:51], v[144:147], v[104:107]
    ds_read_b64_tr_b16 v[40:41], v5 offset:49152
    s_add_u32 m0, s38, 24576
    v_mfma_f32_16x16x32_bf16 v[104:107], v[52:55], v[152:155], v[104:107]
    ds_read_b64_tr_b16 v[42:43], v5 offset:49664
    s_mov_b32 s39, 1441792
    v_mfma_f32_16x16x32_bf16 v[108:111], v[48:51], v[148:151], v[108:111]
    ds_read_b64_tr_b16 v[44:45], v7 offset:49152
    buffer_load_dwordx4 v30, s[40:43], s39 offen lds
    v_mfma_f32_16x16x32_bf16 v[108:111], v[52:55], v[156:159], v[108:111]
    ds_read_b64_tr_b16 v[46:47], v7 offset:49664
    buffer_load_dword v31, off, s[20:23], s96 sc0 sc1
    s_waitcnt lgkmcnt(4)
    v_mfma_f32_16x16x32_bf16 v[96:99], v[56:59], v[160:163], v[96:99]
    ds_read_b64_tr_b16 v[48:49], v4 offset:57344
    v_mfma_f32_16x16x32_bf16 v[96:99], v[60:63], v[168:171], v[96:99]
    ds_read_b64_tr_b16 v[50:51], v4 offset:57856
    v_mfma_f32_16x16x32_bf16 v[100:103], v[56:59], v[164:167], v[100:103]
    ds_read_b64_tr_b16 v[52:53], v6 offset:57344
    v_mfma_f32_16x16x32_bf16 v[100:103], v[60:63], v[172:175], v[100:103]
    ds_read_b64_tr_b16 v[54:55], v6 offset:57856
    v_mfma_f32_16x16x32_bf16 v[16:19], v[8:11], v[56:59], v[16:19]
    s_waitcnt lgkmcnt(4)
    v_mfma_f32_16x16x32_bf16 v[104:107], v[40:43], v[160:163], v[104:107]
    ds_read_b64_tr_b16 v[56:57], v5 offset:57344
    v_mfma_f32_16x16x32_bf16 v[104:107], v[44:47], v[168:171], v[104:107]
    ds_read_b64_tr_b16 v[58:59], v5 offset:57856
    v_mfma_f32_16x16x32_bf16 v[108:111], v[40:43], v[164:167], v[108:111]
    ds_read_b64_tr_b16 v[60:61], v7 offset:57344
    v_mfma_f32_16x16x32_bf16 v[108:111], v[44:47], v[172:175], v[108:111]
    ds_read_b64_tr_b16 v[62:63], v7 offset:57856
    s_waitcnt lgkmcnt(4)
    v_mfma_f32_16x16x32_bf16 v[96:99], v[48:51], v[176:179], v[96:99]
    v_mfma_f32_16x16x32_bf16 v[96:99], v[52:55], v[184:187], v[96:99]
    s_waitcnt vmcnt(7)
    s_waitcnt lgkmcnt(0)
    s_barrier
    v_add_u32 v4, 0x10000, v4
    v_add_u32 v5, 0x10000, v5
    v_add_u32 v6, 0x10000, v6
    v_add_u32 v7, 0x10000, v7
    ds_read_b64_tr_b16 v[40:41], v4 offset:0
    ds_read_b64_tr_b16 v[42:43], v4 offset:512
    v_mfma_f32_16x16x32_bf16 v[100:103], v[48:51], v[180:183], v[100:103]
    ds_read_b64_tr_b16 v[44:45], v6 offset:0
    ds_read_b64_tr_b16 v[46:47], v6 offset:512
    v_mfma_f32_16x16x32_bf16 v[100:103], v[52:55], v[188:191], v[100:103]
    v_mfma_f32_16x16x32_bf16 v[16:19], v[8:11], v[48:51], v[16:19]
    v_mfma_f32_16x16x32_bf16 v[104:107], v[56:59], v[176:179], v[104:107]
    ds_read_b64_tr_b16 v[48:49], v5 offset:0
    s_add_u32 m0, s38, 32768
    s_mov_b32 s39, 589824
    v_mfma_f32_16x16x32_bf16 v[104:107], v[60:63], v[184:187], v[104:107]
    ds_read_b64_tr_b16 v[50:51], v5 offset:512
    buffer_load_dwordx4 v30, s[40:43], s39 offen lds
    s_add_u32 m0, s38, 40960
    v_mfma_f32_16x16x32_bf16 v[108:111], v[56:59], v[180:183], v[108:111]
    ds_read_b64_tr_b16 v[52:53], v7 offset:0
    s_mov_b32 s39, 720896
    buffer_load_dwordx4 v30, s[40:43], s39 offen lds
    v_mfma_f32_16x16x32_bf16 v[108:111], v[60:63], v[188:191], v[108:111]
    ds_read_b64_tr_b16 v[54:55], v7 offset:512
    s_waitcnt vmcnt(2)
    v_readfirstlane_b32 s71, v31
    s_cmp_ge_u32 s71, 8
    s_cbranch_scc1 K1_ok_94
    s_mov_b32 s72, 0
K1_poll_93:
    buffer_load_dword v31, off, s[20:23], s96 offset:0 sc0 sc1
    s_waitcnt vmcnt(0)
    v_readfirstlane_b32 s71, v31
    s_add_u32 s72, s72, 1
    s_cmp_ge_u32 s72, 0x20000
    s_cbranch_scc1 K1_ok_94
    s_cmp_lt_u32 s71, 8
    s_cbranch_scc1 K1_poll_93
K1_ok_94:
    s_add_u32 m0, s38, 49152
    s_mov_b32 s39, 851968
    buffer_load_dwordx4 v30, s[40:43], s39 offen lds
    v_and_b32 v33, 31, v0
    v_lshl_add_u32 v33, v33, 2, s75
    v_xor_b32 v35, 128, v33
    v_mov_b32 v37, 0
    v_mov_b32 v39, 0
    ds_read_b32 v32, v33 offset:1024
    ds_read_b32 v34, v33 offset:1280
    ds_read_b32 v36, v35 offset:1024
    ds_read_b32 v38, v35 offset:1280
    s_waitcnt lgkmcnt(3)
    v_mfma_f32_16x16x16_bf16 v[64:67], v[32:33], v[20:21], v[64:67]
    v_mfma_f32_16x16x16_bf16 v[68:71], v[32:33], v[22:23], v[68:71]
    s_waitcnt lgkmcnt(2)
    v_mfma_f32_16x16x16_bf16 v[80:83], v[34:35], v[20:21], v[80:83]
    v_mfma_f32_16x16x16_bf16 v[84:87], v[34:35], v[22:23], v[84:87]
    s_waitcnt lgkmcnt(1)
    v_mfma_f32_16x16x16_bf16 v[72:75], v[36:37], v[20:21], v[72:75]
    v_mfma_f32_16x16x16_bf16 v[76:79], v[36:37], v[22:23], v[76:79]
    s_waitcnt lgkmcnt(0)
    v_mfma_f32_16x16x16_bf16 v[88:91], v[38:39], v[20:21], v[88:91]
    v_mfma_f32_16x16x16_bf16 v[92:95], v[38:39], v[22:23], v[92:95]
    v_mul_f32 v32, v64, v64
    v_mul_f32 v33, v65, v65
    v_mul_f32 v34, v66, v66
    v_mul_f32 v35, v67, v67
    v_fma_f32 v32, v32, v25, v24
    v_fma_f32 v33, v33, v25, v24
    v_fma_f32 v34, v34, v25, v24
    v_fma_f32 v35, v35, v25, v24
    v_mul_f32 v80, v64, v80
    v_mul_f32 v64, v32, v64
    v_mul_f32 v81, v65, v81
    s_add_u32 m0, s38, 57344
    s_mov_b32 s39, 983040
    buffer_load_dwordx4 v30, s[40:43], s39 offen lds
    v_mul_f32 v65, v33, v65
    v_mul_f32 v82, v66, v82
    v_mul_f32 v66, v34, v66
    v_mul_f32 v83, v67, v83
    v_mul_f32 v67, v35, v67
    v_exp_f32 v64, v64
    v_exp_f32 v65, v65
    v_exp_f32 v66, v66
    v_exp_f32 v67, v67
    v_fma_f32 v64, v64, v26, v26
    v_fma_f32 v65, v65, v26, v26
    v_fma_f32 v66, v66, v26, v26
    s_add_u32 s93, s95, 32768
    buffer_load_dwordx4 v[160:163], v2, s[20:23], s93 offen offset:0 sc0 sc1
    v_fma_f32 v67, v67, v26, v26
    v_rcp_f32 v64, v64
    v_rcp_f32 v65, v65
    v_rcp_f32 v66, v66
    v_rcp_f32 v67, v67
    v_mul_f32 v80, v80, v64
    v_mul_f32 v81, v81, v65
    v_mul_f32 v82, v82, v66
    v_mul_f32 v83, v83, v67
    v_cvt_pk_bf16_f32 v64, v80, v81
    v_cvt_pk_bf16_f32 v65, v82, v83
    v_mul_f32 v32, v68, v68
    buffer_load_dwordx4 v[164:167], v2, s[20:23], s93 offen offset:1024 sc0 sc1
    v_mul_f32 v33, v69, v69
    v_mul_f32 v34, v70, v70
    v_mul_f32 v35, v71, v71
    v_fma_f32 v32, v32, v28, v27
    v_fma_f32 v33, v33, v28, v27
    v_fma_f32 v34, v34, v28, v27
    v_fma_f32 v35, v35, v28, v27
    v_mul_f32 v84, v68, v84
    v_mul_f32 v68, v32, v68
    v_mul_f32 v85, v69, v85
    v_mul_f32 v69, v33, v69
    v_mul_f32 v86, v70, v86
    v_mul_f32 v70, v34, v70
    v_mul_f32 v87, v71, v87
    v_mul_f32 v71, v35, v71
    v_exp_f32 v68, v68
    buffer_load_dwordx4 v[168:171], v2, s[20:23], s93 offen offset:2048 sc0 sc1
    v_exp_f32 v69, v69
    v_exp_f32 v70, v70
    v_exp_f32 v71, v71
    v_fma_f32 v68, v68, v29, v29
    v_fma_f32 v69, v69, v29, v29
    v_fma_f32 v70, v70, v29, v29
    v_fma_f32 v71, v71, v29, v29
    v_rcp_f32 v68, v68
    v_rcp_f32 v69, v69
    v_rcp_f32 v70, v70
    buffer_load_dwordx4 v[172:175], v2, s[20:23], s93 offen offset:3072 sc0 sc1
    v_rcp_f32 v71, v71
    v_mul_f32 v84, v84, v68
    v_mul_f32 v85, v85, v69
    v_mul_f32 v86, v86, v70
    v_mul_f32 v87, v87, v71
    v_cvt_pk_bf16_f32 v66, v84, v85
    v_cvt_pk_bf16_f32 v67, v86, v87
    s_nop 0
    v_permlane16_swap_b32 v64, v66
    v_permlane16_swap_b32 v65, v67
    s_lshl_b32 s70, s36, 13
    s_add_u32 s70, s70, 36864
    s_add_u32 s70, s70, s68
    buffer_store_dwordx4 v[64:67], v3, s[20:23], s70 offen sc0 sc1
    v_mul_f32 v32, v72, v72
    v_mul_f32 v33, v73, v73
    v_mul_f32 v34, v74, v74
    v_mul_f32 v35, v75, v75
    v_fma_f32 v32, v32, v25, v24
    v_fma_f32 v33, v33, v25, v24
    v_fma_f32 v34, v34, v25, v24
    s_add_u32 s93, s95, 65536
    buffer_load_dwordx4 v[176:179], v2, s[20:23], s93 offen offset:0 sc0 sc1
    v_fma_f32 v35, v35, v25, v24
    v_mul_f32 v88, v72, v88
    v_mul_f32 v72, v32, v72
    v_mul_f32 v89, v73, v89
    v_mul_f32 v73, v33, v73
    v_mul_f32 v90, v74, v90
    v_mul_f32 v74, v34, v74
    v_mul_f32 v91, v75, v91
    v_mul_f32 v75, v35, v75
    v_exp_f32 v72, v72
    v_exp_f32 v73, v73
    v_exp_f32 v74, v74
    v_exp_f32 v75, v75
    buffer_load_dwordx4 v[180:183], v2, s[20:23], s93 offen offset:1024 sc0 sc1
    v_fma_f32 v72, v72, v26, v26
    v_fma_f32 v73, v73, v26, v26
    v_fma_f32 v74, v74, v26, v26
    v_fma_f32 v75, v75, v26, v26
    v_rcp_f32 v72, v72
    v_rcp_f32 v73, v73
    v_rcp_f32 v74, v74
    v_rcp_f32 v75, v75
    v_mul_f32 v88, v88, v72
    v_mul_f32 v89, v89, v73
    v_mul_f32 v90, v90, v74
    buffer_load_dwordx4 v[184:187], v2, s[20:23], s93 offen offset:2048 sc0 sc1
    v_mul_f32 v91, v91, v75
    v_cvt_pk_bf16_f32 v72, v88, v89
    v_cvt_pk_bf16_f32 v73, v90, v91
    v_mul_f32 v32, v76, v76
    v_mul_f32 v33, v77, v77
    v_mul_f32 v34, v78, v78
    v_mul_f32 v35, v79, v79
    v_fma_f32 v32, v32, v28, v27
    v_fma_f32 v33, v33, v28, v27
    v_fma_f32 v34, v34, v28, v27
    v_fma_f32 v35, v35, v28, v27
    v_mul_f32 v92, v76, v92
    v_mul_f32 v76, v32, v76
    v_mul_f32 v93, v77, v93
    v_mul_f32 v77, v33, v77
    v_mul_f32 v94, v78, v94
    buffer_load_dwordx4 v[188:191], v2, s[20:23], s93 offen offset:3072 sc0 sc1
    v_mul_f32 v78, v34, v78
    v_mul_f32 v95, v79, v95
    v_mul_f32 v79, v35, v79
    v_exp_f32 v76, v76
    v_exp_f32 v77, v77
    v_exp_f32 v78, v78
    v_exp_f32 v79, v79
    v_fma_f32 v76, v76, v29, v29
    v_fma_f32 v77, v77, v29, v29
    v_fma_f32 v78, v78, v29, v29
    v_fma_f32 v79, v79, v29, v29
    v_rcp_f32 v76, v76
    v_rcp_f32 v77, v77
    v_rcp_f32 v78, v78
    v_rcp_f32 v79, v79
    v_mul_f32 v92, v92, v76
    v_mul_f32 v93, v93, v77
    v_mul_f32 v94, v94, v78
    v_mul_f32 v95, v95, v79
    v_cvt_pk_bf16_f32 v74, v92, v93
    v_cvt_pk_bf16_f32 v75, v94, v95
    s_nop 0
    v_permlane16_swap_b32 v72, v74
    v_permlane16_swap_b32 v73, v75
    s_lshl_b32 s70, s36, 13
    s_add_u32 s70, s70, 36864
    s_add_u32 s70, s70, s69
    buffer_store_dwordx4 v[72:75], v3, s[20:23], s70 offen sc0 sc1
    v_mfma_f32_16x16x32_bf16 v[96:99], v[40:43], v[192:195], v[96:99]
    ds_read_b64_tr_b16 v[56:57], v4 offset:8192
    v_mfma_f32_16x16x32_bf16 v[96:99], v[44:47], v[200:203], v[96:99]
    ds_read_b64_tr_b16 v[58:59], v4 offset:8704
    v_mfma_f32_16x16x32_bf16 v[100:103], v[40:43], v[196:199], v[100:103]
    ds_read_b64_tr_b16 v[60:61], v6 offset:8192
    v_mfma_f32_16x16x32_bf16 v[100:103], v[44:47], v[204:207], v[100:103]
    ds_read_b64_tr_b16 v[62:63], v6 offset:8704
    v_mfma_f32_16x16x32_bf16 v[16:19], v[8:11], v[40:43], v[16:19]
    v_mfma_f32_16x16x32_bf16 v[104:107], v[48:51], v[192:195], v[104:107]
    ds_read_b64_tr_b16 v[40:41], v5 offset:8192
    v_mfma_f32_16x16x32_bf16 v[104:107], v[52:55], v[200:203], v[104:107]
    ds_read_b64_tr_b16 v[42:43], v5 offset:8704
    v_mfma_f32_16x16x32_bf16 v[108:111], v[48:51], v[196:199], v[108:111]
    ds_read_b64_tr_b16 v[44:45], v7 offset:8192
    v_mfma_f32_16x16x32_bf16 v[108:111], v[52:55], v[204:207], v[108:111]
    ds_read_b64_tr_b16 v[46:47], v7 offset:8704
    s_waitcnt lgkmcnt(4)
    v_mfma_f32_16x16x32_bf16 v[96:99], v[56:59], v[208:211], v[96:99]
    ds_read_b64_tr_b16 v[48:49], v4 offset:16384
    v_mfma_f32_16x16x32_bf16 v[96:99], v[60:63], v[216:219], v[96:99]
    ds_read_b64_tr_b16 v[50:51], v4 offset:16896
    v_mfma_f32_16x16x32_bf16 v[100:103], v[56:59], v[212:215], v[100:103]
    ds_read_b64_tr_b16 v[52:53], v6 offset:16384
    v_mfma_f32_16x16x32_bf16 v[100:103], v[60:63], v[220:223], v[100:103]
    ds_read_b64_tr_b16 v[54:55], v6 offset:16896
    v_mfma_f32_16x16x32_bf16 v[16:19], v[8:11], v[56:59], v[16:19]
    s_waitcnt lgkmcnt(4)
    v_mfma_f32_16x16x32_bf16 v[104:107], v[40:43], v[208:211], v[104:107]
    ds_read_b64_tr_b16 v[56:57], v5 offset:16384
    v_mfma_f32_16x16x32_bf16 v[104:107], v[44:47], v[216:219], v[104:107]
    ds_read_b64_tr_b16 v[58:59], v5 offset:16896
    v_mfma_f32_16x16x32_bf16 v[108:111], v[40:43], v[212:215], v[108:111]
    ds_read_b64_tr_b16 v[60:61], v7 offset:16384
    v_mfma_f32_16x16x32_bf16 v[108:111], v[44:47], v[220:223], v[108:111]
    ds_read_b64_tr_b16 v[62:63], v7 offset:16896
    s_add_u32 s92, s90, 8704
    buffer_load_dword v1, off, s[20:23], s92 sc0 sc1
    s_waitcnt lgkmcnt(4)
    v_mfma_f32_16x16x32_bf16 v[96:99], v[48:51], v[224:227], v[96:99]
    ds_read_b64_tr_b16 v[40:41], v4 offset:24576
    v_mfma_f32_16x16x32_bf16 v[96:99], v[52:55], v[232:235], v[96:99]
    ds_read_b64_tr_b16 v[42:43], v4 offset:25088
    v_mfma_f32_16x16x32_bf16 v[100:103], v[48:51], v[228:231], v[100:103]
    ds_read_b64_tr_b16 v[44:45], v6 offset:24576
    v_mfma_f32_16x16x32_bf16 v[100:103], v[52:55], v[236:239], v[100:103]
    ds_read_b64_tr_b16 v[46:47], v6 offset:25088
    v_mfma_f32_16x16x32_bf16 v[16:19], v[8:11], v[48:51], v[16:19]
    s_waitcnt lgkmcnt(4)
    v_mfma_f32_16x16x32_bf16 v[104:107], v[56:59], v[224:227], v[104:107]
    ds_read_b64_tr_b16 v[48:49], v5 offset:24576
    v_mfma_f32_16x16x32_bf16 v[104:107], v[60:63], v[232:235], v[104:107]
    ds_read_b64_tr_b16 v[50:51], v5 offset:25088
    v_mfma_f32_16x16x32_bf16 v[108:111], v[56:59], v[228:231], v[108:111]
    ds_read_b64_tr_b16 v[52:53], v7 offset:24576
    v_mfma_f32_16x16x32_bf16 v[108:111], v[60:63], v[236:239], v[108:111]
    ds_read_b64_tr_b16 v[54:55], v7 offset:25088
    s_waitcnt lgkmcnt(4)
    v_mfma_f32_16x16x32_bf16 v[96:99], v[40:43], v[240:243], v[96:99]
    v_mfma_f32_16x16x32_bf16 v[96:99], v[44:47], v[248:251], v[96:99]
    v_mfma_f32_16x16x32_bf16 v[100:103], v[40:43], v[244:247], v[100:103]
    v_mfma_f32_16x16x32_bf16 v[100:103], v[44:47], v[252:255], v[100:103]
    v_mfma_f32_16x16x32_bf16 v[16:19], v[8:11], v[40:43], v[16:19]
    s_waitcnt lgkmcnt(0)
    v_mfma_f32_16x16x32_bf16 v[104:107], v[48:51], v[240:243], v[104:107]
    v_mfma_f32_16x16x32_bf16 v[104:107], v[52:55], v[248:251], v[104:107]
    v_mfma_f32_16x16x32_bf16 v[108:111], v[48:51], v[244:247], v[108:111]
    v_mfma_f32_16x16x32_bf16 v[108:111], v[52:55], v[252:255], v[108:111]
    v_and_b32 v32, 15, v0
    v_lshrrev_b32 v33, 5, v0
    v_lshl_add_u32 v32, v32, 2, s74
    v_lshl_add_u32 v32, v33, 8, v32
    v_cvt_pk_bf16_f32 v33, v16, v16
    v_lshlrev_b32 v33, 16, v33
    v_sub_f32 v33, v16, v33
    v_cvt_pk_bf16_f32 v33, v16, v33
    ds_write_b32 v32, v33 offset:2048
    s_waitcnt lgkmcnt(0)
    s_barrier
    v_and_b32 v33, 31, v0
    v_lshl_add_u32 v33, v33, 2, s75
    v_xor_b32 v35, 128, v33
    ds_read_b32 v32, v33 offset:2048
    ds_read_b32 v34, v35 offset:2048
    s_waitcnt lgkmcnt(1)
    v_mfma_f32_16x16x16_bf16 v[96:99], v[32:33], v[20:21], v[96:99]
    v_mfma_f32_16x16x16_bf16 v[100:103], v[32:33], v[22:23], v[100:103]
    s_waitcnt lgkmcnt(0)
    v_mfma_f32_16x16x16_bf16 v[104:107], v[34:35], v[20:21], v[104:107]
    v_mfma_f32_16x16x16_bf16 v[108:111], v[34:35], v[22:23], v[108:111]
    v_mov_b32 v132, 1.0
    v_mov_b32 v133, 1.0
    v_mov_b32 v134, 1.0
    v_mov_b32 v135, 1.0
    s_waitcnt vmcnt(0)
    v_readfirstlane_b32 s71, v1
    s_cmp_ge_u32 s71, 16
    s_cbranch_scc1 K1_ok_96
    s_mov_b32 s72, 0
K1_poll_95:
    buffer_load_dword v1, off, s[20:23], s92 offset:0 sc0 sc1
    s_waitcnt vmcnt(0)
    v_readfirstlane_b32 s71, v1
    s_add_u32 s72, s72, 1
    s_cmp_ge_u32 s72, 0x20000
    s_cbranch_scc1 K1_ok_96
    s_cmp_lt_u32 s71, 16
    s_cbranch_scc1 K1_poll_95
K1_ok_96:
    s_add_u32 s70, s90, s38
    buffer_load_dwordx4 v[128:131], v2, s[20:23], s70 offen sc0 sc1
    s_add_u32 s70, s90, 8192
    s_mov_b32 exec_hi, 0
    buffer_load_dwordx4 v[132:135], v2, s[20:23], s70 offen sc0 sc1
    s_mov_b32 exec_hi, -1
    v_lshrrev_b32 v37, 5, v0
    v_bfe_u32 v36, v0, 2, 2
    v_lshl_add_u32 v37, v37, 3, v36
    s_add_u32 m0, s38, 65536
    s_mov_b32 s39, 1114112
    buffer_load_dwordx4 v30, s[40:43], s39 offen lds
    v_lshlrev_b32 v37, 5, v37
    v_bfe_u32 v36, v0, 4, 1
    v_lshl_add_u32 v37, v36, 4, v37
    v_bfe_u32 v36, v0, 1, 1
    v_lshl_add_u32 v37, v36, 3, v37
    v_xor_b32 v36, s33, v0
    v_and_b32 v36, 1, v36
    v_lshl_add_u32 v37, v36, 9, v37
    s_lshl_b32 s70, s34, 10
    s_add_u32 s70, s70, 160768
    v_add_u32 v37, s70, v37
    v_cvt_pk_bf16_f32 v96, v96, v97
    v_cvt_pk_bf16_f32 v97, v98, v99
    v_cvt_pk_bf16_f32 v98, v100, v101
    v_cvt_pk_bf16_f32 v99, v102, v103
    ds_read_b64_tr_b16 v[100:101], v37
    ds_read_b64_tr_b16 v[102:103], v37 offset:128
    v_cvt_pk_bf16_f32 v104, v104, v105
    v_cvt_pk_bf16_f32 v105, v106, v107
    v_cvt_pk_bf16_f32 v106, v108, v109
    v_cvt_pk_bf16_f32 v107, v110, v111
    v_permlane16_swap_b32 v96, v98
    v_permlane16_swap_b32 v97, v99
    v_permlane16_swap_b32 v104, v106
    v_permlane16_swap_b32 v105, v107
    s_waitcnt lgkmcnt(1)
    v_cndmask_b32 v108, 0, v100, s[88:89]
    v_cndmask_b32 v109, 0, v101, s[88:89]
    s_waitcnt lgkmcnt(0)
    v_cndmask_b32 v110, 0, v102, s[88:89]
    s_add_u32 m0, s38, 73728
    s_mov_b32 s39, 1245184
    buffer_load_dwordx4 v30, s[40:43], s39 offen lds
    v_cndmask_b32 v111, 0, v103, s[88:89]
    v_cndmask_b32 v100, 0, v100, s[86:87]
    v_cndmask_b32 v101, 0, v101, s[86:87]
    v_cndmask_b32 v102, 0, v102, s[86:87]
    v_cndmask_b32 v103, 0, v103, s[86:87]
    v_mfma_f32_32x32x16_bf16 v[112:127], v[108:111], v[104:107], 0
    s_nop 0
    v_mfma_f32_32x32x16_bf16 v[112:127], v[100:103], v[96:99], v[112:127]
    v_cndmask_b32 v36, v24, v27, s[84:85]
    v_mul_f32 v36, 0xbf206c99, v36
    s_nop 9
    v_max3_f32 v32, v112, v113, v114
    v_min3_f32 v34, v112, v113, v114
    v_max3_f32 v32, v32, v115, v116
    v_min3_f32 v34, v34, v115, v116
    v_max3_f32 v32, v32, v117, v118
    v_min3_f32 v34, v34, v117, v118
    v_max3_f32 v32, v32, v119, v120
    v_min3_f32 v34, v34, v119, v120
    v_max3_f32 v32, v32, v121, v122
    v_min3_f32 v34, v34, v121, v122
    v_max3_f32 v32, v32, v123, v124
    v_min3_f32 v34, v34, v123, v124
    v_max3_f32 v32, v32, v125, v126
    s_add_u32 m0, s38, 81920
    s_mov_b32 s39, 1376256
    buffer_load_dwordx4 v30, s[40:43], s39 offen lds
    v_min3_f32 v34, v34, v125, v126
    v_max_f32 v32, v32, v127
    v_min_f32 v34, v34, v127
    v_mul_f32 v32, v32, v36
    v_mul_f32 v34, v34, v36
    v_fma_f32 v96, v112, v36, -v32
    v_fma_f32 v112, -v112, v36, v34
    v_fma_f32 v97, v113, v36, -v32
    v_fma_f32 v113, -v113, v36, v34
    v_exp_f32 v96, v96
    v_exp_f32 v112, v112
    v_exp_f32 v97, v97
    v_exp_f32 v113, v113
    v_fma_f32 v98, v114, v36, -v32
    v_fma_f32 v114, -v114, v36, v34
    v_fma_f32 v99, v115, v36, -v32
    s_add_u32 m0, s38, 90112
    s_mov_b32 s39, 1507328
    buffer_load_dwordx4 v30, s[40:43], s39 offen lds
    v_fma_f32 v115, -v115, v36, v34
    v_exp_f32 v98, v98
    v_exp_f32 v114, v114
    v_exp_f32 v99, v99
    v_exp_f32 v115, v115
    v_fma_f32 v100, v116, v36, -v32
    v_fma_f32 v116, -v116, v36, v34
    v_fma_f32 v101, v117, v36, -v32
    v_fma_f32 v117, -v117, v36, v34
    v_exp_f32 v100, v100
    v_exp_f32 v116, v116
    v_exp_f32 v101, v101
    v_exp_f32 v117, v117
    s_add_u32 s93, s95, 36864
    buffer_load_dwordx4 v[192:195], v2, s[20:23], s93 offen offset:0 sc0 sc1
    v_fma_f32 v102, v118, v36, -v32
    v_fma_f32 v118, -v118, v36, v34
    v_fma_f32 v103, v119, v36, -v32
    v_fma_f32 v119, -v119, v36, v34
    v_exp_f32 v102, v102
    v_exp_f32 v118, v118
    v_exp_f32 v103, v103
    v_exp_f32 v119, v119
    v_fma_f32 v104, v120, v36, -v32
    v_fma_f32 v120, -v120, v36, v34
    v_fma_f32 v105, v121, v36, -v32
    v_fma_f32 v121, -v121, v36, v34
    v_exp_f32 v104, v104
    v_exp_f32 v120, v120
    buffer_load_dwordx4 v[196:199], v2, s[20:23], s93 offen offset:1024 sc0 sc1
    v_exp_f32 v105, v105
    v_exp_f32 v121, v121
    v_fma_f32 v106, v122, v36, -v32
    v_fma_f32 v122, -v122, v36, v34
    v_fma_f32 v107, v123, v36, -v32
    v_fma_f32 v123, -v123, v36, v34
    v_exp_f32 v106, v106
    v_exp_f32 v122, v122
    v_exp_f32 v107, v107
    v_exp_f32 v123, v123
    v_fma_f32 v108, v124, v36, -v32
    v_fma_f32 v124, -v124, v36, v34
    v_fma_f32 v109, v125, v36, -v32
    buffer_load_dwordx4 v[200:203], v2, s[20:23], s93 offen offset:2048 sc0 sc1
    v_fma_f32 v125, -v125, v36, v34
    v_exp_f32 v108, v108
    v_exp_f32 v124, v124
    v_exp_f32 v109, v109
    v_exp_f32 v125, v125
    v_fma_f32 v110, v126, v36, -v32
    v_fma_f32 v126, -v126, v36, v34
    v_fma_f32 v111, v127, v36, -v32
    v_fma_f32 v127, -v127, v36, v34
    v_exp_f32 v110, v110
    v_exp_f32 v126, v126
    v_exp_f32 v111, v111
    v_exp_f32 v127, v127
    buffer_load_dword v31, off, s[20:23], s96 offset:128 sc0 sc1
    buffer_load_dwordx4 v[204:207], v2, s[20:23], s93 offen offset:3072 sc0 sc1
    v_lshrrev_b32 v33, 1, v2
    s_lshr_b32 s70, s38, 1
    s_add_u32 s70, s70, 155648
    v_add_u32 v35, s70, v33
    v_add_u32 v33, 162816, v33
    s_waitcnt vmcnt(10)
    v_cvt_pk_bf16_f32 v128, v128, v129
    v_cvt_pk_bf16_f32 v129, v130, v131
    s_waitcnt vmcnt(9)
    v_cvt_pk_bf16_f32 v130, v132, v133
    v_cvt_pk_bf16_f32 v131, v134, v135
    ds_write_b64 v35, v[128:129]
    ds_write_b64 v33, v[130:131]
    v_and_b32 v36, 3, v0
    v_bfe_u32 v39, v0, 2, 1
    v_lshl_add_u32 v36, v39, 3, v36
    v_bfe_u32 v39, v0, 3, 1
    v_lshl_add_u32 v36, v39, 2, v36
    s_lshl_b32 s70, s34, 1
    s_and_b32 s71, s33, 1
    s_or_b32 s70, s70, s71
    s_lshl_b32 s71, s70, 10
    s_add_u32 s71, s71, 155648
    s_lshl_b32 s70, s70, 6
    s_add_u32 s70, s70, 162816
    v_lshl_add_u32 v36, v36, 6, s71
    v_and_b32 v39, 1, v0
    v_lshl_add_u32 v39, v39, 8, s70
    v_cndmask_b32 v36, v36, v39, s[84:85]
    v_lshrrev_b32 v39, 5, v0
    v_lshl_add_u32 v36, v39, 4, v36
    v_mov_b32 v39, 0x400
    s_add_u32 s93, s95, 69632
    buffer_load_dwordx4 v[208:211], v2, s[20:23], s93 offen offset:0 sc0 sc1
    v_cndmask_b32 v39, v39, 64, s[84:85]
    v_xor_b32 v39, v39, v36
    v_cvt_pk_bf16_f32 v96, v96, v97
    v_cvt_pk_bf16_f32 v97, v98, v99
    v_cvt_pk_bf16_f32 v98, v100, v101
    v_cvt_pk_bf16_f32 v99, v102, v103
    v_cvt_pk_bf16_f32 v100, v104, v105
    v_cvt_pk_bf16_f32 v101, v106, v107
    v_cvt_pk_bf16_f32 v102, v108, v109
    v_cvt_pk_bf16_f32 v103, v110, v111
    s_waitcnt lgkmcnt(0)
    s_barrier
    ds_read_b128 v[128:131], v36 offset:0
    ds_read_b128 v[132:135], v36 offset:32
    ds_read_b128 v[136:139], v39 offset:0
    ds_read_b128 v[140:143], v39 offset:32
    v_permlane32_swap_b32 v96, v100
    v_permlane32_swap_b32 v97, v101
    v_permlane32_swap_b32 v98, v102
    v_permlane32_swap_b32 v99, v103
    v_cvt_pk_bf16_f32 v112, v112, v113
    v_cvt_pk_bf16_f32 v113, v114, v115
    v_cvt_pk_bf16_f32 v114, v116, v117
    v_cvt_pk_bf16_f32 v115, v118, v119
    v_cvt_pk_bf16_f32 v116, v120, v121
    v_cvt_pk_bf16_f32 v117, v122, v123
    v_cvt_pk_bf16_f32 v118, v124, v125
    v_cvt_pk_bf16_f32 v119, v126, v127
    v_permlane32_swap_b32 v112, v116
    v_permlane32_swap_b32 v113, v117
    v_permlane32_swap_b32 v114, v118
    v_permlane32_swap_b32 v115, v119
    s_waitcnt lgkmcnt(3)
    v_mfma_f32_32x32x16_bf16 v[64:79], v[128:131], v[96:99], 0
    s_waitcnt lgkmcnt(2)
    v_mfma_f32_32x32x16_bf16 v[80:95], v[132:135], v[112:115], 0
    s_waitcnt lgkmcnt(1)
    v_mfma_f32_32x32x16_bf16 v[40:55], v[136:139], v[100:103], 0
    s_waitcnt lgkmcnt(0)
    v_mfma_f32_32x32x16_bf16 v[144:159], v[140:143], v[116:119], 0
    s_nop 5
    v_rcp_f32 v73, v73
    buffer_load_dwordx4 v[212:215], v2, s[20:23], s93 offen offset:1024 sc0 sc1
    v_rcp_f32 v89, v89
    v_fmaak_f32 v72, v72, v73, 0xb61a7fa3
    v_fmac_f32 v72, v88, v89
    v_rcp_f32 v72, v72
    s_nop 0
    v_mul_f32 v73, v73, v72
    v_mul_f32 v89, v89, v72
    v_mul_f32 v64, v64, v73
    v_mul_f32 v65, v65, v73
    v_mul_f32 v66, v66, v73
    v_mul_f32 v67, v67, v73
    v_mul_f32 v68, v68, v73
    v_mul_f32 v69, v69, v73
    v_mul_f32 v70, v70, v73
    v_mul_f32 v71, v71, v73
    v_fmac_f32 v64, v80, v89
    v_fmac_f32 v65, v81, v89
    v_fmac_f32 v66, v82, v89
    v_fmac_f32 v67, v83, v89
    buffer_load_dwordx4 v[216:219], v2, s[20:23], s93 offen offset:2048 sc0 sc1
    v_fmac_f32 v68, v84, v89
    v_fmac_f32 v69, v85, v89
    v_fmac_f32 v70, v86, v89
    v_fmac_f32 v71, v87, v89
    v_cvt_pk_bf16_f32 v64, v64, v65
    v_cvt_pk_bf16_f32 v65, v66, v67
    v_cvt_pk_bf16_f32 v66, v68, v69
    v_cvt_pk_bf16_f32 v67, v70, v71
    s_lshl_b32 s70, s36, 12
    s_add_u32 s70, s70, 114688
    s_add_u32 s70, s70, s68
    buffer_store_dwordx4 v[64:67], v3, s[20:23], s70 offen sc0 sc1
    v_rcp_f32 v49, v49
    v_rcp_f32 v153, v153
    v_fmaak_f32 v48, v48, v49, 0xb61a7fa3
    v_fmac_f32 v48, v152, v153
    v_rcp_f32 v48, v48
    s_nop 0
    v_mul_f32 v49, v49, v48
    v_mul_f32 v153, v153, v48
    v_mul_f32 v40, v40, v49
    v_mul_f32 v41, v41, v49
    buffer_load_dwordx4 v[220:223], v2, s[20:23], s93 offen offset:3072 sc0 sc1
    v_mul_f32 v42, v42, v49
    v_mul_f32 v43, v43, v49
    v_mul_f32 v44, v44, v49
    v_mul_f32 v45, v45, v49
    v_mul_f32 v46, v46, v49
    v_mul_f32 v47, v47, v49
    v_fmac_f32 v40, v144, v153
    v_fmac_f32 v41, v145, v153
    v_fmac_f32 v42, v146, v153
    v_fmac_f32 v43, v147, v153
    v_fmac_f32 v44, v148, v153
    v_fmac_f32 v45, v149, v153
    v_fmac_f32 v46, v150, v153
    v_fmac_f32 v47, v151, v153
    v_cvt_pk_bf16_f32 v40, v40, v41
    v_cvt_pk_bf16_f32 v41, v42, v43
    v_cvt_pk_bf16_f32 v42, v44, v45
    v_cvt_pk_bf16_f32 v43, v46, v47
    s_lshl_b32 s70, s36, 12
    s_add_u32 s70, s70, 114688
    s_add_u32 s70, s70, s69
    buffer_store_dwordx4 v[40:43], v3, s[20:23], s70 offen sc0 sc1
    s_waitcnt vmcnt(7)
    v_readfirstlane_b32 s71, v31
    s_cmp_ge_u32 s71, 8
    s_cbranch_scc1 K1_ok_98
    s_mov_b32 s72, 0
K1_poll_97:
    buffer_load_dword v31, off, s[20:23], s96 offset:128 sc0 sc1
    s_waitcnt vmcnt(0)
    v_readfirstlane_b32 s71, v31
    s_add_u32 s72, s72, 1
    s_cmp_ge_u32 s72, 0x20000
    s_cbranch_scc1 K1_ok_98
    s_cmp_lt_u32 s71, 8
    s_cbranch_scc1 K1_poll_97
K1_ok_98:
    v_lshrrev_b32 v32, 5, v0
    v_bfe_u32 v33, v0, 2, 2
    v_lshl_add_u32 v32, v32, 3, v33
    s_lshl_b32 s70, s33, 13
    s_add_u32 s71, s70, 65536
    v_lshl_add_u32 v32, v32, 7, s71
    v_bfe_u32 v33, v0, 3, 1
    v_bfe_u32 v34, v0, 4, 1
    v_lshl_or_b32 v33, v33, 1, v34
    v_xor_b32 v33, s33, v33
    v_lshl_add_u32 v32, v33, 5, v32
    v_and_b32 v33, 1, v0
    v_lshl_add_u32 v32, v33, 4, v32
    v_bfe_u32 v33, v0, 1, 1
    v_lshl_add_u32 v4, v33, 3, v32
    v_xor_b32 v5, 64, v4
    ds_read_b64_tr_b16 v[40:41], v4 offset:32768
    ds_read_b64_tr_b16 v[42:43], v4 offset:33280
    ds_read_b64_tr_b16 v[44:45], v5 offset:32768
    ds_read_b64_tr_b16 v[46:47], v5 offset:33280
    ds_read_b64_tr_b16 v[48:49], v4 offset:34816
    ds_read_b64_tr_b16 v[50:51], v4 offset:35328
    ds_read_b64_tr_b16 v[52:53], v5 offset:34816
    ds_read_b64_tr_b16 v[54:55], v5 offset:35328
    s_lshl_b32 s71, s34, 15
    s_add_u32 s70, s70, s71
    v_add_u32 v16, s70, v2
    v_xor_b32 v13, 0x2000, v16
    v_xor_b32 v14, 0x4000, v16
    v_xor_b32 v15, 0x6000, v16
    v_add_u32 v36, 98304, v13
    v_add_u32 v37, 98304, v14
    v_add_u32 v38, 98304, v15
    v_add_u32 v39, 98304, v16
    v_and_b32 v32, 31, v0
    v_lshrrev_b32 v33, 5, v0
    v_lshlrev_b32 v33, 4, v33
    v_lshl_add_u32 v12, v32, 10, v33
    s_waitcnt lgkmcnt(4)
    v_mfma_f32_32x32x16_bf16 v[96:111], v[40:43], v[160:163], 0
    ds_read_b64_tr_b16 v[56:57], v4 offset:36864
    ds_read_b64_tr_b16 v[58:59], v4 offset:37376
    v_mfma_f32_32x32x16_bf16 v[112:127], v[44:47], v[160:163], 0
    ds_read_b64_tr_b16 v[60:61], v5 offset:36864
    ds_read_b64_tr_b16 v[62:63], v5 offset:37376
    s_add_u32 s93, s94, 0
    buffer_load_dwordx4 v[224:227], v2, s[20:23], s93 offen offset:0 sc0 sc1
    s_waitcnt lgkmcnt(4)
    v_mfma_f32_32x32x16_bf16 v[96:111], v[48:51], v[164:167], v[96:111]
    ds_read_b64_tr_b16 v[40:41], v4 offset:38912
    ds_read_b64_tr_b16 v[42:43], v4 offset:39424
    buffer_load_dwordx4 v[228:231], v2, s[20:23], s93 offen offset:1024 sc0 sc1
    v_mfma_f32_32x32x16_bf16 v[112:127], v[52:55], v[164:167], v[112:127]
    ds_read_b64_tr_b16 v[44:45], v5 offset:38912
    ds_read_b64_tr_b16 v[46:47], v5 offset:39424
    buffer_load_dwordx4 v[232:235], v2, s[20:23], s93 offen offset:2048 sc0 sc1
    s_waitcnt lgkmcnt(4)
    v_mfma_f32_32x32x16_bf16 v[96:111], v[56:59], v[168:171], v[96:111]
    v_add_u32 v4, 0xffff0000, v4
    v_add_u32 v5, 0xffff0000, v5
    ds_read_b64_tr_b16 v[48:49], v4 offset:0
    ds_read_b64_tr_b16 v[50:51], v4 offset:512
    v_mfma_f32_32x32x16_bf16 v[112:127], v[60:63], v[168:171], v[112:127]
    ds_read_b64_tr_b16 v[52:53], v5 offset:0
    ds_read_b64_tr_b16 v[54:55], v5 offset:512
    buffer_load_dwordx4 v[236:239], v2, s[20:23], s93 offen offset:3072 sc0 sc1
    s_waitcnt lgkmcnt(4)
    v_mfma_f32_32x32x16_bf16 v[96:111], v[40:43], v[172:175], v[96:111]
    ds_read_b64_tr_b16 v[56:57], v4 offset:2048
    ds_read_b64_tr_b16 v[58:59], v4 offset:2560
    s_add_u32 s93, s94, 16384
    buffer_load_dwordx4 v[240:243], v2, s[20:23], s93 offen offset:0 sc0 sc1
    v_mfma_f32_32x32x16_bf16 v[112:127], v[44:47], v[172:175], v[112:127]
    ds_read_b64_tr_b16 v[60:61], v5 offset:2048
    ds_read_b64_tr_b16 v[62:63], v5 offset:2560
    buffer_load_dwordx4 v[244:247], v2, s[20:23], s93 offen offset:1024 sc0 sc1
    s_waitcnt lgkmcnt(4)
    v_mfma_f32_32x32x16_bf16 v[96:111], v[48:51], v[176:179], v[96:111]
    ds_read_b64_tr_b16 v[40:41], v4 offset:4096
    ds_read_b64_tr_b16 v[42:43], v4 offset:4608
    v_mfma_f32_32x32x16_bf16 v[112:127], v[52:55], v[176:179], v[112:127]
    ds_read_b64_tr_b16 v[44:45], v5 offset:4096
    ds_read_b64_tr_b16 v[46:47], v5 offset:4608
    buffer_load_dwordx4 v[248:251], v2, s[20:23], s93 offen offset:2048 sc0 sc1
    s_waitcnt lgkmcnt(4)
    v_mfma_f32_32x32x16_bf16 v[96:111], v[56:59], v[180:183], v[96:111]
    ds_read_b64_tr_b16 v[48:49], v4 offset:6144
    ds_read_b64_tr_b16 v[50:51], v4 offset:6656
    v_mfma_f32_32x32x16_bf16 v[112:127], v[60:63], v[180:183], v[112:127]
    ds_read_b64_tr_b16 v[52:53], v5 offset:6144
    ds_read_b64_tr_b16 v[54:55], v5 offset:6656
    buffer_load_dwordx4 v[252:255], v2, s[20:23], s93 offen offset:3072 sc0 sc1
    s_waitcnt lgkmcnt(4)
    v_mfma_f32_32x32x16_bf16 v[96:111], v[40:43], v[184:187], v[96:111]
    s_waitcnt lgkmcnt(0)
    s_barrier
    ds_read_b64_tr_b16 v[56:57], v4 offset:32768
    ds_read_b64_tr_b16 v[58:59], v4 offset:33280
    v_mfma_f32_32x32x16_bf16 v[112:127], v[44:47], v[184:187], v[112:127]
    ds_read_b64_tr_b16 v[60:61], v5 offset:32768
    ds_read_b64_tr_b16 v[62:63], v5 offset:33280
    s_add_u32 m0, s38, 155648
    s_mov_b32 s39, 196608
    buffer_load_dwordx4 v30, s[40:43], s39 offen lds
    v_mfma_f32_32x32x16_bf16 v[96:111], v[48:51], v[188:191], v[96:111]
    ds_read_b64_tr_b16 v[40:41], v4 offset:34816
    ds_read_b64_tr_b16 v[42:43], v4 offset:35328
    v_mfma_f32_32x32x16_bf16 v[112:127], v[52:55], v[188:191], v[112:127]
    ds_read_b64_tr_b16 v[44:45], v5 offset:34816
    ds_read_b64_tr_b16 v[46:47], v5 offset:35328
    s_add_u32 m0, s38, 98304
    s_mov_b32 s39, 262144
    buffer_load_dwordx4 v30, s[40:43], s39 offen lds
    v_max3_u32 v32, v192, v193, v194
    v_max_u32 v32, v32, v195
    v_cmp_eq_u32 vcc, -1, v32
    s_cbranch_vccnz K1_re_99
K1_bk_101:
    s_waitcnt lgkmcnt(4)
    v_mfma_f32_32x32x16_bf16 v[96:111], v[56:59], v[192:195], v[96:111]
    ds_read_b64_tr_b16 v[48:49], v4 offset:36864
    ds_read_b64_tr_b16 v[50:51], v4 offset:37376
    s_add_u32 m0, s38, 106496
    s_mov_b32 s39, 327680
    buffer_load_dwordx4 v30, s[40:43], s39 offen lds
    v_mfma_f32_32x32x16_bf16 v[112:127], v[60:63], v[192:195], v[112:127]
    ds_read_b64_tr_b16 v[52:53], v5 offset:36864
    ds_read_b64_tr_b16 v[54:55], v5 offset:37376
    v_max3_u32 v32, v196, v197, v198
    v_max_u32 v32, v32, v199
    v_cmp_eq_u32 vcc, -1, v32
    s_cbranch_vccnz K1_re_102
K1_bk_104:
    s_waitcnt lgkmcnt(4)
    v_mfma_f32_32x32x16_bf16 v[96:111], v[40:43], v[196:199], v[96:111]
    ds_read_b64_tr_b16 v[56:57], v4 offset:38912
    ds_read_b64_tr_b16 v[58:59], v4 offset:39424
    s_add_u32 m0, s38, 114688
    s_mov_b32 s39, 393216
    buffer_load_dwordx4 v30, s[40:43], s39 offen lds
    v_mfma_f32_32x32x16_bf16 v[112:127], v[44:47], v[196:199], v[112:127]
    ds_read_b64_tr_b16 v[60:61], v5 offset:38912
    ds_read_b64_tr_b16 v[62:63], v5 offset:39424
    v_max3_u32 v32, v200, v201, v202
    v_max_u32 v32, v32, v203
    v_cmp_eq_u32 vcc, -1, v32
    s_cbranch_vccnz K1_re_105
K1_bk_107:
    s_waitcnt lgkmcnt(4)
    v_mfma_f32_32x32x16_bf16 v[96:111], v[48:51], v[200:203], v[96:111]
    v_add_u32 v4, 0x10000, v4
    v_add_u32 v5, 0x10000, v5
    ds_read_b64_tr_b16 v[40:41], v4 offset:0
    ds_read_b64_tr_b16 v[42:43], v4 offset:512
    s_add_u32 m0, s38, 122880
    s_mov_b32 s39, 458752
    buffer_load_dwordx4 v30, s[40:43], s39 offen lds
    v_mfma_f32_32x32x16_bf16 v[112:127], v[52:55], v[200:203], v[112:127]
    ds_read_b64_tr_b16 v[44:45], v5 offset:0
    ds_read_b64_tr_b16 v[46:47], v5 offset:512
    s_add_u32 m0, s38, 0
    s_mov_b32 s39, 1572864
    buffer_load_dwordx4 v30, s[40:43], s39 offen lds
    s_waitcnt vmcnt(20)
    v_max3_u32 v32, v204, v205, v206
    v_max_u32 v32, v32, v207
    v_cmp_eq_u32 vcc, -1, v32
    s_cbranch_vccnz K1_re_108
K1_bk_110:
    s_waitcnt lgkmcnt(4)
    v_mfma_f32_32x32x16_bf16 v[96:111], v[56:59], v[204:207], v[96:111]
    ds_read_b64_tr_b16 v[48:49], v4 offset:2048
    ds_read_b64_tr_b16 v[50:51], v4 offset:2560
    v_mfma_f32_32x32x16_bf16 v[112:127], v[60:63], v[204:207], v[112:127]
    ds_read_b64_tr_b16 v[52:53], v5 offset:2048
    ds_read_b64_tr_b16 v[54:55], v5 offset:2560
    s_add_u32 m0, s38, 8192
    s_mov_b32 s39, 1638400
    buffer_load_dwordx4 v30, s[40:43], s39 offen lds
    s_waitcnt vmcnt(20)
    v_max3_u32 v32, v208, v209, v210
    v_max_u32 v32, v32, v211
    v_cmp_eq_u32 vcc, -1, v32
    s_cbranch_vccnz K1_re_111
K1_bk_113:
    s_waitcnt lgkmcnt(4)
    v_mfma_f32_32x32x16_bf16 v[96:111], v[40:43], v[208:211], v[96:111]
    ds_read_b64_tr_b16 v[56:57], v4 offset:4096
    ds_read_b64_tr_b16 v[58:59], v4 offset:4608
    v_mfma_f32_32x32x16_bf16 v[112:127], v[44:47], v[208:211], v[112:127]
    ds_read_b64_tr_b16 v[60:61], v5 offset:4096
    ds_read_b64_tr_b16 v[62:63], v5 offset:4608
    s_add_u32 m0, s38, 16384
    s_mov_b32 s39, 1703936
    buffer_load_dwordx4 v30, s[40:43], s39 offen lds
    s_waitcnt vmcnt(20)
    v_max3_u32 v32, v212, v213, v214
    v_max_u32 v32, v32, v215
    v_cmp_eq_u32 vcc, -1, v32
    s_cbranch_vccnz K1_re_114
K1_bk_116:
    s_waitcnt lgkmcnt(4)
    v_mfma_f32_32x32x16_bf16 v[96:111], v[48:51], v[212:215], v[96:111]
    ds_read_b64_tr_b16 v[40:41], v4 offset:6144
    ds_read_b64_tr_b16 v[42:43], v4 offset:6656
    s_add_u32 m0, s38, 24576
    s_mov_b32 s39, 1769472
    buffer_load_dwordx4 v30, s[40:43], s39 offen lds
    v_mfma_f32_32x32x16_bf16 v[112:127], v[52:55], v[212:215], v[112:127]
    ds_read_b64_tr_b16 v[44:45], v5 offset:6144
    ds_read_b64_tr_b16 v[46:47], v5 offset:6656
    s_waitcnt vmcnt(20)
    v_max3_u32 v32, v216, v217, v218
    v_max_u32 v32, v32, v219
    v_cmp_eq_u32 vcc, -1, v32
    s_cbranch_vccnz K1_re_117
K1_bk_119:
    s_waitcnt lgkmcnt(4)
    v_mfma_f32_32x32x16_bf16 v[96:111], v[56:59], v[216:219], v[96:111]
    s_waitcnt vmcnt(8)
    s_waitcnt lgkmcnt(0)
    s_barrier
    v_add_u32 v4, 0x10000, v4
    v_add_u32 v5, 0x10000, v5
    ds_read_b64_tr_b16 v[48:49], v4 offset:0
    ds_read_b64_tr_b16 v[50:51], v4 offset:512
    s_add_u32 s93, s94, 98304
    buffer_load_dwordx4 v[64:67], v2, s[20:23], s93 offen offset:0 sc0 sc1
    v_mfma_f32_32x32x16_bf16 v[112:127], v[60:63], v[216:219], v[112:127]
    ds_read_b64_tr_b16 v[52:53], v5 offset:0
    ds_read_b64_tr_b16 v[54:55], v5 offset:512
    buffer_load_dwordx4 v[68:71], v2, s[20:23], s93 offen offset:1024 sc0 sc1
    v_max3_u32 v32, v220, v221, v222
    v_max_u32 v32, v32, v223
    v_cmp_eq_u32 vcc, -1, v32
    s_cbranch_vccnz K1_re_120
K1_bk_122:
    v_mfma_f32_32x32x16_bf16 v[96:111], v[40:43], v[220:223], v[96:111]
    ds_read_b64_tr_b16 v[56:57], v4 offset:2048
    ds_read_b64_tr_b16 v[58:59], v4 offset:2560
    v_mfma_f32_32x32x16_bf16 v[112:127], v[44:47], v[220:223], v[112:127]
    ds_read_b64_tr_b16 v[60:61], v5 offset:2048
    ds_read_b64_tr_b16 v[62:63], v5 offset:2560
    buffer_load_dwordx4 v[72:75], v2, s[20:23], s93 offen offset:2048 sc0 sc1
    v_max3_u32 v32, v224, v225, v226
    v_max_u32 v32, v32, v227
    v_cmp_eq_u32 vcc, -1, v32
    s_cbranch_vccnz K1_re_123
K1_bk_125:
    s_waitcnt lgkmcnt(4)
    v_mfma_f32_32x32x16_bf16 v[96:111], v[48:51], v[224:227], v[96:111]
    ds_read_b64_tr_b16 v[40:41], v4 offset:4096
    ds_read_b64_tr_b16 v[42:43], v4 offset:4608
    buffer_load_dwordx4 v[76:79], v2, s[20:23], s93 offen offset:3072 sc0 sc1
    v_mfma_f32_32x32x16_bf16 v[112:127], v[52:55], v[224:227], v[112:127]
    ds_read_b64_tr_b16 v[44:45], v5 offset:4096
    ds_read_b64_tr_b16 v[46:47], v5 offset:4608
    v_max3_u32 v32, v228, v229, v230
    v_max_u32 v32, v32, v231
    v_cmp_eq_u32 vcc, -1, v32
    s_cbranch_vccnz K1_re_126
K1_bk_128:
    s_waitcnt lgkmcnt(4)
    v_mfma_f32_32x32x16_bf16 v[96:111], v[56:59], v[228:231], v[96:111]
    ds_read_b64_tr_b16 v[48:49], v4 offset:6144
    ds_read_b64_tr_b16 v[50:51], v4 offset:6656
    s_add_u32 m0, s38, 32768
    s_nop 0
    buffer_load_dwordx4 v30, s[44:47], 0 offen lds
    v_mfma_f32_32x32x16_bf16 v[112:127], v[60:63], v[228:231], v[112:127]
    ds_read_b64_tr_b16 v[52:53], v5 offset:6144
    ds_read_b64_tr_b16 v[54:55], v5 offset:6656
    s_add_u32 m0, s38, 40960
    s_mov_b32 s39, 65536
    buffer_load_dwordx4 v30, s[44:47], s39 offen lds
    v_max3_u32 v32, v232, v233, v234
    v_max_u32 v32, v32, v235
    v_cmp_eq_u32 vcc, -1, v32
    s_cbranch_vccnz K1_re_129
K1_bk_131:
    s_waitcnt lgkmcnt(4)
    v_mfma_f32_32x32x16_bf16 v[96:111], v[40:43], v[232:235], v[96:111]
    s_waitcnt vmcnt(10)
    s_waitcnt lgkmcnt(0)
    s_barrier
    v_add_u32 v4, 0xffff0000, v4
    v_add_u32 v5, 0xffff0000, v5
    ds_read_b64_tr_b16 v[56:57], v4 offset:32768
    ds_read_b64_tr_b16 v[58:59], v4 offset:33280
    v_mfma_f32_32x32x16_bf16 v[112:127], v[44:47], v[232:235], v[112:127]
    ds_read_b64_tr_b16 v[60:61], v5 offset:32768
    ds_read_b64_tr_b16 v[62:63], v5 offset:33280
    s_add_u32 m0, s38, 49152
    s_mov_b32 s39, 131072
    buffer_load_dwordx4 v30, s[44:47], s39 offen lds
    v_max3_u32 v32, v236, v237, v238
    v_max_u32 v32, v32, v239
    v_cmp_eq_u32 vcc, -1, v32
    s_cbranch_vccnz K1_re_132
K1_bk_134:
    v_mfma_f32_32x32x16_bf16 v[96:111], v[48:51], v[236:239], v[96:111]
    ds_read_b64_tr_b16 v[40:41], v4 offset:34816
    ds_read_b64_tr_b16 v[42:43], v4 offset:35328
    s_add_u32 m0, s38, 57344
    s_mov_b32 s39, 196608
    buffer_load_dwordx4 v30, s[44:47], s39 offen lds
    v_mfma_f32_32x32x16_bf16 v[112:127], v[52:55], v[236:239], v[112:127]
    ds_read_b64_tr_b16 v[44:45], v5 offset:34816
    ds_read_b64_tr_b16 v[46:47], v5 offset:35328
    s_add_u32 s93, s94, 114688
    buffer_load_dwordx4 v[128:131], v2, s[20:23], s93 offen offset:0 sc0 sc1
    v_max3_u32 v32, v240, v241, v242
    v_max_u32 v32, v32, v243
    v_cmp_eq_u32 vcc, -1, v32
    s_cbranch_vccnz K1_re_135
K1_bk_137:
    s_waitcnt lgkmcnt(4)
    v_mfma_f32_32x32x16_bf16 v[96:111], v[56:59], v[240:243], v[96:111]
    ds_read_b64_tr_b16 v[48:49], v4 offset:36864
    ds_read_b64_tr_b16 v[50:51], v4 offset:37376
    v_mfma_f32_32x32x16_bf16 v[112:127], v[60:63], v[240:243], v[112:127]
    ds_read_b64_tr_b16 v[52:53], v5 offset:36864
    ds_read_b64_tr_b16 v[54:55], v5 offset:37376
    buffer_load_dwordx4 v[132:135], v2, s[20:23], s93 offen offset:1024 sc0 sc1
    v_max3_u32 v32, v244, v245, v246
    v_max_u32 v32, v32, v247
    v_cmp_eq_u32 vcc, -1, v32
    s_cbranch_vccnz K1_re_138
K1_bk_140:
    s_waitcnt lgkmcnt(4)
    v_mfma_f32_32x32x16_bf16 v[96:111], v[40:43], v[244:247], v[96:111]
    ds_read_b64_tr_b16 v[56:57], v4 offset:38912
    ds_read_b64_tr_b16 v[58:59], v4 offset:39424
    buffer_load_dwordx4 v[136:139], v2, s[20:23], s93 offen offset:2048 sc0 sc1
    v_mfma_f32_32x32x16_bf16 v[112:127], v[44:47], v[244:247], v[112:127]
    ds_read_b64_tr_b16 v[60:61], v5 offset:38912
    ds_read_b64_tr_b16 v[62:63], v5 offset:39424
    buffer_load_dwordx4 v[140:143], v2, s[20:23], s93 offen offset:3072 sc0 sc1
    v_max3_u32 v32, v248, v249, v250
    v_max_u32 v32, v32, v251
    v_cmp_eq_u32 vcc, -1, v32
    s_cbranch_vccnz K1_re_141
K1_bk_143:
    s_waitcnt lgkmcnt(4)
    v_mfma_f32_32x32x16_bf16 v[96:111], v[48:51], v[248:251], v[96:111]
    s_waitcnt vmcnt(12)
    s_waitcnt lgkmcnt(0)
    s_barrier
    v_add_u32 v4, 0xffff0000, v4
    v_add_u32 v5, 0xffff0000, v5
    ds_read_b64_tr_b16 v[40:41], v4 offset:0
    ds_read_b64_tr_b16 v[42:43], v4 offset:512
    v_mfma_f32_32x32x16_bf16 v[112:127], v[52:55], v[248:251], v[112:127]
    ds_read_b64_tr_b16 v[44:45], v5 offset:0
    ds_read_b64_tr_b16 v[46:47], v5 offset:512
    s_add_u32 m0, s38, 65536
    s_mov_b32 s39, 262144
    buffer_load_dwordx4 v30, s[44:47], s39 offen lds
    v_max3_u32 v32, v252, v253, v254
    v_max_u32 v32, v32, v255
    v_cmp_eq_u32 vcc, -1, v32
    s_cbranch_vccnz K1_re_144
K1_bk_146:
    v_mfma_f32_32x32x16_bf16 v[96:111], v[56:59], v[252:255], v[96:111]
    ds_read_b64_tr_b16 v[48:49], v4 offset:2048
    ds_read_b64_tr_b16 v[50:51], v4 offset:2560
    s_add_u32 m0, s38, 73728
    s_mov_b32 s39, 327680
    buffer_load_dwordx4 v30, s[44:47], s39 offen lds
    v_mfma_f32_32x32x16_bf16 v[112:127], v[60:63], v[252:255], v[112:127]
    ds_read_b64_tr_b16 v[52:53], v5 offset:2048
    ds_read_b64_tr_b16 v[54:55], v5 offset:2560
    s_add_u32 m0, s38, 81920
    s_mov_b32 s39, 393216
    buffer_load_dwordx4 v30, s[44:47], s39 offen lds
    s_waitcnt vmcnt(14)
    v_max3_u32 v32, v64, v65, v66
    v_max_u32 v32, v32, v67
    v_cmp_eq_u32 vcc, -1, v32
    s_cbranch_vccnz K1_re_147
K1_bk_149:
    s_waitcnt lgkmcnt(4)
    v_mfma_f32_32x32x16_bf16 v[96:111], v[40:43], v[64:67], v[96:111]
    ds_read_b64_tr_b16 v[56:57], v4 offset:4096
    ds_read_b64_tr_b16 v[58:59], v4 offset:4608
    v_mfma_f32_32x32x16_bf16 v[112:127], v[44:47], v[64:67], v[112:127]
    ds_read_b64_tr_b16 v[60:61], v5 offset:4096
    ds_read_b64_tr_b16 v[62:63], v5 offset:4608
    s_add_u32 m0, s38, 90112
    s_mov_b32 s39, 458752
    buffer_load_dwordx4 v30, s[44:47], s39 offen lds
    s_waitcnt vmcnt(14)
    v_max3_u32 v32, v68, v69, v70
    v_max_u32 v32, v32, v71
    v_cmp_eq_u32 vcc, -1, v32
    s_cbranch_vccnz K1_re_150
K1_bk_152:
    s_waitcnt lgkmcnt(4)
    v_mfma_f32_32x32x16_bf16 v[96:111], v[48:51], v[68:71], v[96:111]
    ds_read_b64_tr_b16 v[40:41], v4 offset:6144
    ds_read_b64_tr_b16 v[42:43], v4 offset:6656
    buffer_load_dwordx4 v[8:11], v12, s[4:7], s98 offen
    v_mfma_f32_32x32x16_bf16 v[112:127], v[52:55], v[68:71], v[112:127]
    ds_read_b64_tr_b16 v[44:45], v5 offset:6144
    ds_read_b64_tr_b16 v[46:47], v5 offset:6656
    s_add_u32 s93, s94, 131072
    buffer_load_dwordx4 v[144:147], v2, s[20:23], s93 offen offset:0 sc0 sc1
    s_waitcnt vmcnt(15)
    v_max3_u32 v32, v72, v73, v74
    v_max_u32 v32, v32, v75
    v_cmp_eq_u32 vcc, -1, v32
    s_cbranch_vccnz K1_re_153
K1_bk_155:
    s_waitcnt lgkmcnt(4)
    v_mfma_f32_32x32x16_bf16 v[96:111], v[56:59], v[72:75], v[96:111]
    s_waitcnt vmcnt(10)
    s_waitcnt lgkmcnt(0)
    s_barrier
    ds_read_b64_tr_b16 v[48:49], v4 offset:32768
    ds_read_b64_tr_b16 v[50:51], v4 offset:33280
    v_mfma_f32_32x32x16_bf16 v[112:127], v[60:63], v[72:75], v[112:127]
    ds_read_b64_tr_b16 v[52:53], v5 offset:32768
    ds_read_b64_tr_b16 v[54:55], v5 offset:33280
    buffer_load_dwordx4 v[148:151], v2, s[20:23], s93 offen offset:1024 sc0 sc1
    v_max3_u32 v32, v76, v77, v78
    v_max_u32 v32, v32, v79
    v_cmp_eq_u32 vcc, -1, v32
    s_cbranch_vccnz K1_re_156
K1_bk_158:
    v_mfma_f32_32x32x16_bf16 v[96:111], v[40:43], v[76:79], v[96:111]
    ds_read_b64_tr_b16 v[56:57], v4 offset:34816
    ds_read_b64_tr_b16 v[58:59], v4 offset:35328
    buffer_load_dwordx4 v[152:155], v2, s[20:23], s93 offen offset:2048 sc0 sc1
    v_mfma_f32_32x32x16_bf16 v[112:127], v[44:47], v[76:79], v[112:127]
    ds_read_b64_tr_b16 v[60:61], v5 offset:34816
    ds_read_b64_tr_b16 v[62:63], v5 offset:35328
    buffer_load_dwordx4 v[156:159], v2, s[20:23], s93 offen offset:3072 sc0 sc1
    s_waitcnt vmcnt(12)
    v_max3_u32 v32, v128, v129, v130
    v_max_u32 v32, v32, v131
    v_cmp_eq_u32 vcc, -1, v32
    s_cbranch_vccnz K1_re_159
K1_bk_161:
    s_waitcnt lgkmcnt(4)
    v_mfma_f32_32x32x16_bf16 v[160:175], v[48:51], v[128:131], 0
    ds_read_b64_tr_b16 v[40:41], v4 offset:36864
    ds_read_b64_tr_b16 v[42:43], v4 offset:37376
    v_mfma_f32_32x32x16_bf16 v[176:191], v[52:55], v[128:131], 0
    ds_read_b64_tr_b16 v[44:45], v5 offset:36864
    ds_read_b64_tr_b16 v[46:47], v5 offset:37376
    ds_write_b128 v37, v[112:115] offset:4096
    s_waitcnt vmcnt(11)
    v_max3_u32 v32, v132, v133, v134
    v_max_u32 v32, v32, v135
    v_cmp_eq_u32 vcc, -1, v32
    s_cbranch_vccnz K1_re_162
K1_bk_164:
    s_waitcnt lgkmcnt(5)
    v_mfma_f32_32x32x16_bf16 v[160:175], v[56:59], v[132:135], v[160:175]
    ds_read_b64_tr_b16 v[48:49], v4 offset:38912
    ds_read_b64_tr_b16 v[50:51], v4 offset:39424
    v_mfma_f32_32x32x16_bf16 v[176:191], v[60:63], v[132:135], v[176:191]
    ds_read_b64_tr_b16 v[52:53], v5 offset:38912
    ds_read_b64_tr_b16 v[54:55], v5 offset:39424
    ds_write_b128 v37, v[116:119] offset:5120
    s_waitcnt vmcnt(10)
    v_max3_u32 v32, v136, v137, v138
    v_max_u32 v32, v32, v139
    v_cmp_eq_u32 vcc, -1, v32
    s_cbranch_vccnz K1_re_165
K1_bk_167:
    s_waitcnt lgkmcnt(6)
    v_mfma_f32_32x32x16_bf16 v[160:175], v[40:43], v[136:139], v[160:175]
    s_waitcnt vmcnt(5)
    s_waitcnt lgkmcnt(0)
    s_barrier
    v_add_u32 v4, 0x10000, v4
    v_add_u32 v5, 0x10000, v5
    ds_read_b64_tr_b16 v[56:57], v4 offset:0
    ds_read_b64_tr_b16 v[58:59], v4 offset:512
    v_mfma_f32_32x32x16_bf16 v[176:191], v[44:47], v[136:139], v[176:191]
    ds_read_b64_tr_b16 v[60:61], v5 offset:0
    ds_read_b64_tr_b16 v[62:63], v5 offset:512
    ds_write_b128 v38, v[120:123] offset:6144
    v_max3_u32 v32, v140, v141, v142
    v_max_u32 v32, v32, v143
    v_cmp_eq_u32 vcc, -1, v32
    s_cbranch_vccnz K1_re_168
K1_bk_170:
    v_mfma_f32_32x32x16_bf16 v[160:175], v[48:51], v[140:143], v[160:175]
    ds_read_b64_tr_b16 v[40:41], v4 offset:2048
    ds_read_b64_tr_b16 v[42:43], v4 offset:2560
    v_mfma_f32_32x32x16_bf16 v[176:191], v[52:55], v[140:143], v[176:191]
    ds_read_b64_tr_b16 v[44:45], v5 offset:2048
    ds_read_b64_tr_b16 v[46:47], v5 offset:2560
    ds_write_b128 v38, v[124:127] offset:7168
    s_waitcnt vmcnt(3)
    v_max3_u32 v32, v144, v145, v146
    v_max_u32 v32, v32, v147
    v_cmp_eq_u32 vcc, -1, v32
    s_cbranch_vccnz K1_re_171
K1_bk_173:
    s_waitcnt lgkmcnt(6)
    v_mfma_f32_32x32x16_bf16 v[160:175], v[56:59], v[144:147], v[160:175]
    ds_read_b64_tr_b16 v[48:49], v4 offset:4096
    ds_read_b64_tr_b16 v[50:51], v4 offset:4608
    v_mfma_f32_32x32x16_bf16 v[176:191], v[60:63], v[144:147], v[176:191]
    ds_read_b64_tr_b16 v[52:53], v5 offset:4096
    ds_read_b64_tr_b16 v[54:55], v5 offset:4608
    ds_write_b128 v36, v[104:107] offset:2048
    s_waitcnt vmcnt(2)
    v_max3_u32 v32, v148, v149, v150
    v_max_u32 v32, v32, v151
    v_cmp_eq_u32 vcc, -1, v32
    s_cbranch_vccnz K1_re_174
K1_bk_176:
    s_waitcnt lgkmcnt(6)
    v_mfma_f32_32x32x16_bf16 v[160:175], v[40:43], v[148:151], v[160:175]
    ds_read_b64_tr_b16 v[56:57], v4 offset:6144
    ds_read_b64_tr_b16 v[58:59], v4 offset:6656
    v_mfma_f32_32x32x16_bf16 v[176:191], v[44:47], v[148:151], v[176:191]
    ds_read_b64_tr_b16 v[60:61], v5 offset:6144
    ds_read_b64_tr_b16 v[62:63], v5 offset:6656
    ds_write_b128 v36, v[108:111] offset:3072
    s_waitcnt vmcnt(1)
    v_max3_u32 v32, v152, v153, v154
    v_max_u32 v32, v32, v155
    v_cmp_eq_u32 vcc, -1, v32
    s_cbranch_vccnz K1_re_177
K1_bk_179:
    s_waitcnt lgkmcnt(6)
    v_mfma_f32_32x32x16_bf16 v[160:175], v[48:51], v[152:155], v[160:175]
    s_waitcnt lgkmcnt(0)
    s_barrier
    ds_read_b128 v[192:195], v39 offset:2048
    ds_read_b128 v[196:199], v39 offset:3072
    ds_read_b128 v[200:203], v39 offset:4096
    ds_read_b128 v[204:207], v39 offset:5120
    ds_read_b128 v[208:211], v39 offset:6144
    ds_read_b128 v[212:215], v39 offset:7168
    v_mfma_f32_32x32x16_bf16 v[176:191], v[52:55], v[152:155], v[176:191]
    v_lshlrev_b32 v240, 16, v8
    v_and_b32 v241, 0xffff0000, v8
    v_lshlrev_b32 v242, 16, v9
    v_and_b32 v243, 0xffff0000, v9
    s_waitcnt vmcnt(0)
    v_max3_u32 v32, v156, v157, v158
    v_max_u32 v32, v32, v159
    v_cmp_eq_u32 vcc, -1, v32
    s_cbranch_vccnz K1_re_180
K1_bk_182:
    v_mfma_f32_32x32x16_bf16 v[160:175], v[56:59], v[156:159], v[160:175]
    v_lshlrev_b32 v244, 16, v10
    v_and_b32 v245, 0xffff0000, v10
    v_lshlrev_b32 v246, 16, v11
    v_and_b32 v247, 0xffff0000, v11
    v_mfma_f32_32x32x16_bf16 v[176:191], v[60:63], v[156:159], v[176:191]
    s_waitcnt lgkmcnt(5)
    v_add_f32 v192, v192, v96
    v_add_f32 v193, v193, v97
    v_add_f32 v194, v194, v98
    v_add_f32 v195, v195, v99
    s_waitcnt lgkmcnt(4)
    v_add_f32 v196, v196, v100
    v_add_f32 v197, v197, v101
    v_add_f32 v198, v198, v102
    v_add_f32 v199, v199, v103
    s_waitcnt lgkmcnt(1)
    v_add_f32 v200, v200, v208
    v_add_f32 v201, v201, v209
    v_add_f32 v202, v202, v210
    v_add_f32 v203, v203, v211
    s_waitcnt lgkmcnt(0)
    v_add_f32 v204, v204, v212
    v_add_f32 v205, v205, v213
    v_add_f32 v206, v206, v214
    v_add_f32 v207, v207, v215
    ds_write_b128 v14, v[176:179] offset:4096
    v_add_f32 v192, v192, v200
    v_add_f32 v193, v193, v201
    v_add_f32 v194, v194, v202
    v_add_f32 v195, v195, v203
    v_add_f32 v196, v196, v204
    v_add_f32 v197, v197, v205
    v_add_f32 v198, v198, v206
    v_add_f32 v199, v199, v207
    v_mul_f32 v200, 0xbfb8aa3b, v192
    v_mul_f32 v201, 0xbfb8aa3b, v193
    v_mul_f32 v202, 0xbfb8aa3b, v194
    v_mul_f32 v203, 0xbfb8aa3b, v195
    ds_write_b128 v14, v[180:183] offset:5120
    v_mul_f32 v204, 0xbfb8aa3b, v196
    v_mul_f32 v205, 0xbfb8aa3b, v197
    v_mul_f32 v206, 0xbfb8aa3b, v198
    v_mul_f32 v207, 0xbfb8aa3b, v199
    v_exp_f32 v200, v200
    v_exp_f32 v201, v201
    v_exp_f32 v202, v202
    v_exp_f32 v203, v203
    ds_write_b128 v15, v[184:187] offset:6144
    v_exp_f32 v204, v204
    v_exp_f32 v205, v205
    v_exp_f32 v206, v206
    v_exp_f32 v207, v207
    v_add_f32 v200, 1.0, v200
    v_add_f32 v201, 1.0, v201
    v_add_f32 v202, 1.0, v202
    v_add_f32 v203, 1.0, v203
    ds_write_b128 v15, v[188:191] offset:7168
    v_add_f32 v204, 1.0, v204
    v_add_f32 v205, 1.0, v205
    v_add_f32 v206, 1.0, v206
    v_add_f32 v207, 1.0, v207
    v_rcp_f32 v200, v200
    v_rcp_f32 v201, v201
    v_rcp_f32 v202, v202
    v_rcp_f32 v203, v203
    ds_write_b128 v13, v[168:171] offset:2048
    v_rcp_f32 v204, v204
    v_rcp_f32 v205, v205
    v_rcp_f32 v206, v206
    v_rcp_f32 v207, v207
    v_mul_f32 v192, v192, v200
    v_mul_f32 v193, v193, v201
    v_mul_f32 v194, v194, v202
    v_mul_f32 v195, v195, v203
    ds_write_b128 v13, v[172:175] offset:3072
    v_mul_f32 v196, v196, v204
    v_mul_f32 v197, v197, v205
    s_waitcnt lgkmcnt(0)
    s_barrier
    ds_read_b128 v[216:219], v16 offset:2048
    ds_read_b128 v[220:223], v16 offset:3072
    ds_read_b128 v[224:227], v16 offset:4096
    ds_read_b128 v[228:231], v16 offset:5120
    ds_read_b128 v[232:235], v16 offset:6144
    ds_read_b128 v[236:239], v16 offset:7168
    v_mul_f32 v198, v198, v206
    v_mul_f32 v199, v199, v207
    s_waitcnt lgkmcnt(5)
    v_add_f32 v160, v160, v216
    v_add_f32 v161, v161, v217
    v_add_f32 v162, v162, v218
    v_add_f32 v163, v163, v219
    s_waitcnt lgkmcnt(4)
    v_add_f32 v164, v164, v220
    v_add_f32 v165, v165, v221
    v_add_f32 v166, v166, v222
    v_add_f32 v167, v167, v223
    s_waitcnt lgkmcnt(3)
    v_add_f32 v160, v160, v224
    v_add_f32 v161, v161, v225
    v_add_f32 v162, v162, v226
    v_add_f32 v163, v163, v227
    s_waitcnt lgkmcnt(2)
    v_add_f32 v164, v164, v228
    v_add_f32 v165, v165, v229
    v_add_f32 v166, v166, v230
    v_add_f32 v167, v167, v231
    s_waitcnt lgkmcnt(1)
    v_add_f32 v160, v160, v232
    v_add_f32 v161, v161, v233
    v_add_f32 v162, v162, v234
    v_add_f32 v163, v163, v235
    s_waitcnt lgkmcnt(0)
    v_add_f32 v164, v164, v236
    v_add_f32 v165, v165, v237
    v_add_f32 v166, v166, v238
    v_add_f32 v167, v167, v239
    v_fmac_f32 v240, v160, v192
    v_fmac_f32 v241, v161, v193
    v_fmac_f32 v242, v162, v194
    v_fmac_f32 v243, v163, v195
    v_fmac_f32 v244, v164, v196
    v_fmac_f32 v245, v165, v197
    v_fmac_f32 v246, v166, v198
    v_fmac_f32 v247, v167, v199
    v_cvt_pk_bf16_f32 v240, v240, v241
    v_cvt_pk_bf16_f32 v241, v242, v243
    v_cvt_pk_bf16_f32 v242, v244, v245
    v_cvt_pk_bf16_f32 v243, v246, v247
    buffer_store_dwordx4 v[240:243], v12, s[48:51], s98 offen
    s_endpgm
K1_re_7:
    s_mov_b32 s72, 0
    s_add_u32 s70, s95, 36864
K1_lp_8:
    buffer_load_dwordx4 v[160:163], v2, s[20:23], s70 offen offset:0 sc0 sc1
    buffer_load_dwordx4 v[164:167], v2, s[20:23], s70 offen offset:1024 sc0 sc1
    buffer_load_dwordx4 v[168:171], v2, s[20:23], s70 offen offset:2048 sc0 sc1
    buffer_load_dwordx4 v[172:175], v2, s[20:23], s70 offen offset:3072 sc0 sc1
    s_waitcnt vmcnt(0)
    v_max3_u32 v32, v160, v161, v162
    v_max_u32 v32, v32, v163
    v_cmp_eq_u32 vcc, -1, v32
    s_add_u32 s72, s72, 1
    s_cmp_ge_u32 s72, 0x10000
    s_cbranch_scc1 K1_bk_9
    s_cbranch_vccnz K1_lp_8
    s_branch K1_bk_9
K1_re_10:
    s_mov_b32 s72, 0
    s_add_u32 s70, s95, 36864
K1_lp_11:
    buffer_load_dwordx4 v[164:167], v2, s[20:23], s70 offen offset:1024 sc0 sc1
    buffer_load_dwordx4 v[168:171], v2, s[20:23], s70 offen offset:2048 sc0 sc1
    buffer_load_dwordx4 v[172:175], v2, s[20:23], s70 offen offset:3072 sc0 sc1
    s_waitcnt vmcnt(0)
    v_max3_u32 v32, v164, v165, v166
    v_max_u32 v32, v32, v167
    v_cmp_eq_u32 vcc, -1, v32
    s_add_u32 s72, s72, 1
    s_cmp_ge_u32 s72, 0x10000
    s_cbranch_scc1 K1_bk_12
    s_cbranch_vccnz K1_lp_11
    s_branch K1_bk_12
K1_re_13:
    s_mov_b32 s72, 0
    s_add_u32 s70, s95, 36864
K1_lp_14:
    buffer_load_dwordx4 v[168:171], v2, s[20:23], s70 offen offset:2048 sc0 sc1
    buffer_load_dwordx4 v[172:175], v2, s[20:23], s70 offen offset:3072 sc0 sc1
    s_waitcnt vmcnt(0)
    v_max3_u32 v32, v168, v169, v170
    v_max_u32 v32, v32, v171
    v_cmp_eq_u32 vcc, -1, v32
    s_add_u32 s72, s72, 1
    s_cmp_ge_u32 s72, 0x10000
    s_cbranch_scc1 K1_bk_15
    s_cbranch_vccnz K1_lp_14
    s_branch K1_bk_15
K1_re_16:
    s_mov_b32 s72, 0
    s_add_u32 s70, s95, 36864
K1_lp_17:
    buffer_load_dwordx4 v[172:175], v2, s[20:23], s70 offen offset:3072 sc0 sc1
    s_waitcnt vmcnt(0)
    v_max3_u32 v32, v172, v173, v174
    v_max_u32 v32, v32, v175
    v_cmp_eq_u32 vcc, -1, v32
    s_add_u32 s72, s72, 1
    s_cmp_ge_u32 s72, 0x10000
    s_cbranch_scc1 K1_bk_18
    s_cbranch_vccnz K1_lp_17
    s_branch K1_bk_18
K1_re_19:
    s_mov_b32 s72, 0
    s_add_u32 s70, s95, 69632
K1_lp_20:
    buffer_load_dwordx4 v[176:179], v2, s[20:23], s70 offen offset:0 sc0 sc1
    buffer_load_dwordx4 v[180:183], v2, s[20:23], s70 offen offset:1024 sc0 sc1
    buffer_load_dwordx4 v[184:187], v2, s[20:23], s70 offen offset:2048 sc0 sc1
    buffer_load_dwordx4 v[188:191], v2, s[20:23], s70 offen offset:3072 sc0 sc1
    s_waitcnt vmcnt(0)
    v_max3_u32 v32, v176, v177, v178
    v_max_u32 v32, v32, v179
    v_cmp_eq_u32 vcc, -1, v32
    s_add_u32 s72, s72, 1
    s_cmp_ge_u32 s72, 0x10000
    s_cbranch_scc1 K1_bk_21
    s_cbranch_vccnz K1_lp_20
    s_branch K1_bk_21
K1_re_22:
    s_mov_b32 s72, 0
    s_add_u32 s70, s95, 69632
K1_lp_23:
    buffer_load_dwordx4 v[180:183], v2, s[20:23], s70 offen offset:1024 sc0 sc1
    buffer_load_dwordx4 v[184:187], v2, s[20:23], s70 offen offset:2048 sc0 sc1
    buffer_load_dwordx4 v[188:191], v2, s[20:23], s70 offen offset:3072 sc0 sc1
    s_waitcnt vmcnt(0)
    v_max3_u32 v32, v180, v181, v182
    v_max_u32 v32, v32, v183
    v_cmp_eq_u32 vcc, -1, v32
    s_add_u32 s72, s72, 1
    s_cmp_ge_u32 s72, 0x10000
    s_cbranch_scc1 K1_bk_24
    s_cbranch_vccnz K1_lp_23
    s_branch K1_bk_24
K1_re_25:
    s_mov_b32 s72, 0
    s_add_u32 s70, s95, 69632
K1_lp_26:
    buffer_load_dwordx4 v[184:187], v2, s[20:23], s70 offen offset:2048 sc0 sc1
    buffer_load_dwordx4 v[188:191], v2, s[20:23], s70 offen offset:3072 sc0 sc1
    s_waitcnt vmcnt(0)
    v_max3_u32 v32, v184, v185, v186
    v_max_u32 v32, v32, v187
    v_cmp_eq_u32 vcc, -1, v32
    s_add_u32 s72, s72, 1
    s_cmp_ge_u32 s72, 0x10000
    s_cbranch_scc1 K1_bk_27
    s_cbranch_vccnz K1_lp_26
    s_branch K1_bk_27
K1_re_28:
    s_mov_b32 s72, 0
    s_add_u32 s70, s95, 69632
K1_lp_29:
    buffer_load_dwordx4 v[188:191], v2, s[20:23], s70 offen offset:3072 sc0 sc1
    s_waitcnt vmcnt(0)
    v_max3_u32 v32, v188, v189, v190
    v_max_u32 v32, v32, v191
    v_cmp_eq_u32 vcc, -1, v32
    s_add_u32 s72, s72, 1
    s_cmp_ge_u32 s72, 0x10000
    s_cbranch_scc1 K1_bk_30
    s_cbranch_vccnz K1_lp_29
    s_branch K1_bk_30
K1_re_31:
    s_mov_b32 s72, 0
    s_add_u32 s70, s94, 0
K1_lp_32:
    buffer_load_dwordx4 v[192:195], v2, s[20:23], s70 offen offset:0 sc0 sc1
    buffer_load_dwordx4 v[196:199], v2, s[20:23], s70 offen offset:1024 sc0 sc1
    buffer_load_dwordx4 v[200:203], v2, s[20:23], s70 offen offset:2048 sc0 sc1
    buffer_load_dwordx4 v[204:207], v2, s[20:23], s70 offen offset:3072 sc0 sc1
    s_waitcnt vmcnt(0)
    v_max3_u32 v32, v192, v193, v194
    v_max_u32 v32, v32, v195
    v_cmp_eq_u32 vcc, -1, v32
    s_add_u32 s72, s72, 1
    s_cmp_ge_u32 s72, 0x10000
    s_cbranch_scc1 K1_bk_33
    s_cbranch_vccnz K1_lp_32
    s_branch K1_bk_33
K1_re_34:
    s_mov_b32 s72, 0
    s_add_u32 s70, s94, 0
K1_lp_35:
    buffer_load_dwordx4 v[196:199], v2, s[20:23], s70 offen offset:1024 sc0 sc1
    buffer_load_dwordx4 v[200:203], v2, s[20:23], s70 offen offset:2048 sc0 sc1
    buffer_load_dwordx4 v[204:207], v2, s[20:23], s70 offen offset:3072 sc0 sc1
    s_waitcnt vmcnt(0)
    v_max3_u32 v32, v196, v197, v198
    v_max_u32 v32, v32, v199
    v_cmp_eq_u32 vcc, -1, v32
    s_add_u32 s72, s72, 1
    s_cmp_ge_u32 s72, 0x10000
    s_cbranch_scc1 K1_bk_36
    s_cbranch_vccnz K1_lp_35
    s_branch K1_bk_36
K1_re_37:
    s_mov_b32 s72, 0
    s_add_u32 s70, s94, 0
K1_lp_38:
    buffer_load_dwordx4 v[200:203], v2, s[20:23], s70 offen offset:2048 sc0 sc1
    buffer_load_dwordx4 v[204:207], v2, s[20:23], s70 offen offset:3072 sc0 sc1
    s_waitcnt vmcnt(0)
    v_max3_u32 v32, v200, v201, v202
    v_max_u32 v32, v32, v203
    v_cmp_eq_u32 vcc, -1, v32
    s_add_u32 s72, s72, 1
    s_cmp_ge_u32 s72, 0x10000
    s_cbranch_scc1 K1_bk_39
    s_cbranch_vccnz K1_lp_38
    s_branch K1_bk_39
K1_re_40:
    s_mov_b32 s72, 0
    s_add_u32 s70, s94, 0
K1_lp_41:
    buffer_load_dwordx4 v[204:207], v2, s[20:23], s70 offen offset:3072 sc0 sc1
    s_waitcnt vmcnt(0)
    v_max3_u32 v32, v204, v205, v206
    v_max_u32 v32, v32, v207
    v_cmp_eq_u32 vcc, -1, v32
    s_add_u32 s72, s72, 1
    s_cmp_ge_u32 s72, 0x10000
    s_cbranch_scc1 K1_bk_42
    s_cbranch_vccnz K1_lp_41
    s_branch K1_bk_42
K1_re_43:
    s_mov_b32 s72, 0
    s_add_u32 s70, s94, 16384
K1_lp_44:
    buffer_load_dwordx4 v[208:211], v2, s[20:23], s70 offen offset:0 sc0 sc1
    buffer_load_dwordx4 v[212:215], v2, s[20:23], s70 offen offset:1024 sc0 sc1
    buffer_load_dwordx4 v[216:219], v2, s[20:23], s70 offen offset:2048 sc0 sc1
    buffer_load_dwordx4 v[220:223], v2, s[20:23], s70 offen offset:3072 sc0 sc1
    s_waitcnt vmcnt(0)
    v_max3_u32 v32, v208, v209, v210
    v_max_u32 v32, v32, v211
    v_cmp_eq_u32 vcc, -1, v32
    s_add_u32 s72, s72, 1
    s_cmp_ge_u32 s72, 0x10000
    s_cbranch_scc1 K1_bk_45
    s_cbranch_vccnz K1_lp_44
    s_branch K1_bk_45
K1_re_46:
    s_mov_b32 s72, 0
    s_add_u32 s70, s94, 16384
K1_lp_47:
    buffer_load_dwordx4 v[212:215], v2, s[20:23], s70 offen offset:1024 sc0 sc1
    buffer_load_dwordx4 v[216:219], v2, s[20:23], s70 offen offset:2048 sc0 sc1
    buffer_load_dwordx4 v[220:223], v2, s[20:23], s70 offen offset:3072 sc0 sc1
    s_waitcnt vmcnt(0)
    v_max3_u32 v32, v212, v213, v214
    v_max_u32 v32, v32, v215
    v_cmp_eq_u32 vcc, -1, v32
    s_add_u32 s72, s72, 1
    s_cmp_ge_u32 s72, 0x10000
    s_cbranch_scc1 K1_bk_48
    s_cbranch_vccnz K1_lp_47
    s_branch K1_bk_48
K1_re_49:
    s_mov_b32 s72, 0
    s_add_u32 s70, s94, 16384
K1_lp_50:
    buffer_load_dwordx4 v[216:219], v2, s[20:23], s70 offen offset:2048 sc0 sc1
    buffer_load_dwordx4 v[220:223], v2, s[20:23], s70 offen offset:3072 sc0 sc1
    s_waitcnt vmcnt(0)
    v_max3_u32 v32, v216, v217, v218
    v_max_u32 v32, v32, v219
    v_cmp_eq_u32 vcc, -1, v32
    s_add_u32 s72, s72, 1
    s_cmp_ge_u32 s72, 0x10000
    s_cbranch_scc1 K1_bk_51
    s_cbranch_vccnz K1_lp_50
    s_branch K1_bk_51
K1_re_52:
    s_mov_b32 s72, 0
    s_add_u32 s70, s94, 16384
K1_lp_53:
    buffer_load_dwordx4 v[220:223], v2, s[20:23], s70 offen offset:3072 sc0 sc1
    s_waitcnt vmcnt(0)
    v_max3_u32 v32, v220, v221, v222
    v_max_u32 v32, v32, v223
    v_cmp_eq_u32 vcc, -1, v32
    s_add_u32 s72, s72, 1
    s_cmp_ge_u32 s72, 0x10000
    s_cbranch_scc1 K1_bk_54
    s_cbranch_vccnz K1_lp_53
    s_branch K1_bk_54
K1_re_55:
    s_mov_b32 s72, 0
    s_add_u32 s70, s94, 98304
K1_lp_56:
    buffer_load_dwordx4 v[64:67], v2, s[20:23], s70 offen offset:0 sc0 sc1
    buffer_load_dwordx4 v[68:71], v2, s[20:23], s70 offen offset:1024 sc0 sc1
    buffer_load_dwordx4 v[72:75], v2, s[20:23], s70 offen offset:2048 sc0 sc1
    buffer_load_dwordx4 v[76:79], v2, s[20:23], s70 offen offset:3072 sc0 sc1
    s_waitcnt vmcnt(0)
    v_max3_u32 v32, v64, v65, v66
    v_max_u32 v32, v32, v67
    v_cmp_eq_u32 vcc, -1, v32
    s_add_u32 s72, s72, 1
    s_cmp_ge_u32 s72, 0x10000
    s_cbranch_scc1 K1_bk_57
    s_cbranch_vccnz K1_lp_56
    s_branch K1_bk_57
K1_re_58:
    s_mov_b32 s72, 0
    s_add_u32 s70, s94, 98304
K1_lp_59:
    buffer_load_dwordx4 v[68:71], v2, s[20:23], s70 offen offset:1024 sc0 sc1
    buffer_load_dwordx4 v[72:75], v2, s[20:23], s70 offen offset:2048 sc0 sc1
    buffer_load_dwordx4 v[76:79], v2, s[20:23], s70 offen offset:3072 sc0 sc1
    s_waitcnt vmcnt(0)
    v_max3_u32 v32, v68, v69, v70
    v_max_u32 v32, v32, v71
    v_cmp_eq_u32 vcc, -1, v32
    s_add_u32 s72, s72, 1
    s_cmp_ge_u32 s72, 0x10000
    s_cbranch_scc1 K1_bk_60
    s_cbranch_vccnz K1_lp_59
    s_branch K1_bk_60
K1_re_61:
    s_mov_b32 s72, 0
    s_add_u32 s70, s94, 98304
K1_lp_62:
    buffer_load_dwordx4 v[72:75], v2, s[20:23], s70 offen offset:2048 sc0 sc1
    buffer_load_dwordx4 v[76:79], v2, s[20:23], s70 offen offset:3072 sc0 sc1
    s_waitcnt vmcnt(0)
    v_max3_u32 v32, v72, v73, v74
    v_max_u32 v32, v32, v75
    v_cmp_eq_u32 vcc, -1, v32
    s_add_u32 s72, s72, 1
    s_cmp_ge_u32 s72, 0x10000
    s_cbranch_scc1 K1_bk_63
    s_cbranch_vccnz K1_lp_62
    s_branch K1_bk_63
K1_re_64:
    s_mov_b32 s72, 0
    s_add_u32 s70, s94, 98304
K1_lp_65:
    buffer_load_dwordx4 v[76:79], v2, s[20:23], s70 offen offset:3072 sc0 sc1
    s_waitcnt vmcnt(0)
    v_max3_u32 v32, v76, v77, v78
    v_max_u32 v32, v32, v79
    v_cmp_eq_u32 vcc, -1, v32
    s_add_u32 s72, s72, 1
    s_cmp_ge_u32 s72, 0x10000
    s_cbranch_scc1 K1_bk_66
    s_cbranch_vccnz K1_lp_65
    s_branch K1_bk_66
K1_re_67:
    s_mov_b32 s72, 0
    s_add_u32 s70, s94, 114688
K1_lp_68:
    buffer_load_dwordx4 v[224:227], v2, s[20:23], s70 offen offset:0 sc0 sc1
    buffer_load_dwordx4 v[228:231], v2, s[20:23], s70 offen offset:1024 sc0 sc1
    buffer_load_dwordx4 v[232:235], v2, s[20:23], s70 offen offset:2048 sc0 sc1
    buffer_load_dwordx4 v[236:239], v2, s[20:23], s70 offen offset:3072 sc0 sc1
    s_waitcnt vmcnt(0)
    v_max3_u32 v32, v224, v225, v226
    v_max_u32 v32, v32, v227
    v_cmp_eq_u32 vcc, -1, v32
    s_add_u32 s72, s72, 1
    s_cmp_ge_u32 s72, 0x10000
    s_cbranch_scc1 K1_bk_69
    s_cbranch_vccnz K1_lp_68
    s_branch K1_bk_69
K1_re_70:
    s_mov_b32 s72, 0
    s_add_u32 s70, s94, 114688
K1_lp_71:
    buffer_load_dwordx4 v[228:231], v2, s[20:23], s70 offen offset:1024 sc0 sc1
    buffer_load_dwordx4 v[232:235], v2, s[20:23], s70 offen offset:2048 sc0 sc1
    buffer_load_dwordx4 v[236:239], v2, s[20:23], s70 offen offset:3072 sc0 sc1
    s_waitcnt vmcnt(0)
    v_max3_u32 v32, v228, v229, v230
    v_max_u32 v32, v32, v231
    v_cmp_eq_u32 vcc, -1, v32
    s_add_u32 s72, s72, 1
    s_cmp_ge_u32 s72, 0x10000
    s_cbranch_scc1 K1_bk_72
    s_cbranch_vccnz K1_lp_71
    s_branch K1_bk_72
K1_re_73:
    s_mov_b32 s72, 0
    s_add_u32 s70, s94, 114688
K1_lp_74:
    buffer_load_dwordx4 v[232:235], v2, s[20:23], s70 offen offset:2048 sc0 sc1
    buffer_load_dwordx4 v[236:239], v2, s[20:23], s70 offen offset:3072 sc0 sc1
    s_waitcnt vmcnt(0)
    v_max3_u32 v32, v232, v233, v234
    v_max_u32 v32, v32, v235
    v_cmp_eq_u32 vcc, -1, v32
    s_add_u32 s72, s72, 1
    s_cmp_ge_u32 s72, 0x10000
    s_cbranch_scc1 K1_bk_75
    s_cbranch_vccnz K1_lp_74
    s_branch K1_bk_75
K1_re_76:
    s_mov_b32 s72, 0
    s_add_u32 s70, s94, 114688
K1_lp_77:
    buffer_load_dwordx4 v[236:239], v2, s[20:23], s70 offen offset:3072 sc0 sc1
    s_waitcnt vmcnt(0)
    v_max3_u32 v32, v236, v237, v238
    v_max_u32 v32, v32, v239
    v_cmp_eq_u32 vcc, -1, v32
    s_add_u32 s72, s72, 1
    s_cmp_ge_u32 s72, 0x10000
    s_cbranch_scc1 K1_bk_78
    s_cbranch_vccnz K1_lp_77
    s_branch K1_bk_78
K1_re_79:
    s_mov_b32 s72, 0
    s_add_u32 s70, s94, 131072
K1_lp_80:
    buffer_load_dwordx4 v[240:243], v2, s[20:23], s70 offen offset:0 sc0 sc1
    buffer_load_dwordx4 v[244:247], v2, s[20:23], s70 offen offset:1024 sc0 sc1
    buffer_load_dwordx4 v[248:251], v2, s[20:23], s70 offen offset:2048 sc0 sc1
    buffer_load_dwordx4 v[252:255], v2, s[20:23], s70 offen offset:3072 sc0 sc1
    s_waitcnt vmcnt(0)
    v_max3_u32 v32, v240, v241, v242
    v_max_u32 v32, v32, v243
    v_cmp_eq_u32 vcc, -1, v32
    s_add_u32 s72, s72, 1
    s_cmp_ge_u32 s72, 0x10000
    s_cbranch_scc1 K1_bk_81
    s_cbranch_vccnz K1_lp_80
    s_branch K1_bk_81
K1_re_82:
    s_mov_b32 s72, 0
    s_add_u32 s70, s94, 131072
K1_lp_83:
    buffer_load_dwordx4 v[244:247], v2, s[20:23], s70 offen offset:1024 sc0 sc1
    buffer_load_dwordx4 v[248:251], v2, s[20:23], s70 offen offset:2048 sc0 sc1
    buffer_load_dwordx4 v[252:255], v2, s[20:23], s70 offen offset:3072 sc0 sc1
    s_waitcnt vmcnt(0)
    v_max3_u32 v32, v244, v245, v246
    v_max_u32 v32, v32, v247
    v_cmp_eq_u32 vcc, -1, v32
    s_add_u32 s72, s72, 1
    s_cmp_ge_u32 s72, 0x10000
    s_cbranch_scc1 K1_bk_84
    s_cbranch_vccnz K1_lp_83
    s_branch K1_bk_84
K1_re_85:
    s_mov_b32 s72, 0
    s_add_u32 s70, s94, 131072
K1_lp_86:
    buffer_load_dwordx4 v[248:251], v2, s[20:23], s70 offen offset:2048 sc0 sc1
    buffer_load_dwordx4 v[252:255], v2, s[20:23], s70 offen offset:3072 sc0 sc1
    s_waitcnt vmcnt(0)
    v_max3_u32 v32, v248, v249, v250
    v_max_u32 v32, v32, v251
    v_cmp_eq_u32 vcc, -1, v32
    s_add_u32 s72, s72, 1
    s_cmp_ge_u32 s72, 0x10000
    s_cbranch_scc1 K1_bk_87
    s_cbranch_vccnz K1_lp_86
    s_branch K1_bk_87
K1_re_88:
    s_mov_b32 s72, 0
    s_add_u32 s70, s94, 131072
K1_lp_89:
    buffer_load_dwordx4 v[252:255], v2, s[20:23], s70 offen offset:3072 sc0 sc1
    s_waitcnt vmcnt(0)
    v_max3_u32 v32, v252, v253, v254
    v_max_u32 v32, v32, v255
    v_cmp_eq_u32 vcc, -1, v32
    s_add_u32 s72, s72, 1
    s_cmp_ge_u32 s72, 0x10000
    s_cbranch_scc1 K1_bk_90
    s_cbranch_vccnz K1_lp_89
    s_branch K1_bk_90
K1_re_99:
    s_mov_b32 s72, 0
    s_add_u32 s70, s95, 36864
K1_lp_100:
    buffer_load_dwordx4 v[192:195], v2, s[20:23], s70 offen offset:0 sc0 sc1
    buffer_load_dwordx4 v[196:199], v2, s[20:23], s70 offen offset:1024 sc0 sc1
    buffer_load_dwordx4 v[200:203], v2, s[20:23], s70 offen offset:2048 sc0 sc1
    buffer_load_dwordx4 v[204:207], v2, s[20:23], s70 offen offset:3072 sc0 sc1
    s_waitcnt vmcnt(0)
    v_max3_u32 v32, v192, v193, v194
    v_max_u32 v32, v32, v195
    v_cmp_eq_u32 vcc, -1, v32
    s_add_u32 s72, s72, 1
    s_cmp_ge_u32 s72, 0x10000
    s_cbranch_scc1 K1_bk_101
    s_cbranch_vccnz K1_lp_100
    s_branch K1_bk_101
K1_re_102:
    s_mov_b32 s72, 0
    s_add_u32 s70, s95, 36864
K1_lp_103:
    buffer_load_dwordx4 v[196:199], v2, s[20:23], s70 offen offset:1024 sc0 sc1
    buffer_load_dwordx4 v[200:203], v2, s[20:23], s70 offen offset:2048 sc0 sc1
    buffer_load_dwordx4 v[204:207], v2, s[20:23], s70 offen offset:3072 sc0 sc1
    s_waitcnt vmcnt(0)
    v_max3_u32 v32, v196, v197, v198
    v_max_u32 v32, v32, v199
    v_cmp_eq_u32 vcc, -1, v32
    s_add_u32 s72, s72, 1
    s_cmp_ge_u32 s72, 0x10000
    s_cbranch_scc1 K1_bk_104
    s_cbranch_vccnz K1_lp_103
    s_branch K1_bk_104
K1_re_105:
    s_mov_b32 s72, 0
    s_add_u32 s70, s95, 36864
K1_lp_106:
    buffer_load_dwordx4 v[200:203], v2, s[20:23], s70 offen offset:2048 sc0 sc1
    buffer_load_dwordx4 v[204:207], v2, s[20:23], s70 offen offset:3072 sc0 sc1
    s_waitcnt vmcnt(0)
    v_max3_u32 v32, v200, v201, v202
    v_max_u32 v32, v32, v203
    v_cmp_eq_u32 vcc, -1, v32
    s_add_u32 s72, s72, 1
    s_cmp_ge_u32 s72, 0x10000
    s_cbranch_scc1 K1_bk_107
    s_cbranch_vccnz K1_lp_106
    s_branch K1_bk_107
K1_re_108:
    s_mov_b32 s72, 0
    s_add_u32 s70, s95, 36864
K1_lp_109:
    buffer_load_dwordx4 v[204:207], v2, s[20:23], s70 offen offset:3072 sc0 sc1
    s_waitcnt vmcnt(0)
    v_max3_u32 v32, v204, v205, v206
    v_max_u32 v32, v32, v207
    v_cmp_eq_u32 vcc, -1, v32
    s_add_u32 s72, s72, 1
    s_cmp_ge_u32 s72, 0x10000
    s_cbranch_scc1 K1_bk_110
    s_cbranch_vccnz K1_lp_109
    s_branch K1_bk_110
K1_re_111:
    s_mov_b32 s72, 0
    s_add_u32 s70, s95, 69632
K1_lp_112:
    buffer_load_dwordx4 v[208:211], v2, s[20:23], s70 offen offset:0 sc0 sc1
    buffer_load_dwordx4 v[212:215], v2, s[20:23], s70 offen offset:1024 sc0 sc1
    buffer_load_dwordx4 v[216:219], v2, s[20:23], s70 offen offset:2048 sc0 sc1
    buffer_load_dwordx4 v[220:223], v2, s[20:23], s70 offen offset:3072 sc0 sc1
    s_waitcnt vmcnt(0)
    v_max3_u32 v32, v208, v209, v210
    v_max_u32 v32, v32, v211
    v_cmp_eq_u32 vcc, -1, v32
    s_add_u32 s72, s72, 1
    s_cmp_ge_u32 s72, 0x10000
    s_cbranch_scc1 K1_bk_113
    s_cbranch_vccnz K1_lp_112
    s_branch K1_bk_113
K1_re_114:
    s_mov_b32 s72, 0
    s_add_u32 s70, s95, 69632
K1_lp_115:
    buffer_load_dwordx4 v[212:215], v2, s[20:23], s70 offen offset:1024 sc0 sc1
    buffer_load_dwordx4 v[216:219], v2, s[20:23], s70 offen offset:2048 sc0 sc1
    buffer_load_dwordx4 v[220:223], v2, s[20:23], s70 offen offset:3072 sc0 sc1
    s_waitcnt vmcnt(0)
    v_max3_u32 v32, v212, v213, v214
    v_max_u32 v32, v32, v215
    v_cmp_eq_u32 vcc, -1, v32
    s_add_u32 s72, s72, 1
    s_cmp_ge_u32 s72, 0x10000
    s_cbranch_scc1 K1_bk_116
    s_cbranch_vccnz K1_lp_115
    s_branch K1_bk_116
K1_re_117:
    s_mov_b32 s72, 0
    s_add_u32 s70, s95, 69632
K1_lp_118:
    buffer_load_dwordx4 v[216:219], v2, s[20:23], s70 offen offset:2048 sc0 sc1
    buffer_load_dwordx4 v[220:223], v2, s[20:23], s70 offen offset:3072 sc0 sc1
    s_waitcnt vmcnt(0)
    v_max3_u32 v32, v216, v217, v218
    v_max_u32 v32, v32, v219
    v_cmp_eq_u32 vcc, -1, v32
    s_add_u32 s72, s72, 1
    s_cmp_ge_u32 s72, 0x10000
    s_cbranch_scc1 K1_bk_119
    s_cbranch_vccnz K1_lp_118
    s_branch K1_bk_119
K1_re_120:
    s_mov_b32 s72, 0
    s_add_u32 s70, s95, 69632
K1_lp_121:
    buffer_load_dwordx4 v[220:223], v2, s[20:23], s70 offen offset:3072 sc0 sc1
    s_waitcnt vmcnt(0)
    v_max3_u32 v32, v220, v221, v222
    v_max_u32 v32, v32, v223
    v_cmp_eq_u32 vcc, -1, v32
    s_add_u32 s72, s72, 1
    s_cmp_ge_u32 s72, 0x10000
    s_cbranch_scc1 K1_bk_122
    s_cbranch_vccnz K1_lp_121
    s_branch K1_bk_122
K1_re_123:
    s_mov_b32 s72, 0
    s_add_u32 s70, s94, 0
K1_lp_124:
    buffer_load_dwordx4 v[224:227], v2, s[20:23], s70 offen offset:0 sc0 sc1
    buffer_load_dwordx4 v[228:231], v2, s[20:23], s70 offen offset:1024 sc0 sc1
    buffer_load_dwordx4 v[232:235], v2, s[20:23], s70 offen offset:2048 sc0 sc1
    buffer_load_dwordx4 v[236:239], v2, s[20:23], s70 offen offset:3072 sc0 sc1
    s_waitcnt vmcnt(0)
    v_max3_u32 v32, v224, v225, v226
    v_max_u32 v32, v32, v227
    v_cmp_eq_u32 vcc, -1, v32
    s_add_u32 s72, s72, 1
    s_cmp_ge_u32 s72, 0x10000
    s_cbranch_scc1 K1_bk_125
    s_cbranch_vccnz K1_lp_124
    s_branch K1_bk_125
K1_re_126:
    s_mov_b32 s72, 0
    s_add_u32 s70, s94, 0
K1_lp_127:
    buffer_load_dwordx4 v[228:231], v2, s[20:23], s70 offen offset:1024 sc0 sc1
    buffer_load_dwordx4 v[232:235], v2, s[20:23], s70 offen offset:2048 sc0 sc1
    buffer_load_dwordx4 v[236:239], v2, s[20:23], s70 offen offset:3072 sc0 sc1
    s_waitcnt vmcnt(0)
    v_max3_u32 v32, v228, v229, v230
    v_max_u32 v32, v32, v231
    v_cmp_eq_u32 vcc, -1, v32
    s_add_u32 s72, s72, 1
    s_cmp_ge_u32 s72, 0x10000
    s_cbranch_scc1 K1_bk_128
    s_cbranch_vccnz K1_lp_127
    s_branch K1_bk_128
K1_re_129:
    s_mov_b32 s72, 0
    s_add_u32 s70, s94, 0
K1_lp_130:
    buffer_load_dwordx4 v[232:235], v2, s[20:23], s70 offen offset:2048 sc0 sc1
    buffer_load_dwordx4 v[236:239], v2, s[20:23], s70 offen offset:3072 sc0 sc1
    s_waitcnt vmcnt(0)
    v_max3_u32 v32, v232, v233, v234
    v_max_u32 v32, v32, v235
    v_cmp_eq_u32 vcc, -1, v32
    s_add_u32 s72, s72, 1
    s_cmp_ge_u32 s72, 0x10000
    s_cbranch_scc1 K1_bk_131
    s_cbranch_vccnz K1_lp_130
    s_branch K1_bk_131
K1_re_132:
    s_mov_b32 s72, 0
    s_add_u32 s70, s94, 0
K1_lp_133:
    buffer_load_dwordx4 v[236:239], v2, s[20:23], s70 offen offset:3072 sc0 sc1
    s_waitcnt vmcnt(0)
    v_max3_u32 v32, v236, v237, v238
    v_max_u32 v32, v32, v239
    v_cmp_eq_u32 vcc, -1, v32
    s_add_u32 s72, s72, 1
    s_cmp_ge_u32 s72, 0x10000
    s_cbranch_scc1 K1_bk_134
    s_cbranch_vccnz K1_lp_133
    s_branch K1_bk_134
K1_re_135:
    s_mov_b32 s72, 0
    s_add_u32 s70, s94, 16384
K1_lp_136:
    buffer_load_dwordx4 v[240:243], v2, s[20:23], s70 offen offset:0 sc0 sc1
    buffer_load_dwordx4 v[244:247], v2, s[20:23], s70 offen offset:1024 sc0 sc1
    buffer_load_dwordx4 v[248:251], v2, s[20:23], s70 offen offset:2048 sc0 sc1
    buffer_load_dwordx4 v[252:255], v2, s[20:23], s70 offen offset:3072 sc0 sc1
    s_waitcnt vmcnt(0)
    v_max3_u32 v32, v240, v241, v242
    v_max_u32 v32, v32, v243
    v_cmp_eq_u32 vcc, -1, v32
    s_add_u32 s72, s72, 1
    s_cmp_ge_u32 s72, 0x10000
    s_cbranch_scc1 K1_bk_137
    s_cbranch_vccnz K1_lp_136
    s_branch K1_bk_137
K1_re_138:
    s_mov_b32 s72, 0
    s_add_u32 s70, s94, 16384
K1_lp_139:
    buffer_load_dwordx4 v[244:247], v2, s[20:23], s70 offen offset:1024 sc0 sc1
    buffer_load_dwordx4 v[248:251], v2, s[20:23], s70 offen offset:2048 sc0 sc1
    buffer_load_dwordx4 v[252:255], v2, s[20:23], s70 offen offset:3072 sc0 sc1
    s_waitcnt vmcnt(0)
    v_max3_u32 v32, v244, v245, v246
    v_max_u32 v32, v32, v247
    v_cmp_eq_u32 vcc, -1, v32
    s_add_u32 s72, s72, 1
    s_cmp_ge_u32 s72, 0x10000
    s_cbranch_scc1 K1_bk_140
    s_cbranch_vccnz K1_lp_139
    s_branch K1_bk_140
K1_re_141:
    s_mov_b32 s72, 0
    s_add_u32 s70, s94, 16384
K1_lp_142:
    buffer_load_dwordx4 v[248:251], v2, s[20:23], s70 offen offset:2048 sc0 sc1
    buffer_load_dwordx4 v[252:255], v2, s[20:23], s70 offen offset:3072 sc0 sc1
    s_waitcnt vmcnt(0)
    v_max3_u32 v32, v248, v249, v250
    v_max_u32 v32, v32, v251
    v_cmp_eq_u32 vcc, -1, v32
    s_add_u32 s72, s72, 1
    s_cmp_ge_u32 s72, 0x10000
    s_cbranch_scc1 K1_bk_143
    s_cbranch_vccnz K1_lp_142
    s_branch K1_bk_143
K1_re_144:
    s_mov_b32 s72, 0
    s_add_u32 s70, s94, 16384
K1_lp_145:
    buffer_load_dwordx4 v[252:255], v2, s[20:23], s70 offen offset:3072 sc0 sc1
    s_waitcnt vmcnt(0)
    v_max3_u32 v32, v252, v253, v254
    v_max_u32 v32, v32, v255
    v_cmp_eq_u32 vcc, -1, v32
    s_add_u32 s72, s72, 1
    s_cmp_ge_u32 s72, 0x10000
    s_cbranch_scc1 K1_bk_146
    s_cbranch_vccnz K1_lp_145
    s_branch K1_bk_146
K1_re_147:
    s_mov_b32 s72, 0
    s_add_u32 s70, s94, 98304
K1_lp_148:
    buffer_load_dwordx4 v[64:67], v2, s[20:23], s70 offen offset:0 sc0 sc1
    buffer_load_dwordx4 v[68:71], v2, s[20:23], s70 offen offset:1024 sc0 sc1
    buffer_load_dwordx4 v[72:75], v2, s[20:23], s70 offen offset:2048 sc0 sc1
    buffer_load_dwordx4 v[76:79], v2, s[20:23], s70 offen offset:3072 sc0 sc1
    s_waitcnt vmcnt(0)
    v_max3_u32 v32, v64, v65, v66
    v_max_u32 v32, v32, v67
    v_cmp_eq_u32 vcc, -1, v32
    s_add_u32 s72, s72, 1
    s_cmp_ge_u32 s72, 0x10000
    s_cbranch_scc1 K1_bk_149
    s_cbranch_vccnz K1_lp_148
    s_branch K1_bk_149
K1_re_150:
    s_mov_b32 s72, 0
    s_add_u32 s70, s94, 98304
K1_lp_151:
    buffer_load_dwordx4 v[68:71], v2, s[20:23], s70 offen offset:1024 sc0 sc1
    buffer_load_dwordx4 v[72:75], v2, s[20:23], s70 offen offset:2048 sc0 sc1
    buffer_load_dwordx4 v[76:79], v2, s[20:23], s70 offen offset:3072 sc0 sc1
    s_waitcnt vmcnt(0)
    v_max3_u32 v32, v68, v69, v70
    v_max_u32 v32, v32, v71
    v_cmp_eq_u32 vcc, -1, v32
    s_add_u32 s72, s72, 1
    s_cmp_ge_u32 s72, 0x10000
    s_cbranch_scc1 K1_bk_152
    s_cbranch_vccnz K1_lp_151
    s_branch K1_bk_152
K1_re_153:
    s_mov_b32 s72, 0
    s_add_u32 s70, s94, 98304
K1_lp_154:
    buffer_load_dwordx4 v[72:75], v2, s[20:23], s70 offen offset:2048 sc0 sc1
    buffer_load_dwordx4 v[76:79], v2, s[20:23], s70 offen offset:3072 sc0 sc1
    s_waitcnt vmcnt(0)
    v_max3_u32 v32, v72, v73, v74
    v_max_u32 v32, v32, v75
    v_cmp_eq_u32 vcc, -1, v32
    s_add_u32 s72, s72, 1
    s_cmp_ge_u32 s72, 0x10000
    s_cbranch_scc1 K1_bk_155
    s_cbranch_vccnz K1_lp_154
    s_branch K1_bk_155
K1_re_156:
    s_mov_b32 s72, 0
    s_add_u32 s70, s94, 98304
K1_lp_157:
    buffer_load_dwordx4 v[76:79], v2, s[20:23], s70 offen offset:3072 sc0 sc1
    s_waitcnt vmcnt(0)
    v_max3_u32 v32, v76, v77, v78
    v_max_u32 v32, v32, v79
    v_cmp_eq_u32 vcc, -1, v32
    s_add_u32 s72, s72, 1
    s_cmp_ge_u32 s72, 0x10000
    s_cbranch_scc1 K1_bk_158
    s_cbranch_vccnz K1_lp_157
    s_branch K1_bk_158
K1_re_159:
    s_mov_b32 s72, 0
    s_add_u32 s70, s94, 114688
K1_lp_160:
    buffer_load_dwordx4 v[128:131], v2, s[20:23], s70 offen offset:0 sc0 sc1
    buffer_load_dwordx4 v[132:135], v2, s[20:23], s70 offen offset:1024 sc0 sc1
    buffer_load_dwordx4 v[136:139], v2, s[20:23], s70 offen offset:2048 sc0 sc1
    buffer_load_dwordx4 v[140:143], v2, s[20:23], s70 offen offset:3072 sc0 sc1
    s_waitcnt vmcnt(0)
    v_max3_u32 v32, v128, v129, v130
    v_max_u32 v32, v32, v131
    v_cmp_eq_u32 vcc, -1, v32
    s_add_u32 s72, s72, 1
    s_cmp_ge_u32 s72, 0x10000
    s_cbranch_scc1 K1_bk_161
    s_cbranch_vccnz K1_lp_160
    s_branch K1_bk_161
K1_re_162:
    s_mov_b32 s72, 0
    s_add_u32 s70, s94, 114688
K1_lp_163:
    buffer_load_dwordx4 v[132:135], v2, s[20:23], s70 offen offset:1024 sc0 sc1
    buffer_load_dwordx4 v[136:139], v2, s[20:23], s70 offen offset:2048 sc0 sc1
    buffer_load_dwordx4 v[140:143], v2, s[20:23], s70 offen offset:3072 sc0 sc1
    s_waitcnt vmcnt(0)
    v_max3_u32 v32, v132, v133, v134
    v_max_u32 v32, v32, v135
    v_cmp_eq_u32 vcc, -1, v32
    s_add_u32 s72, s72, 1
    s_cmp_ge_u32 s72, 0x10000
    s_cbranch_scc1 K1_bk_164
    s_cbranch_vccnz K1_lp_163
    s_branch K1_bk_164
K1_re_165:
    s_mov_b32 s72, 0
    s_add_u32 s70, s94, 114688
K1_lp_166:
    buffer_load_dwordx4 v[136:139], v2, s[20:23], s70 offen offset:2048 sc0 sc1
    buffer_load_dwordx4 v[140:143], v2, s[20:23], s70 offen offset:3072 sc0 sc1
    s_waitcnt vmcnt(0)
    v_max3_u32 v32, v136, v137, v138
    v_max_u32 v32, v32, v139
    v_cmp_eq_u32 vcc, -1, v32
    s_add_u32 s72, s72, 1
    s_cmp_ge_u32 s72, 0x10000
    s_cbranch_scc1 K1_bk_167
    s_cbranch_vccnz K1_lp_166
    s_branch K1_bk_167
K1_re_168:
    s_mov_b32 s72, 0
    s_add_u32 s70, s94, 114688
K1_lp_169:
    buffer_load_dwordx4 v[140:143], v2, s[20:23], s70 offen offset:3072 sc0 sc1
    s_waitcnt vmcnt(0)
    v_max3_u32 v32, v140, v141, v142
    v_max_u32 v32, v32, v143
    v_cmp_eq_u32 vcc, -1, v32
    s_add_u32 s72, s72, 1
    s_cmp_ge_u32 s72, 0x10000
    s_cbranch_scc1 K1_bk_170
    s_cbranch_vccnz K1_lp_169
    s_branch K1_bk_170
K1_re_171:
    s_mov_b32 s72, 0
    s_add_u32 s70, s94, 131072
K1_lp_172:
    buffer_load_dwordx4 v[144:147], v2, s[20:23], s70 offen offset:0 sc0 sc1
    buffer_load_dwordx4 v[148:151], v2, s[20:23], s70 offen offset:1024 sc0 sc1
    buffer_load_dwordx4 v[152:155], v2, s[20:23], s70 offen offset:2048 sc0 sc1
    buffer_load_dwordx4 v[156:159], v2, s[20:23], s70 offen offset:3072 sc0 sc1
    s_waitcnt vmcnt(0)
    v_max3_u32 v32, v144, v145, v146
    v_max_u32 v32, v32, v147
    v_cmp_eq_u32 vcc, -1, v32
    s_add_u32 s72, s72, 1
    s_cmp_ge_u32 s72, 0x10000
    s_cbranch_scc1 K1_bk_173
    s_cbranch_vccnz K1_lp_172
    s_branch K1_bk_173
K1_re_174:
    s_mov_b32 s72, 0
    s_add_u32 s70, s94, 131072
K1_lp_175:
    buffer_load_dwordx4 v[148:151], v2, s[20:23], s70 offen offset:1024 sc0 sc1
    buffer_load_dwordx4 v[152:155], v2, s[20:23], s70 offen offset:2048 sc0 sc1
    buffer_load_dwordx4 v[156:159], v2, s[20:23], s70 offen offset:3072 sc0 sc1
    s_waitcnt vmcnt(0)
    v_max3_u32 v32, v148, v149, v150
    v_max_u32 v32, v32, v151
    v_cmp_eq_u32 vcc, -1, v32
    s_add_u32 s72, s72, 1
    s_cmp_ge_u32 s72, 0x10000
    s_cbranch_scc1 K1_bk_176
    s_cbranch_vccnz K1_lp_175
    s_branch K1_bk_176
K1_re_177:
    s_mov_b32 s72, 0
    s_add_u32 s70, s94, 131072
K1_lp_178:
    buffer_load_dwordx4 v[152:155], v2, s[20:23], s70 offen offset:2048 sc0 sc1
    buffer_load_dwordx4 v[156:159], v2, s[20:23], s70 offen offset:3072 sc0 sc1
    s_waitcnt vmcnt(0)
    v_max3_u32 v32, v152, v153, v154
    v_max_u32 v32, v32, v155
    v_cmp_eq_u32 vcc, -1, v32
    s_add_u32 s72, s72, 1
    s_cmp_ge_u32 s72, 0x10000
    s_cbranch_scc1 K1_bk_179
    s_cbranch_vccnz K1_lp_178
    s_branch K1_bk_179
K1_re_180:
    s_mov_b32 s72, 0
    s_add_u32 s70, s94, 131072
K1_lp_181:
    buffer_load_dwordx4 v[156:159], v2, s[20:23], s70 offen offset:3072 sc0 sc1
    s_waitcnt vmcnt(0)
    v_max3_u32 v32, v156, v157, v158
    v_max_u32 v32, v32, v159
    v_cmp_eq_u32 vcc, -1, v32
    s_add_u32 s72, s72, 1
    s_cmp_ge_u32 s72, 0x10000
    s_cbranch_scc1 K1_bk_182
    s_cbranch_vccnz K1_lp_181
    s_branch K1_bk_182
    s_endpgm
.section .rodata,"a"
.p2align 6
.amdhsa_kernel recurrent_scan__linear_kernel_hedgehog__glu_gated_geglu__prompt_kernel
  .amdhsa_next_free_vgpr 256
  .amdhsa_next_free_sgpr 102
  .amdhsa_accum_offset 256
  .amdhsa_group_segment_fixed_size 0
  .amdhsa_kernarg_size 88
  .amdhsa_user_sgpr_count 2
  .amdhsa_user_sgpr_kernarg_segment_ptr 1
  .amdhsa_system_sgpr_workgroup_id_x 1
.end_amdhsa_kernel
```
